```python
import torch

def _softmax(x, axis=-1):
    return torch.softmax(x, dim=axis)

def _gelu(x):
    return torch.nn.functional.gelu(x, approximate='tanh')

def _silu(x):
    return torch.nn.functional.silu(x)

def _sigmoid(x):
    return torch.sigmoid(x)

def _layernorm(x, axis=-1, eps=1e-05):
    m = x.mean(dim=axis, keepdim=True)
    v = x.var(dim=axis, keepdim=True, unbiased=False)
    return (x - m) / torch.sqrt(v + eps)

def _scatter_add(tgt, idx, src, axis=0):
    return tgt.clone().index_add_(axis, idx, src)

def _segment_sum(src, seg, n):
    out = torch.zeros((n,) + src.shape[1:], dtype=src.dtype)
    return out.index_add_(0, seg, src)

def _pad(x, pw):
    flat = tuple((v for pair in reversed(pw) for v in pair))
    return torch.nn.functional.pad(x, flat)
kernel_name = 'adaLN_cond__mha_block_cached__swiglu_ffn__decode'

def setup_inputs():

    _w = lambda a: (lambda t: t.to(torch.bfloat16) if t.is_floating_point() else t)(torch.as_tensor(a))

    def _A_setup():
        B, Sq, D = (8, 1, 512)
        H, Sk, Dh = (32, 4096, 128)
        return {'x': _w((lambda *s: torch.randn(*s, dtype=torch.bfloat16) * 0.1)(B, Sq, D)), 'k_cache': _w((lambda *s: torch.randn(*s, dtype=torch.bfloat16) * 0.8)(B, H, Sk, Dh)), 'v_cache': _w((lambda *s: torch.randn(*s, dtype=torch.bfloat16) * 1.6)(B, H, Sk, Dh)), 'wq': _w((lambda *s: torch.randn(*s, dtype=torch.bfloat16) * 0.8)(D, H * Dh) * D ** (-0.5)), 'wo': _w((lambda *s: torch.randn(*s, dtype=torch.bfloat16) * 1.6)(H * Dh, D) * (H * Dh) ** (-0.5))}
    _A_in = _A_setup()

    def _B_setup():
        B, S, D, F = (8, 1, 512, 1376)
        return {'x': _w((lambda *s: torch.randn(*s, dtype=torch.bfloat16) * 0.1)(B, S, D)), 'w_gate': _w((lambda *s: torch.randn(*s, dtype=torch.bfloat16) * 0.1)(D, F)), 'w_up': _w((lambda *s: torch.randn(*s, dtype=torch.bfloat16) * 0.1)(D, F)), 'w_down': _w((lambda *s: torch.randn(*s, dtype=torch.bfloat16) * 0.1)(F, D))}
    _B_in = _B_setup()
    return {'A_x': _A_in['x'], 'A_k_cache': _A_in['k_cache'], 'A_v_cache': _A_in['v_cache'], 'A_wq': _A_in['wq'], 'A_wo': _A_in['wo'], 'B_x': _B_in['x'], 'B_w_gate': _B_in['w_gate'], 'B_w_up': _B_in['w_up'], 'B_w_down': _B_in['w_down'], 'c': _w((lambda *s: torch.randn(*s, dtype=torch.bfloat16) * 0.8)(8, 512) * 8.0), 'w_mod': _w((lambda *s: torch.randn(*s, dtype=torch.bfloat16) * 0.8)(512, 6 * 512) * 512 ** (-0.5) * 8.0)}

def reference(A_x, A_k_cache, A_v_cache, A_wq, A_wo, B_x, B_w_gate, B_w_up, B_w_down, c, w_mod):

    def _A_ref(x, k_cache, v_cache, wq, wo):
        B, Sq, D = x.shape
        H, Dh = (32, 128)
        q = (lambda x, *d: x.permute(*d))((x @ wq).reshape(B, Sq, H, Dh), 0, 2, 1, 3)
        scores = torch.einsum('bhqd,bhkd->bhqk', q, k_cache) * Dh ** (-0.5)
        p = _softmax(scores, axis=-1)
        o = torch.einsum('bhqk,bhkd->bhqd', p, v_cache)
        return (lambda x, *d: x.permute(*d))(o, 0, 2, 1, 3).reshape(B, Sq, H * Dh) @ wo

    def _B_ref(x, w_gate, w_up, w_down):
        g = _silu(x @ w_gate)
        u = x @ w_up
        return g * u @ w_down
    x = A_x
    mod = (_silu(c) @ w_mod).reshape(c.shape[0], 6, 1, -1)
    sa, ca, ga, sb, cb, gb = (mod[:, 0].clone(), mod[:, 1].clone(), mod[:, 2].clone(), mod[:, 3].clone(), mod[:, 4].clone(), mod[:, 5].clone())
    h = _layernorm(x, axis=-1) * (1 + ca) + sa
    x = x + ga * _A_ref(h, A_k_cache, A_v_cache, A_wq, A_wo)
    h = _layernorm(x, axis=-1) * (1 + cb) + sb
    x = x + gb * _B_ref(h, B_w_gate, B_w_up, B_w_down)
    return x
```

```asm
; @launch grid=(256,1,1) block=(512,1,1) lds=158208
.amdgcn_target "amdgcn-amd-amdhsa--gfx950"
.text
.globl adaLN_cond__mha_block_cached__swiglu_ffn__decode_kernel
.p2align 8
.type adaLN_cond__mha_block_cached__swiglu_ffn__decode_kernel,@function
adaLN_cond__mha_block_cached__swiglu_ffn__decode_kernel:
  s_cmp_ge_u32 s2, 256
  s_cbranch_scc1 L_end
  s_nop 0
  s_load_dwordx16 s[16:31], s[0:1], 0
  s_load_dwordx8 s[32:39], s[0:1], 64
  s_load_dwordx4 s[40:43], s[0:1], 96
  v_lshrrev_b32 v1, 6, v0
  s_nop 0
  v_readfirstlane_b32 s3, v1
  v_and_b32 v0, 63, v0
  v_lshlrev_b32_e64 v1, 4, v0
  s_cmp_ge_u32 s3, 4
  s_cbranch_scc1 L_service
  s_memrealtime s[70:71]
  s_and_b32 s58, s2, 7
  s_lshl_b32 s58, s58, 1
  s_bfe_u32 s59, s2, 0x10003
  s_or_b32 s58, s58, s59
  s_and_b32 s59, s2, 16
  s_or_b32 s58, s58, s59
  s_and_b32 s59, s2, 0xe0
  s_or_b32 s58, s58, s59
  s_lshl_b32 s58, s58, 20
  s_lshl_b32 s59, s3, 12
  s_add_u32 s58, s58, s59
  s_mov_b32 s56, s58
  v_mov_b32 v60, 0
  v_and_b32 v45, 15, v0
  v_lshrrev_b32_e64 v46, 4, v0
  s_mul_i32 s78, s3, 12288
  s_add_u32 s78, s78, 39424
  s_waitcnt lgkmcnt(0)
  s_mov_b32 s52, s42
  s_mov_b32 s53, s43
  s_mov_b32 s54, 1073741824
  s_mov_b32 s55, 0x00020000
  buffer_load_dword v3, v60, s[52:55], 0 offen offset:0 sc1
  s_mov_b32 s44, s18
  s_mov_b32 s45, s19
  s_mov_b32 s46, 268435456
  s_mov_b32 s47, 0x00020000
  s_mov_b32 s80, s34
  s_mov_b32 s81, s35
  s_mov_b32 s82, 8192
  s_mov_b32 s83, 0x00020000
  s_mov_b32 s84, s36
  s_mov_b32 s85, s37
  s_mov_b32 s86, 3145728
  s_mov_b32 s87, 0x00020000
  s_mov_b64 s[34:35], -1
  s_cmp_ge_u32 s2, 64
  s_cbranch_scc1 L_s_noissue
  s_setprio 3
  s_and_b32 s74, s2, 7
  s_lshl_b32 s74, s74, 2
  s_lshr_b32 s75, s2, 3
  s_and_b32 s75, s75, 3
  s_add_u32 s74, s74, s75
  s_and_b32 s75, s2, 0xe0
  s_add_u32 s75, s75, s74
  s_lshl_b32 s75, s75, 5
  s_mul_i32 s76, s3, 786432
  s_add_u32 s75, s75, s76
  v_and_b32 v64, 7, v0
  v_lshlrev_b32 v64, 10, v64
  v_bfe_u32 v65, v0, 3, 1
  v_lshl_add_u32 v64, v65, 7, v64
  v_lshl_add_u32 v64, v46, 4, v64
  s_lshl_b32 s76, s3, 8
  buffer_load_dwordx4 v[68:71], v64, s[80:83], s76 offen
  buffer_load_dwordx4 v[72:75], v64, s[80:83], s76 offen offset:64
  v_lshrrev_b32 v65, 1, v0
  v_mul_u32_u24 v65, 6144, v65
  v_and_b32_e64 v66, 1, v0
  v_lshl_add_u32 v65, v66, 4, v65
  s_add_u32 m0, s78, 0
  s_nop 0
  buffer_load_dwordx4 v65, s[84:87], s75 offen  lds
  s_add_u32 s75, s75, 196608
  s_add_u32 m0, s78, 1024
  s_nop 0
  buffer_load_dwordx4 v65, s[84:87], s75 offen  lds
  s_add_u32 s75, s75, 196608
  s_add_u32 m0, s78, 2048
  s_nop 0
  buffer_load_dwordx4 v65, s[84:87], s75 offen  lds
  s_add_u32 s75, s75, 196608
  s_add_u32 m0, s78, 3072
  s_nop 0
  s_nop 0
  buffer_load_dwordx4 v65, s[84:87], s75 offen  lds
L_s_noissue:
  s_cmp_lt_u32 s2, 64
  s_cbranch_scc1 L_s_skip
  buffer_load_dwordx4 v[128:131], v1, s[44:47], s56 offen offset:0 nt
  buffer_load_dwordx4 v[132:135], v1, s[44:47], s56 offen offset:1024 nt
  buffer_load_dwordx4 v[136:139], v1, s[44:47], s56 offen offset:2048 nt
  buffer_load_dwordx4 v[140:143], v1, s[44:47], s56 offen offset:3072 nt
  s_add_u32 s56, s56, 16384
  buffer_load_dwordx4 v[144:147], v1, s[44:47], s56 offen offset:0 nt
  buffer_load_dwordx4 v[148:151], v1, s[44:47], s56 offen offset:1024 nt
  buffer_load_dwordx4 v[152:155], v1, s[44:47], s56 offen offset:2048 nt
  buffer_load_dwordx4 v[156:159], v1, s[44:47], s56 offen offset:3072 nt
  s_add_u32 s56, s56, 16384
  buffer_load_dwordx4 v[160:163], v1, s[44:47], s56 offen offset:0 nt
  buffer_load_dwordx4 v[164:167], v1, s[44:47], s56 offen offset:1024 nt
  buffer_load_dwordx4 v[168:171], v1, s[44:47], s56 offen offset:2048 nt
  buffer_load_dwordx4 v[172:175], v1, s[44:47], s56 offen offset:3072 nt
  s_add_u32 s56, s56, 16384
  buffer_load_dwordx4 v[176:179], v1, s[44:47], s56 offen offset:0 nt
  buffer_load_dwordx4 v[180:183], v1, s[44:47], s56 offen offset:1024 nt
  buffer_load_dwordx4 v[184:187], v1, s[44:47], s56 offen offset:2048 nt
  buffer_load_dwordx4 v[188:191], v1, s[44:47], s56 offen offset:3072 nt
  s_add_u32 s56, s56, 16384
L_s_skip:
  s_mov_b32 s60, 0xaaaaaaaa
  s_mov_b32 s61, 0xaaaaaaaa
  s_mov_b32 s62, 0xcccccccc
  s_mov_b32 s63, 0xcccccccc
  s_mov_b32 s64, 0x05040100
  s_mov_b32 s65, 0x07060302
  s_mov_b32 s66, 0x3db504f3
  s_mov_b32 s88, -1
  s_mov_b32 s89, 0
  s_lshl_b32 s59, s3, 12
  s_add_u32 s59, s59, 20992
  v_lshlrev_b32 v2, 2, v0
  v_add_u32 v2, s59, v2
  v_mov_b32 v40, 0xff800000
  s_barrier
  s_cmp_ge_u32 s2, 64
  s_cbranch_scc1 L_s_moddone
  s_waitcnt vmcnt(4)
  v_readfirstlane_b32 s67, v3
  s_add_u32 s67, s67, 1540483477
  v_lshlrev_b32_e64 v76, 16, v68
  v_and_b32 v77, 0xffff0000, v68
  v_mul_f32 v78, 0xbfb8aa3b, v76
  v_exp_f32 v78, v78
  s_nop 0
  v_add_f32_e64 v78, 1.0, v78
  v_min_f32 v78, 0x7f7fffff, v78
  v_rcp_f32 v80, v78
  s_nop 0
  v_mul_f32_e64 v82, v76, v80
  v_fma_f32 v76, -v82, v78, v76
  v_fma_f32 v76, v76, v80, v82
  v_mul_f32 v79, 0xbfb8aa3b, v77
  v_exp_f32 v79, v79
  s_nop 0
  v_add_f32_e64 v79, 1.0, v79
  v_min_f32 v79, 0x7f7fffff, v79
  v_rcp_f32 v81, v79
  s_nop 0
  v_mul_f32_e64 v83, v77, v81
  v_fma_f32 v77, -v83, v79, v77
  v_fma_f32 v77, v77, v81, v83
  v_cvt_pk_bf16_f32 v68, v76, v77
  v_lshlrev_b32_e64 v76, 16, v69
  v_and_b32 v77, 0xffff0000, v69
  v_mul_f32 v78, 0xbfb8aa3b, v76
  v_exp_f32 v78, v78
  s_nop 0
  v_add_f32_e64 v78, 1.0, v78
  v_min_f32 v78, 0x7f7fffff, v78
  v_rcp_f32 v80, v78
  s_nop 0
  v_mul_f32_e64 v82, v76, v80
  v_fma_f32 v76, -v82, v78, v76
  v_fma_f32 v76, v76, v80, v82
  v_mul_f32 v79, 0xbfb8aa3b, v77
  v_exp_f32 v79, v79
  s_nop 0
  v_add_f32_e64 v79, 1.0, v79
  v_min_f32 v79, 0x7f7fffff, v79
  v_rcp_f32 v81, v79
  s_nop 0
  v_mul_f32_e64 v83, v77, v81
  v_fma_f32 v77, -v83, v79, v77
  v_fma_f32 v77, v77, v81, v83
  v_cvt_pk_bf16_f32 v69, v76, v77
  v_lshlrev_b32_e64 v76, 16, v70
  v_and_b32 v77, 0xffff0000, v70
  v_mul_f32 v78, 0xbfb8aa3b, v76
  v_exp_f32 v78, v78
  s_nop 0
  v_add_f32_e64 v78, 1.0, v78
  v_min_f32 v78, 0x7f7fffff, v78
  v_rcp_f32 v80, v78
  s_nop 0
  v_mul_f32_e64 v82, v76, v80
  v_fma_f32 v76, -v82, v78, v76
  v_fma_f32 v76, v76, v80, v82
  v_mul_f32 v79, 0xbfb8aa3b, v77
  v_exp_f32 v79, v79
  s_nop 0
  v_add_f32_e64 v79, 1.0, v79
  v_min_f32 v79, 0x7f7fffff, v79
  v_rcp_f32 v81, v79
  s_nop 0
  v_mul_f32_e64 v83, v77, v81
  v_fma_f32 v77, -v83, v79, v77
  v_fma_f32 v77, v77, v81, v83
  v_cvt_pk_bf16_f32 v70, v76, v77
  v_lshlrev_b32_e64 v76, 16, v71
  v_and_b32 v77, 0xffff0000, v71
  v_mul_f32 v78, 0xbfb8aa3b, v76
  v_exp_f32 v78, v78
  s_nop 0
  v_add_f32_e64 v78, 1.0, v78
  v_min_f32 v78, 0x7f7fffff, v78
  v_rcp_f32 v80, v78
  s_nop 0
  v_mul_f32_e64 v82, v76, v80
  v_fma_f32 v76, -v82, v78, v76
  v_fma_f32 v76, v76, v80, v82
  v_mul_f32 v79, 0xbfb8aa3b, v77
  v_exp_f32 v79, v79
  s_nop 0
  v_add_f32_e64 v79, 1.0, v79
  v_min_f32 v79, 0x7f7fffff, v79
  v_rcp_f32 v81, v79
  s_nop 0
  v_mul_f32_e64 v83, v77, v81
  v_fma_f32 v77, -v83, v79, v77
  v_fma_f32 v77, v77, v81, v83
  v_cvt_pk_bf16_f32 v71, v76, v77
  v_lshlrev_b32_e64 v76, 16, v72
  v_and_b32 v77, 0xffff0000, v72
  v_mul_f32 v78, 0xbfb8aa3b, v76
  v_exp_f32 v78, v78
  s_nop 0
  v_add_f32_e64 v78, 1.0, v78
  v_min_f32 v78, 0x7f7fffff, v78
  v_rcp_f32 v80, v78
  s_nop 0
  v_mul_f32_e64 v82, v76, v80
  v_fma_f32 v76, -v82, v78, v76
  v_fma_f32 v76, v76, v80, v82
  v_mul_f32 v79, 0xbfb8aa3b, v77
  v_exp_f32 v79, v79
  s_nop 0
  v_add_f32_e64 v79, 1.0, v79
  v_min_f32 v79, 0x7f7fffff, v79
  v_rcp_f32 v81, v79
  s_nop 0
  v_mul_f32_e64 v83, v77, v81
  v_fma_f32 v77, -v83, v79, v77
  v_fma_f32 v77, v77, v81, v83
  v_cvt_pk_bf16_f32 v72, v76, v77
  v_lshlrev_b32_e64 v76, 16, v73
  v_and_b32 v77, 0xffff0000, v73
  v_mul_f32 v78, 0xbfb8aa3b, v76
  v_exp_f32 v78, v78
  s_nop 0
  v_add_f32_e64 v78, 1.0, v78
  v_min_f32 v78, 0x7f7fffff, v78
  v_rcp_f32 v80, v78
  s_nop 0
  v_mul_f32_e64 v82, v76, v80
  v_fma_f32 v76, -v82, v78, v76
  v_fma_f32 v76, v76, v80, v82
  v_mul_f32 v79, 0xbfb8aa3b, v77
  v_exp_f32 v79, v79
  s_nop 0
  v_add_f32_e64 v79, 1.0, v79
  v_min_f32 v79, 0x7f7fffff, v79
  v_rcp_f32 v81, v79
  s_nop 0
  v_mul_f32_e64 v83, v77, v81
  v_fma_f32 v77, -v83, v79, v77
  v_fma_f32 v77, v77, v81, v83
  v_cvt_pk_bf16_f32 v73, v76, v77
  v_lshlrev_b32_e64 v76, 16, v74
  v_and_b32 v77, 0xffff0000, v74
  v_mul_f32 v78, 0xbfb8aa3b, v76
  v_exp_f32 v78, v78
  s_nop 0
  v_add_f32_e64 v78, 1.0, v78
  v_min_f32 v78, 0x7f7fffff, v78
  v_rcp_f32 v80, v78
  s_nop 0
  v_mul_f32_e64 v82, v76, v80
  v_fma_f32 v76, -v82, v78, v76
  v_fma_f32 v76, v76, v80, v82
  v_mul_f32 v79, 0xbfb8aa3b, v77
  v_exp_f32 v79, v79
  s_nop 0
  v_add_f32_e64 v79, 1.0, v79
  v_min_f32 v79, 0x7f7fffff, v79
  v_rcp_f32 v81, v79
  s_nop 0
  v_mul_f32_e64 v83, v77, v81
  v_fma_f32 v77, -v83, v79, v77
  v_fma_f32 v77, v77, v81, v83
  v_cvt_pk_bf16_f32 v74, v76, v77
  v_lshlrev_b32_e64 v76, 16, v75
  v_and_b32 v77, 0xffff0000, v75
  v_mul_f32 v78, 0xbfb8aa3b, v76
  v_exp_f32 v78, v78
  s_nop 0
  v_add_f32_e64 v78, 1.0, v78
  v_min_f32 v78, 0x7f7fffff, v78
  v_rcp_f32 v80, v78
  s_nop 0
  v_mul_f32_e64 v82, v76, v80
  v_fma_f32 v76, -v82, v78, v76
  v_fma_f32 v76, v76, v80, v82
  v_mul_f32 v79, 0xbfb8aa3b, v77
  v_exp_f32 v79, v79
  s_nop 0
  v_add_f32_e64 v79, 1.0, v79
  v_min_f32 v79, 0x7f7fffff, v79
  v_rcp_f32 v81, v79
  s_nop 0
  v_mul_f32_e64 v83, v77, v81
  v_fma_f32 v77, -v83, v79, v77
  v_fma_f32 v77, v77, v81, v83
  v_cvt_pk_bf16_f32 v75, v76, v77
  v_lshrrev_b32 v64, 2, v45
  v_lshlrev_b32 v64, 5, v64
  v_lshl_add_u32 v64, v46, 8, v64
  v_and_b32_e64 v67, 3, v45
  v_lshl_add_u32 v64, v67, 3, v64
  v_add_u32 v64, s78, v64
  s_waitcnt vmcnt(0)
  ds_read_b64_tr_b16 v[84:85], v64 offset:0
  ds_read_b64_tr_b16 v[86:87], v64 offset:128
  ds_read_b64_tr_b16 v[88:89], v64 offset:1024
  ds_read_b64_tr_b16 v[90:91], v64 offset:1152
  ds_read_b64_tr_b16 v[92:93], v64 offset:2048
  ds_read_b64_tr_b16 v[94:95], v64 offset:2176
  ds_read_b64_tr_b16 v[96:97], v64 offset:3072
  ds_read_b64_tr_b16 v[98:99], v64 offset:3200
  s_nop 0
  s_waitcnt lgkmcnt(0)
  v_mfma_f32_16x16x32_bf16 v[100:103], v[68:71], v[84:87], 0
  v_mfma_f32_16x16x32_bf16 v[104:107], v[68:71], v[92:95], 0
  v_mfma_f32_16x16x32_bf16 v[100:103], v[72:75], v[88:91], v[100:103]
  v_mfma_f32_16x16x32_bf16 v[104:107], v[72:75], v[96:99], v[104:107]
  s_nop 0
  s_nop 6
  v_cndmask_b32 v108, v104, v100, s[88:89]
  v_cndmask_b32 v109, v105, v101, s[88:89]
  v_cndmask_b32 v110, v106, v102, s[88:89]
  v_cndmask_b32 v111, v107, v103, s[88:89]
  s_lshl_b32 s76, s3, 10
  v_add_u32 v65, s76, v1
  ds_write_b128 v65, v[108:111] offset:4352
  v_mov_b32_e64 v66, 0
  v_mov_b32 v65, 1
  s_mov_b64 exec, 1
  ds_add_rtn_u32 v65, v66, v65 offset:0
  s_mov_b64 exec, -1
  s_waitcnt lgkmcnt(0)
  v_readfirstlane_b32 s76, v65
  s_cmp_lg_u32 s76, 3
  s_cbranch_scc1 L_s_moddone2
  v_and_b32 v64, 7, v0
  v_lshlrev_b32 v64, 5, v64
  v_lshrrev_b32 v67, 5, v0
  v_lshl_add_u32 v64, v67, 8, v64
  v_bfe_u32 v67, v0, 3, 2
  v_lshl_add_u32 v64, v67, 2, v64
  v_add_u32 v67, 4352, v64
  ds_read2_b32 v[84:85], v67 offset0:0 offset1:4
  ds_read2_b32 v[86:87], v67 offset0:128 offset1:132
  v_add_u32 v67, 1024, v67
  ds_read2_b32 v[88:89], v67 offset0:0 offset1:4
  ds_read2_b32 v[90:91], v67 offset0:128 offset1:132
  v_add_u32 v67, 1024, v67
  ds_read2_b32 v[92:93], v67 offset0:0 offset1:4
  ds_read2_b32 v[94:95], v67 offset0:128 offset1:132
  v_add_u32 v67, 1024, v67
  ds_read2_b32 v[96:97], v67 offset0:0 offset1:4
  ds_read2_b32 v[98:99], v67 offset0:128 offset1:132
  s_waitcnt lgkmcnt(0)
  v_add_f32 v84, v84, v92
  v_add_f32 v85, v85, v93
  v_add_f32 v86, v86, v94
  v_add_f32 v87, v87, v95
  v_add_f32 v88, v88, v96
  v_add_f32 v89, v89, v97
  v_add_f32 v90, v90, v98
  v_add_f32 v91, v91, v99
  v_add_f32 v84, v84, v88
  v_add_f32 v85, v85, v89
  v_add_f32 v86, v86, v90
  v_add_f32 v87, v87, v91
  v_add_f32 v112, v84, v86
  v_add_f32_e64 v113, v85, v87
  v_cvt_pk_bf16_f32 v108, v112, v113
  v_mov_b32_e64 v109, s67
  s_and_b32 s76, s2, 0xe0
  s_add_u32 s76, s76, s74
  s_lshl_b32 s76, s76, 9
  s_add_u32 s76, s76, 4096
  v_lshlrev_b32_e64 v64, 3, v0
  buffer_store_dwordx2 v[108:109], v64, s[52:55], s76 offen sc1
L_s_moddone2:
  s_nop 7
  s_nop 3
  buffer_load_dwordx4 v[128:131], v1, s[44:47], s56 offen offset:0 nt
  buffer_load_dwordx4 v[132:135], v1, s[44:47], s56 offen offset:1024 nt
  buffer_load_dwordx4 v[136:139], v1, s[44:47], s56 offen offset:2048 nt
  buffer_load_dwordx4 v[140:143], v1, s[44:47], s56 offen offset:3072 nt
  s_add_u32 s56, s56, 16384
  buffer_load_dwordx4 v[144:147], v1, s[44:47], s56 offen offset:0 nt
  buffer_load_dwordx4 v[148:151], v1, s[44:47], s56 offen offset:1024 nt
  buffer_load_dwordx4 v[152:155], v1, s[44:47], s56 offen offset:2048 nt
  buffer_load_dwordx4 v[156:159], v1, s[44:47], s56 offen offset:3072 nt
  s_add_u32 s56, s56, 16384
  buffer_load_dwordx4 v[160:163], v1, s[44:47], s56 offen offset:0 nt
  buffer_load_dwordx4 v[164:167], v1, s[44:47], s56 offen offset:1024 nt
  buffer_load_dwordx4 v[168:171], v1, s[44:47], s56 offen offset:2048 nt
  buffer_load_dwordx4 v[172:175], v1, s[44:47], s56 offen offset:3072 nt
  s_add_u32 s56, s56, 16384
  buffer_load_dwordx4 v[176:179], v1, s[44:47], s56 offen offset:0 nt
  buffer_load_dwordx4 v[180:183], v1, s[44:47], s56 offen offset:1024 nt
  buffer_load_dwordx4 v[184:187], v1, s[44:47], s56 offen offset:2048 nt
  buffer_load_dwordx4 v[188:191], v1, s[44:47], s56 offen offset:3072 nt
  s_add_u32 s56, s56, 16384
L_s_moddone:
  s_nop 0
  s_nop 6
  s_nop 3
  s_setprio 0
  s_waitcnt vmcnt(15)
  buffer_load_dwordx4 v[192:195], v1, s[44:47], s56 offen offset:0 nt
  s_waitcnt vmcnt(15)
  buffer_load_dwordx4 v[196:199], v1, s[44:47], s56 offen offset:1024 nt
  s_waitcnt vmcnt(15)
  buffer_load_dwordx4 v[200:203], v1, s[44:47], s56 offen offset:2048 nt
  s_waitcnt vmcnt(15)
  buffer_load_dwordx4 v[204:207], v1, s[44:47], s56 offen offset:3072 nt
  s_add_u32 s56, s56, 16384
  s_waitcnt vmcnt(15)
  buffer_load_dwordx4 v[208:211], v1, s[44:47], s56 offen offset:0 nt
  s_waitcnt vmcnt(15)
  buffer_load_dwordx4 v[212:215], v1, s[44:47], s56 offen offset:1024 nt
  s_waitcnt vmcnt(15)
  buffer_load_dwordx4 v[216:219], v1, s[44:47], s56 offen offset:2048 nt
  s_waitcnt vmcnt(15)
  buffer_load_dwordx4 v[220:223], v1, s[44:47], s56 offen offset:3072 nt
  s_add_u32 s56, s56, 16384
  s_waitcnt vmcnt(15)
  buffer_load_dwordx4 v[224:227], v1, s[44:47], s56 offen offset:0 nt
  s_waitcnt vmcnt(15)
  buffer_load_dwordx4 v[228:231], v1, s[44:47], s56 offen offset:1024 nt
  s_waitcnt vmcnt(15)
  buffer_load_dwordx4 v[232:235], v1, s[44:47], s56 offen offset:2048 nt
  s_waitcnt vmcnt(15)
  buffer_load_dwordx4 v[236:239], v1, s[44:47], s56 offen offset:3072 nt
  s_add_u32 s56, s56, 16384
  s_waitcnt vmcnt(15)
  buffer_load_dwordx4 v[240:243], v1, s[44:47], s56 offen offset:0 nt
  s_waitcnt vmcnt(15)
  buffer_load_dwordx4 v[244:247], v1, s[44:47], s56 offen offset:1024 nt
  s_waitcnt vmcnt(15)
  buffer_load_dwordx4 v[248:251], v1, s[44:47], s56 offen offset:2048 nt
  s_waitcnt vmcnt(15)
  buffer_load_dwordx4 v[252:255], v1, s[44:47], s56 offen offset:3072 nt
  s_add_u32 s56, s56, 16384
  s_waitcnt vmcnt(6)
  buffer_load_dwordx4 v[64:67], v1, s[44:47], s56 offen offset:0 nt
  s_waitcnt vmcnt(6)
  buffer_load_dwordx4 v[68:71], v1, s[44:47], s56 offen offset:1024 nt
  s_waitcnt vmcnt(6)
  buffer_load_dwordx4 v[72:75], v1, s[44:47], s56 offen offset:2048 nt
  s_waitcnt vmcnt(6)
  buffer_load_dwordx4 v[76:79], v1, s[44:47], s56 offen offset:3072 nt
  s_add_u32 s56, s56, 16384
  s_waitcnt vmcnt(6)
  buffer_load_dwordx4 v[80:83], v1, s[44:47], s56 offen offset:0 nt
  s_waitcnt vmcnt(6)
  buffer_load_dwordx4 v[84:87], v1, s[44:47], s56 offen offset:1024 nt
  s_waitcnt vmcnt(6)
  buffer_load_dwordx4 v[88:91], v1, s[44:47], s56 offen offset:2048 nt
  s_waitcnt vmcnt(6)
  buffer_load_dwordx4 v[92:95], v1, s[44:47], s56 offen offset:3072 nt
  s_add_u32 s56, s56, 16384
  s_waitcnt vmcnt(6)
  buffer_load_dwordx4 v[96:99], v1, s[44:47], s56 offen offset:0 nt
  s_waitcnt vmcnt(6)
  buffer_load_dwordx4 v[100:103], v1, s[44:47], s56 offen offset:1024 nt
  s_waitcnt vmcnt(6)
  buffer_load_dwordx4 v[104:107], v1, s[44:47], s56 offen offset:2048 nt
  s_waitcnt vmcnt(6)
  buffer_load_dwordx4 v[108:111], v1, s[44:47], s56 offen offset:3072 nt
  s_add_u32 s56, s56, 16384
  s_waitcnt vmcnt(6)
  buffer_load_dwordx4 v[112:115], v1, s[44:47], s56 offen offset:0 nt
  s_waitcnt vmcnt(6)
  buffer_load_dwordx4 v[116:119], v1, s[44:47], s56 offen offset:1024 nt
  s_waitcnt vmcnt(6)
  buffer_load_dwordx4 v[120:123], v1, s[44:47], s56 offen offset:2048 nt
  s_waitcnt vmcnt(6)
  buffer_load_dwordx4 v[124:127], v1, s[44:47], s56 offen offset:3072 nt
  s_add_u32 s56, s56, 16384
  s_waitcnt vmcnt(6)
  s_lshl_b32 s77, s3, 14
  s_add_u32 m0, s77, 92672
  s_nop 0
  buffer_load_dwordx4 v1, s[44:47], s56 offen offset:0 nt lds
  s_waitcnt vmcnt(6)
  buffer_load_dwordx4 v1, s[44:47], s56 offen offset:1024 nt lds
  s_waitcnt vmcnt(6)
  buffer_load_dwordx4 v1, s[44:47], s56 offen offset:2048 nt lds
  s_waitcnt vmcnt(6)
  buffer_load_dwordx4 v1, s[44:47], s56 offen offset:3072 nt lds
  s_add_u32 s56, s56, 16384
  s_waitcnt vmcnt(6)
  s_lshl_b32 s77, s3, 14
  s_add_u32 m0, s77, 96768
  s_nop 0
  buffer_load_dwordx4 v1, s[44:47], s56 offen offset:0 nt lds
  s_waitcnt vmcnt(6)
  buffer_load_dwordx4 v1, s[44:47], s56 offen offset:1024 nt lds
  s_waitcnt vmcnt(6)
  buffer_load_dwordx4 v1, s[44:47], s56 offen offset:2048 nt lds
  s_waitcnt vmcnt(6)
  buffer_load_dwordx4 v1, s[44:47], s56 offen offset:3072 nt lds
  s_add_u32 s56, s56, 16384
  s_waitcnt vmcnt(6)
  s_lshl_b32 s77, s3, 14
  s_add_u32 m0, s77, 100864
  s_nop 0
  buffer_load_dwordx4 v1, s[44:47], s56 offen offset:0 nt lds
  s_waitcnt vmcnt(6)
  buffer_load_dwordx4 v1, s[44:47], s56 offen offset:1024 nt lds
  s_waitcnt vmcnt(6)
  buffer_load_dwordx4 v1, s[44:47], s56 offen offset:2048 nt lds
  s_waitcnt vmcnt(6)
  buffer_load_dwordx4 v1, s[44:47], s56 offen offset:3072 nt lds
  s_add_u32 s56, s56, 16384
  s_waitcnt vmcnt(6)
  s_lshl_b32 s77, s3, 14
  s_add_u32 m0, s77, 104960
  s_nop 0
  buffer_load_dwordx4 v1, s[44:47], s56 offen offset:0 nt lds
  s_waitcnt vmcnt(6)
  buffer_load_dwordx4 v1, s[44:47], s56 offen offset:1024 nt lds
  s_waitcnt vmcnt(6)
  buffer_load_dwordx4 v1, s[44:47], s56 offen offset:2048 nt lds
  s_waitcnt vmcnt(6)
  buffer_load_dwordx4 v1, s[44:47], s56 offen offset:3072 nt lds
  s_add_u32 s56, s56, 16384
  s_lshl_b32 s77, s3, 14
  s_add_u32 s77, s77, 92672
  v_add_u32 v57, s77, v1
  v_readfirstlane_b32 s67, v3
  s_add_u32 s67, s67, 1540483477
  v_and_b32 v53, 7, v0
  v_mul_u32_u24 v53, 8192, v53
  v_add_u32 v53, 294144, v53
  s_mov_b32 s49, 0
  v_mov_b32 v50, 0
  v_not_b32_e64 v51, s67
  s_sub_u32 s74, s2, 248
  s_mul_i32 s48, s74, 8192
  s_add_u32 s48, s48, 294912
  s_cmp_lt_u32 s74, 8
  s_cselect_b32 s48, s48, 0
  v_mov_b32_e64 v56, s70
  v_subrev_u32 v56, 140, v56
  s_cmp_lg_u32 s3, 0
  s_cbranch_scc1 L_nobase
  ds_write_b32 v60, v56 offset:16
  s_waitcnt lgkmcnt(0)
L_nobase:
  s_barrier
  v_lshlrev_b32_e64 v41, 5, v45
  ds_read_b128 v[8:11], v41 offset:256
  ds_read_b128 v[12:15], v41 offset:272
  ds_read_b128 v[16:19], v41 offset:768
  ds_read_b128 v[20:23], v41 offset:784
  s_waitcnt lgkmcnt(0)
  v_add_f32 v24, v8, v16
  v_add_f32 v25, v9, v17
  v_add_f32 v26, v10, v18
  v_add_f32 v27, v11, v19
  v_add_f32 v28, v12, v20
  v_add_f32 v29, v13, v21
  v_add_f32 v30, v14, v22
  v_add_f32_e64 v31, v15, v23
  ds_read_b128 v[8:11], v41 offset:1280
  ds_read_b128 v[12:15], v41 offset:1296
  ds_read_b128 v[16:19], v41 offset:1792
  ds_read_b128 v[20:23], v41 offset:1808
  s_waitcnt lgkmcnt(0)
  v_add_f32 v8, v8, v16
  v_add_f32 v9, v9, v17
  v_add_f32 v10, v10, v18
  v_add_f32 v11, v11, v19
  v_add_f32 v12, v12, v20
  v_add_f32 v13, v13, v21
  v_add_f32 v14, v14, v22
  v_add_f32 v15, v15, v23
  v_add_f32 v24, v24, v8
  v_add_f32 v25, v25, v9
  v_add_f32 v26, v26, v10
  v_add_f32 v27, v27, v11
  v_add_f32 v28, v28, v12
  v_add_f32 v29, v29, v13
  v_add_f32 v30, v30, v14
  v_add_f32_e64 v31, v31, v15
  v_cvt_pk_bf16_f32 v4, v24, v25
  v_cvt_pk_bf16_f32 v5, v26, v27
  v_cvt_pk_bf16_f32 v6, v28, v29
  v_cvt_pk_bf16_f32 v7, v30, v31
  s_memrealtime s[72:73]
  ds_read_b32 v52, v60 offset:16
  s_waitcnt lgkmcnt(0)
  v_readfirstlane_b32 s73, v52
  s_sub_u32 s72, s72, 1060
  s_sub_u32 s71, s72, s73
  s_mov_b32 s68, 4
  s_cmp_gt_i32 s71, -110
  s_cselect_b32 s68, 3, s68
  s_cmp_gt_i32 s71, -20
  s_cselect_b32 s68, 2, s68
  s_cmp_gt_i32 s71, 50
  s_cselect_b32 s68, 1, s68
  s_cmp_gt_i32 s71, 90
  s_cselect_b32 s68, 0, s68
  s_cmp_lg_u32 s3, 0
  s_cbranch_scc1 L_ct_1
  s_cmp_eq_u32 s48, 0
  s_cbranch_scc1 L_cm_2
  v_mov_b32 v54, s72
  v_mov_b32_e64 v55, s67
  s_add_u32 s50, s48, s49
  s_mov_b64 exec, 1
  buffer_store_dwordx2 v[54:55], v60, s[52:55], s50 offen sc1
  s_mov_b64 exec, -1
L_cm_2:
  s_add_u32 s49, s49, 256
L_ct_1:
  s_cmp_lg_u32 s3, 0
  s_cbranch_scc1 L_ml_3
  buffer_load_dwordx2 v[50:51], v53, s[52:55], s49 offen
L_ml_3:
  s_waitcnt vmcnt(8)
  s_cmp_eq_u32 s68, 0
  s_cbranch_scc1 L_pw_4
  s_waitcnt vmcnt(7)
  s_cmp_eq_u32 s68, 1
  s_cbranch_scc1 L_pw_4
  s_waitcnt vmcnt(6)
  s_cmp_eq_u32 s68, 2
  s_cbranch_scc1 L_pw_4
  s_waitcnt vmcnt(5)
  s_cmp_eq_u32 s68, 3
  s_cbranch_scc1 L_pw_4
  s_waitcnt vmcnt(4)
L_pw_4:
  v_dot2_f32_bf16 v8, v64, v4, 0
  v_dot2_f32_bf16 v8, v65, v5, v8
  v_dot2_f32_bf16 v8, v66, v6, v8
  v_dot2_f32_bf16 v8, v67, v7, v8
  buffer_load_dwordx4 v[64:67], v1, s[44:47], s56 offen offset:0 nt
  v_dot2_f32_bf16 v24, v128, v4, 0
  v_dot2_f32_bf16 v24, v129, v5, v24
  v_dot2_f32_bf16 v24, v130, v6, v24
  v_dot2_f32_bf16 v24, v131, v7, v24
  s_waitcnt vmcnt(8)
  s_cmp_eq_u32 s68, 0
  s_cbranch_scc1 L_pw_5
  s_waitcnt vmcnt(7)
  s_cmp_eq_u32 s68, 1
  s_cbranch_scc1 L_pw_5
  s_waitcnt vmcnt(6)
  s_cmp_eq_u32 s68, 2
  s_cbranch_scc1 L_pw_5
  s_nop 0
  s_waitcnt vmcnt(5)
  s_cmp_eq_u32 s68, 3
  s_cbranch_scc1 L_pw_5
  s_waitcnt vmcnt(4)
L_pw_5:
  v_dot2_f32_bf16 v9, v68, v4, 0
  v_dot2_f32_bf16 v9, v69, v5, v9
  v_dot2_f32_bf16 v9, v70, v6, v9
  v_dot2_f32_bf16 v9, v71, v7, v9
  buffer_load_dwordx4 v[68:71], v1, s[44:47], s56 offen offset:1024 nt
  v_dot2_f32_bf16 v25, v132, v4, 0
  v_dot2_f32_bf16 v25, v133, v5, v25
  v_dot2_f32_bf16 v25, v134, v6, v25
  v_dot2_f32_bf16 v25, v135, v7, v25
  s_waitcnt vmcnt(8)
  s_cmp_eq_u32 s68, 0
  s_cbranch_scc1 L_pw_6
  s_waitcnt vmcnt(7)
  s_cmp_eq_u32 s68, 1
  s_cbranch_scc1 L_pw_6
  s_waitcnt vmcnt(6)
  s_cmp_eq_u32 s68, 2
  s_cbranch_scc1 L_pw_6
  s_nop 0
  s_waitcnt vmcnt(5)
  s_cmp_eq_u32 s68, 3
  s_cbranch_scc1 L_pw_6
  s_waitcnt vmcnt(4)
L_pw_6:
  v_dot2_f32_bf16 v10, v72, v4, 0
  v_dot2_f32_bf16 v10, v73, v5, v10
  v_dot2_f32_bf16 v10, v74, v6, v10
  v_dot2_f32_bf16 v10, v75, v7, v10
  buffer_load_dwordx4 v[72:75], v1, s[44:47], s56 offen offset:2048 nt
  v_add_f32_dpp v8, v8, v8 row_ror:8 row_mask:0xf bank_mask:0x3
  s_nop 0
  s_nop 0
  v_add_f32_dpp v8, v9, v9 row_ror:8 row_mask:0xf bank_mask:0xc
  v_dot2_f32_bf16 v26, v136, v4, 0
  v_dot2_f32_bf16 v26, v137, v5, v26
  v_dot2_f32_bf16 v26, v138, v6, v26
  v_dot2_f32_bf16 v26, v139, v7, v26
  v_add_f32_dpp v24, v24, v24 row_ror:8 row_mask:0xf bank_mask:0x3
  s_nop 1
  v_add_f32_dpp v24, v25, v25 row_ror:8 row_mask:0xf bank_mask:0xc
  s_waitcnt vmcnt(8)
  s_cmp_eq_u32 s68, 0
  s_cbranch_scc1 L_pw_7
  s_waitcnt vmcnt(7)
  s_cmp_eq_u32 s68, 1
  s_cbranch_scc1 L_pw_7
  s_waitcnt vmcnt(6)
  s_cmp_eq_u32 s68, 2
  s_cbranch_scc1 L_pw_7
  s_waitcnt vmcnt(5)
  s_cmp_eq_u32 s68, 3
  s_cbranch_scc1 L_pw_7
  s_waitcnt vmcnt(4)
L_pw_7:
  v_dot2_f32_bf16 v11, v76, v4, 0
  v_dot2_f32_bf16 v11, v77, v5, v11
  v_dot2_f32_bf16 v11, v78, v6, v11
  v_dot2_f32_bf16 v11, v79, v7, v11
  buffer_load_dwordx4 v[76:79], v1, s[44:47], s56 offen offset:3072 nt
  s_add_u32 s56, s56, 16384
  v_dot2_f32_bf16 v27, v140, v4, 0
  v_dot2_f32_bf16 v27, v141, v5, v27
  v_dot2_f32_bf16 v27, v142, v6, v27
  v_dot2_f32_bf16 v27, v143, v7, v27
  s_waitcnt vmcnt(8)
  s_cmp_eq_u32 s68, 0
  s_cbranch_scc1 L_pw_8
  s_waitcnt vmcnt(7)
  s_cmp_eq_u32 s68, 1
  s_cbranch_scc1 L_pw_8
  s_waitcnt vmcnt(6)
  s_cmp_eq_u32 s68, 2
  s_cbranch_scc1 L_pw_8
  s_nop 0
  s_waitcnt vmcnt(5)
  s_cmp_eq_u32 s68, 3
  s_cbranch_scc1 L_pw_8
  s_waitcnt vmcnt(4)
L_pw_8:
  v_dot2_f32_bf16 v12, v80, v4, 0
  v_dot2_f32_bf16 v12, v81, v5, v12
  v_dot2_f32_bf16 v12, v82, v6, v12
  v_dot2_f32_bf16 v12, v83, v7, v12
  buffer_load_dwordx4 v[80:83], v1, s[44:47], s56 offen offset:0 nt
  v_add_f32_dpp v10, v10, v10 row_ror:8 row_mask:0xf bank_mask:0x3
  s_nop 0
  s_nop 0
  v_add_f32_dpp v10, v11, v11 row_ror:8 row_mask:0xf bank_mask:0xc
  v_dot2_f32_bf16 v28, v144, v4, 0
  v_dot2_f32_bf16 v28, v145, v5, v28
  v_dot2_f32_bf16 v28, v146, v6, v28
  v_dot2_f32_bf16 v28, v147, v7, v28
  v_add_f32_dpp v26, v26, v26 row_ror:8 row_mask:0xf bank_mask:0x3
  s_nop 1
  v_add_f32_dpp v26, v27, v27 row_ror:8 row_mask:0xf bank_mask:0xc
  s_waitcnt vmcnt(8)
  s_cmp_eq_u32 s68, 0
  s_cbranch_scc1 L_pw_9
  s_waitcnt vmcnt(7)
  s_cmp_eq_u32 s68, 1
  s_cbranch_scc1 L_pw_9
  s_waitcnt vmcnt(6)
  s_cmp_eq_u32 s68, 2
  s_cbranch_scc1 L_pw_9
  s_waitcnt vmcnt(5)
  s_cmp_eq_u32 s68, 3
  s_cbranch_scc1 L_pw_9
  s_waitcnt vmcnt(4)
L_pw_9:
  v_dot2_f32_bf16 v13, v84, v4, 0
  v_dot2_f32_bf16 v13, v85, v5, v13
  v_dot2_f32_bf16 v13, v86, v6, v13
  v_dot2_f32_bf16 v13, v87, v7, v13
  buffer_load_dwordx4 v[84:87], v1, s[44:47], s56 offen offset:1024 nt
  v_add_f32_dpp v8, v8, v8 row_shl:4 row_mask:0xf bank_mask:0x5
  s_nop 0
  s_nop 0
  v_add_f32_dpp v8, v10, v10 row_shr:4 row_mask:0xf bank_mask:0xa
  v_dot2_f32_bf16 v29, v148, v4, 0
  v_dot2_f32_bf16 v29, v149, v5, v29
  v_dot2_f32_bf16 v29, v150, v6, v29
  v_dot2_f32_bf16 v29, v151, v7, v29
  v_add_f32_dpp v24, v24, v24 row_shl:4 row_mask:0xf bank_mask:0x5
  s_nop 1
  v_add_f32_dpp v24, v26, v26 row_shr:4 row_mask:0xf bank_mask:0xa
  s_waitcnt vmcnt(8)
  s_cmp_eq_u32 s68, 0
  s_cbranch_scc1 L_pw_10
  s_waitcnt vmcnt(7)
  s_cmp_eq_u32 s68, 1
  s_cbranch_scc1 L_pw_10
  s_waitcnt vmcnt(6)
  s_cmp_eq_u32 s68, 2
  s_cbranch_scc1 L_pw_10
  s_waitcnt vmcnt(5)
  s_cmp_eq_u32 s68, 3
  s_cbranch_scc1 L_pw_10
  s_waitcnt vmcnt(4)
L_pw_10:
  v_dot2_f32_bf16 v14, v88, v4, 0
  v_dot2_f32_bf16 v14, v89, v5, v14
  v_dot2_f32_bf16 v14, v90, v6, v14
  v_dot2_f32_bf16 v14, v91, v7, v14
  buffer_load_dwordx4 v[88:91], v1, s[44:47], s56 offen offset:2048 nt
  v_add_f32_dpp v12, v12, v12 row_ror:8 row_mask:0xf bank_mask:0x3
  s_nop 0
  s_nop 0
  v_add_f32_dpp v12, v13, v13 row_ror:8 row_mask:0xf bank_mask:0xc
  v_dot2_f32_bf16 v30, v152, v4, 0
  v_dot2_f32_bf16 v30, v153, v5, v30
  v_dot2_f32_bf16 v30, v154, v6, v30
  v_dot2_f32_bf16 v30, v155, v7, v30
  v_add_f32_dpp v28, v28, v28 row_ror:8 row_mask:0xf bank_mask:0x3
  s_nop 1
  v_add_f32_dpp v28, v29, v29 row_ror:8 row_mask:0xf bank_mask:0xc
  s_waitcnt vmcnt(8)
  s_cmp_eq_u32 s68, 0
  s_cbranch_scc1 L_pw_11
  s_waitcnt vmcnt(7)
  s_cmp_eq_u32 s68, 1
  s_cbranch_scc1 L_pw_11
  s_waitcnt vmcnt(6)
  s_cmp_eq_u32 s68, 2
  s_cbranch_scc1 L_pw_11
  s_waitcnt vmcnt(5)
  s_cmp_eq_u32 s68, 3
  s_cbranch_scc1 L_pw_11
  s_waitcnt vmcnt(4)
L_pw_11:
  v_dot2_f32_bf16 v15, v92, v4, 0
  v_dot2_f32_bf16 v15, v93, v5, v15
  v_dot2_f32_bf16 v15, v94, v6, v15
  v_dot2_f32_bf16 v15, v95, v7, v15
  buffer_load_dwordx4 v[92:95], v1, s[44:47], s56 offen offset:3072 nt
  s_add_u32 s56, s56, 16384
  v_dot2_f32_bf16 v31, v156, v4, 0
  v_dot2_f32_bf16 v31, v157, v5, v31
  v_dot2_f32_bf16 v31, v158, v6, v31
  v_dot2_f32_bf16 v31, v159, v7, v31
  s_waitcnt vmcnt(8)
  s_cmp_eq_u32 s68, 0
  s_cbranch_scc1 L_pw_12
  s_waitcnt vmcnt(7)
  s_cmp_eq_u32 s68, 1
  s_cbranch_scc1 L_pw_12
  s_waitcnt vmcnt(6)
  s_cmp_eq_u32 s68, 2
  s_cbranch_scc1 L_pw_12
  s_nop 0
  s_waitcnt vmcnt(5)
  s_cmp_eq_u32 s68, 3
  s_cbranch_scc1 L_pw_12
  s_waitcnt vmcnt(4)
L_pw_12:
  v_dot2_f32_bf16 v16, v96, v4, 0
  v_dot2_f32_bf16 v16, v97, v5, v16
  v_dot2_f32_bf16 v16, v98, v6, v16
  v_dot2_f32_bf16 v16, v99, v7, v16
  buffer_load_dwordx4 v[96:99], v1, s[44:47], s56 offen offset:0 nt
  v_add_f32_dpp v14, v14, v14 row_ror:8 row_mask:0xf bank_mask:0x3
  s_nop 0
  s_nop 0
  v_add_f32_dpp v14, v15, v15 row_ror:8 row_mask:0xf bank_mask:0xc
  v_dot2_f32_bf16 v32, v160, v4, 0
  v_dot2_f32_bf16 v32, v161, v5, v32
  v_dot2_f32_bf16 v32, v162, v6, v32
  v_dot2_f32_bf16 v32, v163, v7, v32
  v_add_f32_dpp v30, v30, v30 row_ror:8 row_mask:0xf bank_mask:0x3
  s_nop 1
  v_add_f32_dpp v30, v31, v31 row_ror:8 row_mask:0xf bank_mask:0xc
  s_waitcnt vmcnt(8)
  s_cmp_eq_u32 s68, 0
  s_cbranch_scc1 L_pw_13
  s_waitcnt vmcnt(7)
  s_cmp_eq_u32 s68, 1
  s_cbranch_scc1 L_pw_13
  s_waitcnt vmcnt(6)
  s_cmp_eq_u32 s68, 2
  s_cbranch_scc1 L_pw_13
  s_waitcnt vmcnt(5)
  s_cmp_eq_u32 s68, 3
  s_cbranch_scc1 L_pw_13
  s_waitcnt vmcnt(4)
L_pw_13:
  v_dot2_f32_bf16 v17, v100, v4, 0
  v_dot2_f32_bf16 v17, v101, v5, v17
  v_dot2_f32_bf16 v17, v102, v6, v17
  v_dot2_f32_bf16 v17, v103, v7, v17
  buffer_load_dwordx4 v[100:103], v1, s[44:47], s56 offen offset:1024 nt
  v_add_f32_dpp v12, v12, v12 row_shl:4 row_mask:0xf bank_mask:0x5
  s_nop 0
  s_nop 0
  v_add_f32_dpp v12, v14, v14 row_shr:4 row_mask:0xf bank_mask:0xa
  v_dot2_f32_bf16 v33, v164, v4, 0
  v_dot2_f32_bf16 v33, v165, v5, v33
  v_dot2_f32_bf16 v33, v166, v6, v33
  v_dot2_f32_bf16 v33, v167, v7, v33
  v_add_f32_dpp v28, v28, v28 row_shl:4 row_mask:0xf bank_mask:0x5
  s_nop 1
  v_add_f32_dpp v28, v30, v30 row_shr:4 row_mask:0xf bank_mask:0xa
  s_waitcnt vmcnt(8)
  s_cmp_eq_u32 s68, 0
  s_cbranch_scc1 L_pw_14
  s_waitcnt vmcnt(7)
  s_cmp_eq_u32 s68, 1
  s_cbranch_scc1 L_pw_14
  s_waitcnt vmcnt(6)
  s_cmp_eq_u32 s68, 2
  s_cbranch_scc1 L_pw_14
  s_waitcnt vmcnt(5)
  s_cmp_eq_u32 s68, 3
  s_cbranch_scc1 L_pw_14
  s_waitcnt vmcnt(4)
L_pw_14:
  v_dot2_f32_bf16 v18, v104, v4, 0
  v_dot2_f32_bf16 v18, v105, v5, v18
  v_dot2_f32_bf16 v18, v106, v6, v18
  v_dot2_f32_bf16 v18, v107, v7, v18
  buffer_load_dwordx4 v[104:107], v1, s[44:47], s56 offen offset:2048 nt
  v_add_f32_dpp v16, v16, v16 row_ror:8 row_mask:0xf bank_mask:0x3
  s_nop 0
  s_nop 0
  v_add_f32_dpp v16, v17, v17 row_ror:8 row_mask:0xf bank_mask:0xc
  v_dot2_f32_bf16 v34, v168, v4, 0
  v_dot2_f32_bf16 v34, v169, v5, v34
  v_dot2_f32_bf16 v34, v170, v6, v34
  v_dot2_f32_bf16 v34, v171, v7, v34
  v_add_f32_dpp v32, v32, v32 row_ror:8 row_mask:0xf bank_mask:0x3
  s_nop 1
  v_add_f32_dpp v32, v33, v33 row_ror:8 row_mask:0xf bank_mask:0xc
  s_waitcnt vmcnt(8)
  s_cmp_eq_u32 s68, 0
  s_cbranch_scc1 L_pw_15
  s_waitcnt vmcnt(7)
  s_cmp_eq_u32 s68, 1
  s_cbranch_scc1 L_pw_15
  s_waitcnt vmcnt(6)
  s_cmp_eq_u32 s68, 2
  s_cbranch_scc1 L_pw_15
  s_waitcnt vmcnt(5)
  s_cmp_eq_u32 s68, 3
  s_cbranch_scc1 L_pw_15
  s_waitcnt vmcnt(4)
L_pw_15:
  v_dot2_f32_bf16 v19, v108, v4, 0
  v_dot2_f32_bf16 v19, v109, v5, v19
  v_dot2_f32_bf16 v19, v110, v6, v19
  v_dot2_f32_bf16 v19, v111, v7, v19
  buffer_load_dwordx4 v[108:111], v1, s[44:47], s56 offen offset:3072 nt
  s_add_u32 s56, s56, 16384
  v_dot2_f32_bf16 v35, v172, v4, 0
  v_dot2_f32_bf16 v35, v173, v5, v35
  v_dot2_f32_bf16 v35, v174, v6, v35
  v_dot2_f32_bf16 v35, v175, v7, v35
  s_memrealtime s[72:73]
  ds_read_b32 v52, v60 offset:16
  s_waitcnt vmcnt(8)
  s_cmp_eq_u32 s68, 0
  s_cbranch_scc1 L_pw_16
  s_waitcnt vmcnt(7)
  s_cmp_eq_u32 s68, 1
  s_cbranch_scc1 L_pw_16
  s_waitcnt vmcnt(6)
  s_cmp_eq_u32 s68, 2
  s_cbranch_scc1 L_pw_16
  s_nop 0
  s_waitcnt vmcnt(5)
  s_cmp_eq_u32 s68, 3
  s_cbranch_scc1 L_pw_16
  s_waitcnt vmcnt(4)
L_pw_16:
  v_dot2_f32_bf16 v20, v112, v4, 0
  v_dot2_f32_bf16 v20, v113, v5, v20
  v_dot2_f32_bf16 v20, v114, v6, v20
  v_dot2_f32_bf16 v20, v115, v7, v20
  buffer_load_dwordx4 v[112:115], v1, s[44:47], s56 offen offset:0 nt
  v_add_f32_dpp v18, v18, v18 row_ror:8 row_mask:0xf bank_mask:0x3
  s_nop 0
  s_nop 0
  v_add_f32_dpp v18, v19, v19 row_ror:8 row_mask:0xf bank_mask:0xc
  v_dot2_f32_bf16 v36, v176, v4, 0
  v_dot2_f32_bf16 v36, v177, v5, v36
  v_dot2_f32_bf16 v36, v178, v6, v36
  v_dot2_f32_bf16 v36, v179, v7, v36
  v_add_f32_dpp v34, v34, v34 row_ror:8 row_mask:0xf bank_mask:0x3
  s_nop 1
  v_add_f32_dpp v34, v35, v35 row_ror:8 row_mask:0xf bank_mask:0xc
  s_waitcnt vmcnt(8)
  s_cmp_eq_u32 s68, 0
  s_cbranch_scc1 L_pw_17
  s_waitcnt vmcnt(7)
  s_cmp_eq_u32 s68, 1
  s_cbranch_scc1 L_pw_17
  s_waitcnt vmcnt(6)
  s_cmp_eq_u32 s68, 2
  s_cbranch_scc1 L_pw_17
  s_waitcnt vmcnt(5)
  s_cmp_eq_u32 s68, 3
  s_cbranch_scc1 L_pw_17
  s_waitcnt vmcnt(4)
L_pw_17:
  v_dot2_f32_bf16 v21, v116, v4, 0
  v_dot2_f32_bf16 v21, v117, v5, v21
  v_dot2_f32_bf16 v21, v118, v6, v21
  v_dot2_f32_bf16 v21, v119, v7, v21
  buffer_load_dwordx4 v[116:119], v1, s[44:47], s56 offen offset:1024 nt
  v_add_f32_dpp v16, v16, v16 row_shl:4 row_mask:0xf bank_mask:0x5
  s_nop 0
  s_nop 0
  v_add_f32_dpp v16, v18, v18 row_shr:4 row_mask:0xf bank_mask:0xa
  v_dot2_f32_bf16 v37, v180, v4, 0
  v_dot2_f32_bf16 v37, v181, v5, v37
  v_dot2_f32_bf16 v37, v182, v6, v37
  v_dot2_f32_bf16 v37, v183, v7, v37
  v_add_f32_dpp v32, v32, v32 row_shl:4 row_mask:0xf bank_mask:0x5
  s_nop 1
  v_add_f32_dpp v32, v34, v34 row_shr:4 row_mask:0xf bank_mask:0xa
  s_waitcnt vmcnt(8)
  s_cmp_eq_u32 s68, 0
  s_cbranch_scc1 L_pw_18
  s_waitcnt vmcnt(7)
  s_cmp_eq_u32 s68, 1
  s_cbranch_scc1 L_pw_18
  s_waitcnt vmcnt(6)
  s_cmp_eq_u32 s68, 2
  s_cbranch_scc1 L_pw_18
  s_waitcnt vmcnt(5)
  s_cmp_eq_u32 s68, 3
  s_cbranch_scc1 L_pw_18
  s_waitcnt vmcnt(4)
L_pw_18:
  v_dot2_f32_bf16 v22, v120, v4, 0
  v_dot2_f32_bf16 v22, v121, v5, v22
  v_dot2_f32_bf16 v22, v122, v6, v22
  v_dot2_f32_bf16 v22, v123, v7, v22
  buffer_load_dwordx4 v[120:123], v1, s[44:47], s56 offen offset:2048 nt
  v_add_f32_dpp v20, v20, v20 row_ror:8 row_mask:0xf bank_mask:0x3
  s_nop 0
  s_nop 0
  v_add_f32_dpp v20, v21, v21 row_ror:8 row_mask:0xf bank_mask:0xc
  v_dot2_f32_bf16 v38, v184, v4, 0
  v_dot2_f32_bf16 v38, v185, v5, v38
  v_dot2_f32_bf16 v38, v186, v6, v38
  v_dot2_f32_bf16 v38, v187, v7, v38
  v_add_f32_dpp v36, v36, v36 row_ror:8 row_mask:0xf bank_mask:0x3
  s_nop 0
  s_nop 0
  v_add_f32_dpp v36, v37, v37 row_ror:8 row_mask:0xf bank_mask:0xc
  s_waitcnt lgkmcnt(0)
  v_readfirstlane_b32 s73, v52
  s_sub_u32 s72, s72, 1243
  s_sub_u32 s71, s72, s73
  s_mov_b32 s68, 4
  s_cmp_gt_i32 s71, -110
  s_cselect_b32 s68, 3, s68
  s_cmp_gt_i32 s71, -20
  s_cselect_b32 s68, 2, s68
  s_cmp_gt_i32 s71, 50
  s_cselect_b32 s68, 1, s68
  s_cmp_gt_i32 s71, 90
  s_cselect_b32 s68, 0, s68
  s_cmp_lg_u32 s3, 0
  s_cbranch_scc1 L_ct_19
  s_cmp_eq_u32 s48, 0
  s_cbranch_scc1 L_cm_20
  v_mov_b32 v54, s72
  v_mov_b32 v55, s67
  s_add_u32 s50, s48, s49
  s_mov_b64 exec, 1
  buffer_store_dwordx2 v[54:55], v60, s[52:55], s50 offen sc1
  s_mov_b64 exec, -1
L_cm_20:
  s_add_u32 s49, s49, 256
  v_cmp_ne_u32 vcc, s67, v51
  v_subrev_u32 v56, s70, v50
  s_nop 0
  s_nop 0
  v_add_u32_dpp v56, v56, v56 quad_perm:[1,0,3,2] row_mask:0xf bank_mask:0xf
  s_nop 0
  s_nop 0
  v_add_u32_dpp v56, v56, v56 quad_perm:[2,3,0,1] row_mask:0xf bank_mask:0xf
  s_nop 0
  s_nop 0
  v_add_u32_dpp v56, v56, v56 row_half_mirror row_mask:0xf bank_mask:0xf
  v_ashrrev_i32 v56, 3, v56
  s_add_u32 s73, s70, 0
  v_add_u32_e64 v56, s73, v56
  s_cbranch_vccnz L_ct_19
  ds_write_b32 v60, v56 offset:16
L_ct_19:
  s_waitcnt vmcnt(8)
  s_cmp_eq_u32 s68, 0
  s_cbranch_scc1 L_pw_21
  s_waitcnt vmcnt(7)
  s_cmp_eq_u32 s68, 1
  s_cbranch_scc1 L_pw_21
  s_waitcnt vmcnt(6)
  s_cmp_eq_u32 s68, 2
  s_cbranch_scc1 L_pw_21
  s_waitcnt vmcnt(5)
  s_cmp_eq_u32 s68, 3
  s_cbranch_scc1 L_pw_21
  s_waitcnt vmcnt(4)
L_pw_21:
  v_dot2_f32_bf16 v23, v124, v4, 0
  v_dot2_f32_bf16 v23, v125, v5, v23
  v_dot2_f32_bf16 v23, v126, v6, v23
  v_dot2_f32_bf16 v23, v127, v7, v23
  buffer_load_dwordx4 v[124:127], v1, s[44:47], s56 offen offset:3072 nt
  s_add_u32 s56, s56, 16384
  v_dot2_f32_bf16 v39, v188, v4, 0
  v_dot2_f32_bf16 v39, v189, v5, v39
  v_dot2_f32_bf16 v39, v190, v6, v39
  v_dot2_f32_bf16 v39, v191, v7, v39
  v_add_f32_dpp v22, v22, v22 row_ror:8 row_mask:0xf bank_mask:0x3
  s_nop 0
  s_nop 0
  v_add_f32_dpp v22, v23, v23 row_ror:8 row_mask:0xf bank_mask:0xc
  v_add_f32_dpp v20, v20, v20 row_shl:4 row_mask:0xf bank_mask:0x5
  s_nop 0
  s_nop 0
  v_add_f32_dpp v20, v22, v22 row_shr:4 row_mask:0xf bank_mask:0xa
  v_add_f32_dpp v8, v8, v8 quad_perm:[2,3,0,1] row_mask:0xf bank_mask:0xf
  v_add_f32_dpp v12, v12, v12 quad_perm:[2,3,0,1] row_mask:0xf bank_mask:0xf
  v_add_f32_dpp v16, v16, v16 quad_perm:[2,3,0,1] row_mask:0xf bank_mask:0xf
  v_add_f32_dpp v20, v20, v20 quad_perm:[2,3,0,1] row_mask:0xf bank_mask:0xf
  v_cndmask_b32 v8, v8, v12, s[62:63]
  v_cndmask_b32 v16, v16, v20, s[62:63]
  s_nop 0
  s_nop 0
  v_add_f32_dpp v8, v8, v8 quad_perm:[1,0,3,2] row_mask:0xf bank_mask:0xf
  v_add_f32_dpp v16, v16, v16 quad_perm:[1,0,3,2] row_mask:0xf bank_mask:0xf
  v_cndmask_b32 v41, v8, v16, s[60:61]
  v_cvt_pk_bf16_f32 v42, v41, v41
  v_lshlrev_b32 v41, 16, v42
  v_mul_f32 v41, s66, v41
  v_cvt_pk_bf16_f32 v42, v41, v41
  v_lshlrev_b32 v41, 16, v42
  v_max_f32 v40, v40, v41
  ds_write_b32 v2, v41 offset:512
  v_add_f32_dpp v38, v38, v38 row_ror:8 row_mask:0xf bank_mask:0x3
  s_nop 0
  s_nop 0
  v_add_f32_dpp v38, v39, v39 row_ror:8 row_mask:0xf bank_mask:0xc
  v_add_f32_dpp v36, v36, v36 row_shl:4 row_mask:0xf bank_mask:0x5
  s_nop 0
  s_nop 0
  v_add_f32_dpp v36, v38, v38 row_shr:4 row_mask:0xf bank_mask:0xa
  v_add_f32_dpp v24, v24, v24 quad_perm:[2,3,0,1] row_mask:0xf bank_mask:0xf
  v_add_f32_dpp v28, v28, v28 quad_perm:[2,3,0,1] row_mask:0xf bank_mask:0xf
  v_add_f32_dpp v32, v32, v32 quad_perm:[2,3,0,1] row_mask:0xf bank_mask:0xf
  v_add_f32_dpp v36, v36, v36 quad_perm:[2,3,0,1] row_mask:0xf bank_mask:0xf
  v_cndmask_b32 v24, v24, v28, s[62:63]
  v_cndmask_b32 v32, v32, v36, s[62:63]
  s_nop 0
  s_nop 0
  v_add_f32_dpp v24, v24, v24 quad_perm:[1,0,3,2] row_mask:0xf bank_mask:0xf
  v_add_f32_dpp v32, v32, v32 quad_perm:[1,0,3,2] row_mask:0xf bank_mask:0xf
  v_cndmask_b32 v43, v24, v32, s[60:61]
  v_cvt_pk_bf16_f32 v44, v43, v43
  v_lshlrev_b32 v43, 16, v44
  v_mul_f32 v43, s66, v43
  v_cvt_pk_bf16_f32 v44, v43, v43
  v_lshlrev_b32 v43, 16, v44
  v_max_f32 v40, v40, v43
  ds_write_b32 v2, v43 offset:0
  s_cmp_lg_u32 s3, 0
  s_cbranch_scc1 L_ml_22
  buffer_load_dwordx2 v[50:51], v53, s[52:55], s49 offen
L_ml_22:
  s_waitcnt vmcnt(8)
  s_cmp_eq_u32 s68, 0
  s_cbranch_scc1 L_pw_23
  s_waitcnt vmcnt(7)
  s_cmp_eq_u32 s68, 1
  s_cbranch_scc1 L_pw_23
  s_waitcnt vmcnt(6)
  s_cmp_eq_u32 s68, 2
  s_cbranch_scc1 L_pw_23
  s_nop 0
  s_waitcnt vmcnt(5)
  s_cmp_eq_u32 s68, 3
  s_cbranch_scc1 L_pw_23
  s_waitcnt vmcnt(4)
L_pw_23:
  v_dot2_f32_bf16 v8, v64, v4, 0
  v_dot2_f32_bf16 v8, v65, v5, v8
  v_dot2_f32_bf16 v8, v66, v6, v8
  v_dot2_f32_bf16 v8, v67, v7, v8
  buffer_load_dwordx4 v[64:67], v1, s[44:47], s56 offen offset:0 nt
  v_dot2_f32_bf16 v24, v192, v4, 0
  v_dot2_f32_bf16 v24, v193, v5, v24
  v_dot2_f32_bf16 v24, v194, v6, v24
  v_dot2_f32_bf16 v24, v195, v7, v24
  ds_read_b128 v[128:131], v57 offset:0
  ds_read_b128 v[132:135], v57 offset:1024
  s_waitcnt vmcnt(8)
  s_cmp_eq_u32 s68, 0
  s_cbranch_scc1 L_pw_24
  s_waitcnt vmcnt(7)
  s_cmp_eq_u32 s68, 1
  s_cbranch_scc1 L_pw_24
  s_waitcnt vmcnt(6)
  s_cmp_eq_u32 s68, 2
  s_cbranch_scc1 L_pw_24
  s_nop 0
  s_waitcnt vmcnt(5)
  s_cmp_eq_u32 s68, 3
  s_cbranch_scc1 L_pw_24
  s_waitcnt vmcnt(4)
L_pw_24:
  v_dot2_f32_bf16 v9, v68, v4, 0
  v_dot2_f32_bf16 v9, v69, v5, v9
  v_dot2_f32_bf16 v9, v70, v6, v9
  v_dot2_f32_bf16 v9, v71, v7, v9
  buffer_load_dwordx4 v[68:71], v1, s[44:47], s56 offen offset:1024 nt
  v_dot2_f32_bf16 v25, v196, v4, 0
  v_dot2_f32_bf16 v25, v197, v5, v25
  v_dot2_f32_bf16 v25, v198, v6, v25
  v_dot2_f32_bf16 v25, v199, v7, v25
  ds_read_b128 v[136:139], v57 offset:2048
  ds_read_b128 v[140:143], v57 offset:3072
  s_waitcnt vmcnt(8)
  s_cmp_eq_u32 s68, 0
  s_cbranch_scc1 L_pw_25
  s_waitcnt vmcnt(7)
  s_cmp_eq_u32 s68, 1
  s_cbranch_scc1 L_pw_25
  s_waitcnt vmcnt(6)
  s_cmp_eq_u32 s68, 2
  s_cbranch_scc1 L_pw_25
  s_nop 0
  s_waitcnt vmcnt(5)
  s_cmp_eq_u32 s68, 3
  s_cbranch_scc1 L_pw_25
  s_waitcnt vmcnt(4)
L_pw_25:
  v_dot2_f32_bf16 v10, v72, v4, 0
  v_dot2_f32_bf16 v10, v73, v5, v10
  v_dot2_f32_bf16 v10, v74, v6, v10
  v_dot2_f32_bf16 v10, v75, v7, v10
  buffer_load_dwordx4 v[72:75], v1, s[44:47], s56 offen offset:2048 nt
  v_add_f32_dpp v8, v8, v8 row_ror:8 row_mask:0xf bank_mask:0x3
  s_nop 0
  s_nop 0
  v_add_f32_dpp v8, v9, v9 row_ror:8 row_mask:0xf bank_mask:0xc
  v_dot2_f32_bf16 v26, v200, v4, 0
  v_dot2_f32_bf16 v26, v201, v5, v26
  v_dot2_f32_bf16 v26, v202, v6, v26
  v_dot2_f32_bf16 v26, v203, v7, v26
  v_add_f32_dpp v24, v24, v24 row_ror:8 row_mask:0xf bank_mask:0x3
  s_nop 0
  s_nop 0
  v_add_f32_dpp v24, v25, v25 row_ror:8 row_mask:0xf bank_mask:0xc
  ds_read_b128 v[144:147], v57 offset:4096
  ds_read_b128 v[148:151], v57 offset:5120
  s_waitcnt vmcnt(8)
  s_cmp_eq_u32 s68, 0
  s_cbranch_scc1 L_pw_26
  s_waitcnt vmcnt(7)
  s_cmp_eq_u32 s68, 1
  s_cbranch_scc1 L_pw_26
  s_waitcnt vmcnt(6)
  s_cmp_eq_u32 s68, 2
  s_cbranch_scc1 L_pw_26
  s_nop 0
  s_waitcnt vmcnt(5)
  s_cmp_eq_u32 s68, 3
  s_cbranch_scc1 L_pw_26
  s_waitcnt vmcnt(4)
L_pw_26:
  v_dot2_f32_bf16 v11, v76, v4, 0
  v_dot2_f32_bf16 v11, v77, v5, v11
  v_dot2_f32_bf16 v11, v78, v6, v11
  v_dot2_f32_bf16 v11, v79, v7, v11
  buffer_load_dwordx4 v[76:79], v1, s[44:47], s56 offen offset:3072 nt
  s_add_u32 s56, s56, 16384
  v_dot2_f32_bf16 v27, v204, v4, 0
  v_dot2_f32_bf16 v27, v205, v5, v27
  v_dot2_f32_bf16 v27, v206, v6, v27
  v_dot2_f32_bf16 v27, v207, v7, v27
  ds_read_b128 v[152:155], v57 offset:6144
  ds_read_b128 v[156:159], v57 offset:7168
  s_waitcnt vmcnt(8)
  s_cmp_eq_u32 s68, 0
  s_cbranch_scc1 L_pw_27
  s_waitcnt vmcnt(7)
  s_cmp_eq_u32 s68, 1
  s_cbranch_scc1 L_pw_27
  s_waitcnt vmcnt(6)
  s_cmp_eq_u32 s68, 2
  s_cbranch_scc1 L_pw_27
  s_nop 0
  s_waitcnt vmcnt(5)
  s_cmp_eq_u32 s68, 3
  s_cbranch_scc1 L_pw_27
  s_waitcnt vmcnt(4)
L_pw_27:
  v_dot2_f32_bf16 v12, v80, v4, 0
  v_dot2_f32_bf16 v12, v81, v5, v12
  v_dot2_f32_bf16 v12, v82, v6, v12
  v_dot2_f32_bf16 v12, v83, v7, v12
  buffer_load_dwordx4 v[80:83], v1, s[44:47], s56 offen offset:0 nt
  v_add_f32_dpp v10, v10, v10 row_ror:8 row_mask:0xf bank_mask:0x3
  s_nop 0
  s_nop 0
  v_add_f32_dpp v10, v11, v11 row_ror:8 row_mask:0xf bank_mask:0xc
  v_dot2_f32_bf16 v28, v208, v4, 0
  v_dot2_f32_bf16 v28, v209, v5, v28
  v_dot2_f32_bf16 v28, v210, v6, v28
  v_dot2_f32_bf16 v28, v211, v7, v28
  v_add_f32_dpp v26, v26, v26 row_ror:8 row_mask:0xf bank_mask:0x3
  s_nop 0
  s_nop 0
  v_add_f32_dpp v26, v27, v27 row_ror:8 row_mask:0xf bank_mask:0xc
  ds_read_b128 v[160:163], v57 offset:8192
  ds_read_b128 v[164:167], v57 offset:9216
  s_waitcnt vmcnt(8)
  s_cmp_eq_u32 s68, 0
  s_cbranch_scc1 L_pw_28
  s_waitcnt vmcnt(7)
  s_cmp_eq_u32 s68, 1
  s_cbranch_scc1 L_pw_28
  s_waitcnt vmcnt(6)
  s_cmp_eq_u32 s68, 2
  s_cbranch_scc1 L_pw_28
  s_nop 0
  s_waitcnt vmcnt(5)
  s_cmp_eq_u32 s68, 3
  s_cbranch_scc1 L_pw_28
  s_waitcnt vmcnt(4)
L_pw_28:
  v_dot2_f32_bf16 v13, v84, v4, 0
  v_dot2_f32_bf16 v13, v85, v5, v13
  v_dot2_f32_bf16 v13, v86, v6, v13
  v_dot2_f32_bf16 v13, v87, v7, v13
  buffer_load_dwordx4 v[84:87], v1, s[44:47], s56 offen offset:1024 nt
  v_add_f32_dpp v8, v8, v8 row_shl:4 row_mask:0xf bank_mask:0x5
  s_nop 0
  s_nop 0
  v_add_f32_dpp v8, v10, v10 row_shr:4 row_mask:0xf bank_mask:0xa
  v_dot2_f32_bf16 v29, v212, v4, 0
  v_dot2_f32_bf16 v29, v213, v5, v29
  v_dot2_f32_bf16 v29, v214, v6, v29
  v_dot2_f32_bf16 v29, v215, v7, v29
  v_add_f32_dpp v24, v24, v24 row_shl:4 row_mask:0xf bank_mask:0x5
  s_nop 0
  s_nop 0
  v_add_f32_dpp v24, v26, v26 row_shr:4 row_mask:0xf bank_mask:0xa
  ds_read_b128 v[168:171], v57 offset:10240
  ds_read_b128 v[172:175], v57 offset:11264
  s_waitcnt vmcnt(8)
  s_cmp_eq_u32 s68, 0
  s_cbranch_scc1 L_pw_29
  s_waitcnt vmcnt(7)
  s_cmp_eq_u32 s68, 1
  s_cbranch_scc1 L_pw_29
  s_waitcnt vmcnt(6)
  s_cmp_eq_u32 s68, 2
  s_cbranch_scc1 L_pw_29
  s_nop 0
  s_waitcnt vmcnt(5)
  s_cmp_eq_u32 s68, 3
  s_cbranch_scc1 L_pw_29
  s_waitcnt vmcnt(4)
L_pw_29:
  v_dot2_f32_bf16 v14, v88, v4, 0
  v_dot2_f32_bf16 v14, v89, v5, v14
  v_dot2_f32_bf16 v14, v90, v6, v14
  v_dot2_f32_bf16 v14, v91, v7, v14
  buffer_load_dwordx4 v[88:91], v1, s[44:47], s56 offen offset:2048 nt
  v_add_f32_dpp v12, v12, v12 row_ror:8 row_mask:0xf bank_mask:0x3
  s_nop 0
  s_nop 0
  v_add_f32_dpp v12, v13, v13 row_ror:8 row_mask:0xf bank_mask:0xc
  v_dot2_f32_bf16 v30, v216, v4, 0
  v_dot2_f32_bf16 v30, v217, v5, v30
  v_dot2_f32_bf16 v30, v218, v6, v30
  v_dot2_f32_bf16 v30, v219, v7, v30
  v_add_f32_dpp v28, v28, v28 row_ror:8 row_mask:0xf bank_mask:0x3
  s_nop 0
  s_nop 0
  v_add_f32_dpp v28, v29, v29 row_ror:8 row_mask:0xf bank_mask:0xc
  ds_read_b128 v[176:179], v57 offset:12288
  ds_read_b128 v[180:183], v57 offset:13312
  s_waitcnt vmcnt(8)
  s_cmp_eq_u32 s68, 0
  s_cbranch_scc1 L_pw_30
  s_waitcnt vmcnt(7)
  s_cmp_eq_u32 s68, 1
  s_cbranch_scc1 L_pw_30
  s_waitcnt vmcnt(6)
  s_cmp_eq_u32 s68, 2
  s_cbranch_scc1 L_pw_30
  s_nop 0
  s_waitcnt vmcnt(5)
  s_cmp_eq_u32 s68, 3
  s_cbranch_scc1 L_pw_30
  s_waitcnt vmcnt(4)
L_pw_30:
  v_dot2_f32_bf16 v15, v92, v4, 0
  v_dot2_f32_bf16 v15, v93, v5, v15
  v_dot2_f32_bf16 v15, v94, v6, v15
  v_dot2_f32_bf16 v15, v95, v7, v15
  buffer_load_dwordx4 v[92:95], v1, s[44:47], s56 offen offset:3072 nt
  s_add_u32 s56, s56, 16384
  v_dot2_f32_bf16 v31, v220, v4, 0
  v_dot2_f32_bf16 v31, v221, v5, v31
  v_dot2_f32_bf16 v31, v222, v6, v31
  v_dot2_f32_bf16 v31, v223, v7, v31
  ds_read_b128 v[184:187], v57 offset:14336
  ds_read_b128 v[188:191], v57 offset:15360
  s_waitcnt vmcnt(8)
  s_cmp_eq_u32 s68, 0
  s_cbranch_scc1 L_pw_31
  s_waitcnt vmcnt(7)
  s_cmp_eq_u32 s68, 1
  s_cbranch_scc1 L_pw_31
  s_waitcnt vmcnt(6)
  s_cmp_eq_u32 s68, 2
  s_cbranch_scc1 L_pw_31
  s_nop 0
  s_waitcnt vmcnt(5)
  s_cmp_eq_u32 s68, 3
  s_cbranch_scc1 L_pw_31
  s_waitcnt vmcnt(4)
L_pw_31:
  v_dot2_f32_bf16 v16, v96, v4, 0
  v_dot2_f32_bf16 v16, v97, v5, v16
  v_dot2_f32_bf16 v16, v98, v6, v16
  v_dot2_f32_bf16 v16, v99, v7, v16
  buffer_load_dwordx4 v[96:99], v1, s[44:47], s56 offen offset:0 nt
  v_add_f32_dpp v14, v14, v14 row_ror:8 row_mask:0xf bank_mask:0x3
  s_nop 0
  s_nop 0
  v_add_f32_dpp v14, v15, v15 row_ror:8 row_mask:0xf bank_mask:0xc
  v_dot2_f32_bf16 v32, v224, v4, 0
  v_dot2_f32_bf16 v32, v225, v5, v32
  v_dot2_f32_bf16 v32, v226, v6, v32
  v_dot2_f32_bf16 v32, v227, v7, v32
  v_add_f32_dpp v30, v30, v30 row_ror:8 row_mask:0xf bank_mask:0x3
  s_nop 1
  v_add_f32_dpp v30, v31, v31 row_ror:8 row_mask:0xf bank_mask:0xc
  s_waitcnt vmcnt(8)
  s_cmp_eq_u32 s68, 0
  s_cbranch_scc1 L_pw_32
  s_waitcnt vmcnt(7)
  s_cmp_eq_u32 s68, 1
  s_cbranch_scc1 L_pw_32
  s_waitcnt vmcnt(6)
  s_cmp_eq_u32 s68, 2
  s_cbranch_scc1 L_pw_32
  s_waitcnt vmcnt(5)
  s_cmp_eq_u32 s68, 3
  s_cbranch_scc1 L_pw_32
  s_waitcnt vmcnt(4)
L_pw_32:
  v_dot2_f32_bf16 v17, v100, v4, 0
  v_dot2_f32_bf16 v17, v101, v5, v17
  v_dot2_f32_bf16 v17, v102, v6, v17
  v_dot2_f32_bf16 v17, v103, v7, v17
  buffer_load_dwordx4 v[100:103], v1, s[44:47], s56 offen offset:1024 nt
  v_add_f32_dpp v12, v12, v12 row_shl:4 row_mask:0xf bank_mask:0x5
  s_nop 0
  s_nop 0
  v_add_f32_dpp v12, v14, v14 row_shr:4 row_mask:0xf bank_mask:0xa
  v_dot2_f32_bf16 v33, v228, v4, 0
  v_dot2_f32_bf16 v33, v229, v5, v33
  v_dot2_f32_bf16 v33, v230, v6, v33
  v_dot2_f32_bf16 v33, v231, v7, v33
  v_add_f32_dpp v28, v28, v28 row_shl:4 row_mask:0xf bank_mask:0x5
  s_nop 1
  v_add_f32_dpp v28, v30, v30 row_shr:4 row_mask:0xf bank_mask:0xa
  s_waitcnt vmcnt(8)
  s_cmp_eq_u32 s68, 0
  s_cbranch_scc1 L_pw_33
  s_waitcnt vmcnt(7)
  s_cmp_eq_u32 s68, 1
  s_cbranch_scc1 L_pw_33
  s_waitcnt vmcnt(6)
  s_cmp_eq_u32 s68, 2
  s_cbranch_scc1 L_pw_33
  s_waitcnt vmcnt(5)
  s_cmp_eq_u32 s68, 3
  s_cbranch_scc1 L_pw_33
  s_waitcnt vmcnt(4)
L_pw_33:
  v_dot2_f32_bf16 v18, v104, v4, 0
  v_dot2_f32_bf16 v18, v105, v5, v18
  v_dot2_f32_bf16 v18, v106, v6, v18
  v_dot2_f32_bf16 v18, v107, v7, v18
  buffer_load_dwordx4 v[104:107], v1, s[44:47], s56 offen offset:2048 nt
  v_add_f32_dpp v16, v16, v16 row_ror:8 row_mask:0xf bank_mask:0x3
  s_nop 0
  s_nop 0
  v_add_f32_dpp v16, v17, v17 row_ror:8 row_mask:0xf bank_mask:0xc
  v_dot2_f32_bf16 v34, v232, v4, 0
  v_dot2_f32_bf16 v34, v233, v5, v34
  v_dot2_f32_bf16 v34, v234, v6, v34
  v_dot2_f32_bf16 v34, v235, v7, v34
  v_add_f32_dpp v32, v32, v32 row_ror:8 row_mask:0xf bank_mask:0x3
  s_nop 1
  v_add_f32_dpp v32, v33, v33 row_ror:8 row_mask:0xf bank_mask:0xc
  s_waitcnt vmcnt(8)
  s_cmp_eq_u32 s68, 0
  s_cbranch_scc1 L_pw_34
  s_waitcnt vmcnt(7)
  s_cmp_eq_u32 s68, 1
  s_cbranch_scc1 L_pw_34
  s_waitcnt vmcnt(6)
  s_cmp_eq_u32 s68, 2
  s_cbranch_scc1 L_pw_34
  s_waitcnt vmcnt(5)
  s_cmp_eq_u32 s68, 3
  s_cbranch_scc1 L_pw_34
  s_waitcnt vmcnt(4)
L_pw_34:
  v_dot2_f32_bf16 v19, v108, v4, 0
  v_dot2_f32_bf16 v19, v109, v5, v19
  v_dot2_f32_bf16 v19, v110, v6, v19
  v_dot2_f32_bf16 v19, v111, v7, v19
  buffer_load_dwordx4 v[108:111], v1, s[44:47], s56 offen offset:3072 nt
  s_add_u32 s56, s56, 16384
  v_dot2_f32_bf16 v35, v236, v4, 0
  v_dot2_f32_bf16 v35, v237, v5, v35
  v_dot2_f32_bf16 v35, v238, v6, v35
  v_dot2_f32_bf16 v35, v239, v7, v35
  s_memrealtime s[72:73]
  ds_read_b32 v52, v60 offset:16
  s_waitcnt vmcnt(8)
  s_cmp_eq_u32 s68, 0
  s_cbranch_scc1 L_pw_35
  s_waitcnt vmcnt(7)
  s_cmp_eq_u32 s68, 1
  s_cbranch_scc1 L_pw_35
  s_waitcnt vmcnt(6)
  s_cmp_eq_u32 s68, 2
  s_cbranch_scc1 L_pw_35
  s_nop 0
  s_waitcnt vmcnt(5)
  s_cmp_eq_u32 s68, 3
  s_cbranch_scc1 L_pw_35
  s_waitcnt vmcnt(4)
L_pw_35:
  v_dot2_f32_bf16 v20, v112, v4, 0
  v_dot2_f32_bf16 v20, v113, v5, v20
  v_dot2_f32_bf16 v20, v114, v6, v20
  v_dot2_f32_bf16 v20, v115, v7, v20
  buffer_load_dwordx4 v[112:115], v1, s[44:47], s56 offen offset:0 nt
  v_add_f32_dpp v18, v18, v18 row_ror:8 row_mask:0xf bank_mask:0x3
  s_nop 0
  s_nop 0
  v_add_f32_dpp v18, v19, v19 row_ror:8 row_mask:0xf bank_mask:0xc
  v_dot2_f32_bf16 v36, v240, v4, 0
  v_dot2_f32_bf16 v36, v241, v5, v36
  v_dot2_f32_bf16 v36, v242, v6, v36
  v_dot2_f32_bf16 v36, v243, v7, v36
  v_add_f32_dpp v34, v34, v34 row_ror:8 row_mask:0xf bank_mask:0x3
  s_nop 1
  v_add_f32_dpp v34, v35, v35 row_ror:8 row_mask:0xf bank_mask:0xc
  s_waitcnt vmcnt(8)
  s_cmp_eq_u32 s68, 0
  s_cbranch_scc1 L_pw_36
  s_waitcnt vmcnt(7)
  s_cmp_eq_u32 s68, 1
  s_cbranch_scc1 L_pw_36
  s_waitcnt vmcnt(6)
  s_cmp_eq_u32 s68, 2
  s_cbranch_scc1 L_pw_36
  s_waitcnt vmcnt(5)
  s_cmp_eq_u32 s68, 3
  s_cbranch_scc1 L_pw_36
  s_waitcnt vmcnt(4)
L_pw_36:
  v_dot2_f32_bf16 v21, v116, v4, 0
  v_dot2_f32_bf16 v21, v117, v5, v21
  v_dot2_f32_bf16 v21, v118, v6, v21
  v_dot2_f32_bf16 v21, v119, v7, v21
  buffer_load_dwordx4 v[116:119], v1, s[44:47], s56 offen offset:1024 nt
  v_add_f32_dpp v16, v16, v16 row_shl:4 row_mask:0xf bank_mask:0x5
  s_nop 0
  s_nop 0
  v_add_f32_dpp v16, v18, v18 row_shr:4 row_mask:0xf bank_mask:0xa
  v_dot2_f32_bf16 v37, v244, v4, 0
  v_dot2_f32_bf16 v37, v245, v5, v37
  v_dot2_f32_bf16 v37, v246, v6, v37
  v_dot2_f32_bf16 v37, v247, v7, v37
  v_add_f32_dpp v32, v32, v32 row_shl:4 row_mask:0xf bank_mask:0x5
  s_nop 1
  v_add_f32_dpp v32, v34, v34 row_shr:4 row_mask:0xf bank_mask:0xa
  s_waitcnt vmcnt(8)
  s_cmp_eq_u32 s68, 0
  s_cbranch_scc1 L_pw_37
  s_waitcnt vmcnt(7)
  s_cmp_eq_u32 s68, 1
  s_cbranch_scc1 L_pw_37
  s_waitcnt vmcnt(6)
  s_cmp_eq_u32 s68, 2
  s_cbranch_scc1 L_pw_37
  s_waitcnt vmcnt(5)
  s_cmp_eq_u32 s68, 3
  s_cbranch_scc1 L_pw_37
  s_waitcnt vmcnt(4)
L_pw_37:
  v_dot2_f32_bf16 v22, v120, v4, 0
  v_dot2_f32_bf16 v22, v121, v5, v22
  v_dot2_f32_bf16 v22, v122, v6, v22
  v_dot2_f32_bf16 v22, v123, v7, v22
  buffer_load_dwordx4 v[120:123], v1, s[44:47], s56 offen offset:2048 nt
  v_add_f32_dpp v20, v20, v20 row_ror:8 row_mask:0xf bank_mask:0x3
  s_nop 0
  s_nop 0
  v_add_f32_dpp v20, v21, v21 row_ror:8 row_mask:0xf bank_mask:0xc
  v_dot2_f32_bf16 v38, v248, v4, 0
  v_dot2_f32_bf16 v38, v249, v5, v38
  v_dot2_f32_bf16 v38, v250, v6, v38
  v_dot2_f32_bf16 v38, v251, v7, v38
  v_add_f32_dpp v36, v36, v36 row_ror:8 row_mask:0xf bank_mask:0x3
  s_nop 0
  s_nop 0
  v_add_f32_dpp v36, v37, v37 row_ror:8 row_mask:0xf bank_mask:0xc
  s_waitcnt lgkmcnt(0)
  v_readfirstlane_b32 s73, v52
  s_sub_u32 s72, s72, 1488
  s_sub_u32 s71, s72, s73
  s_mov_b32 s68, 4
  s_cmp_gt_i32 s71, -110
  s_cselect_b32 s68, 3, s68
  s_cmp_gt_i32 s71, -20
  s_cselect_b32 s68, 2, s68
  s_cmp_gt_i32 s71, 50
  s_cselect_b32 s68, 1, s68
  s_cmp_gt_i32 s71, 90
  s_cselect_b32 s68, 0, s68
  s_cmp_lg_u32 s3, 0
  s_cbranch_scc1 L_ct_38
  s_cmp_eq_u32 s48, 0
  s_cbranch_scc1 L_cm_39
  v_mov_b32 v54, s72
  v_mov_b32 v55, s67
  s_add_u32 s50, s48, s49
  s_mov_b64 exec, 1
  buffer_store_dwordx2 v[54:55], v60, s[52:55], s50 offen sc1
  s_mov_b64 exec, -1
L_cm_39:
  s_add_u32 s49, s49, 256
  v_cmp_ne_u32 vcc, s67, v51
  v_subrev_u32 v56, s70, v50
  s_nop 0
  s_nop 0
  v_add_u32_dpp v56, v56, v56 quad_perm:[1,0,3,2] row_mask:0xf bank_mask:0xf
  s_nop 0
  s_nop 0
  v_add_u32_dpp v56, v56, v56 quad_perm:[2,3,0,1] row_mask:0xf bank_mask:0xf
  s_nop 0
  s_nop 0
  v_add_u32_dpp v56, v56, v56 row_half_mirror row_mask:0xf bank_mask:0xf
  v_ashrrev_i32 v56, 3, v56
  s_add_u32 s73, s70, 0
  v_add_u32_e64 v56, s73, v56
  s_cbranch_vccnz L_ct_38
  ds_write_b32 v60, v56 offset:16
L_ct_38:
  s_waitcnt vmcnt(8)
  s_cmp_eq_u32 s68, 0
  s_cbranch_scc1 L_pw_40
  s_waitcnt vmcnt(7)
  s_cmp_eq_u32 s68, 1
  s_cbranch_scc1 L_pw_40
  s_waitcnt vmcnt(6)
  s_cmp_eq_u32 s68, 2
  s_cbranch_scc1 L_pw_40
  s_waitcnt vmcnt(5)
  s_cmp_eq_u32 s68, 3
  s_cbranch_scc1 L_pw_40
  s_waitcnt vmcnt(4)
L_pw_40:
  v_dot2_f32_bf16 v23, v124, v4, 0
  v_dot2_f32_bf16 v23, v125, v5, v23
  v_dot2_f32_bf16 v23, v126, v6, v23
  v_dot2_f32_bf16 v23, v127, v7, v23
  buffer_load_dwordx4 v[124:127], v1, s[44:47], s56 offen offset:3072 nt
  s_add_u32 s56, s56, 16384
  v_dot2_f32_bf16 v39, v252, v4, 0
  v_dot2_f32_bf16 v39, v253, v5, v39
  v_dot2_f32_bf16 v39, v254, v6, v39
  v_dot2_f32_bf16 v39, v255, v7, v39
  v_add_f32_dpp v22, v22, v22 row_ror:8 row_mask:0xf bank_mask:0x3
  s_nop 0
  s_nop 0
  v_add_f32_dpp v22, v23, v23 row_ror:8 row_mask:0xf bank_mask:0xc
  v_add_f32_dpp v20, v20, v20 row_shl:4 row_mask:0xf bank_mask:0x5
  s_nop 0
  s_nop 0
  v_add_f32_dpp v20, v22, v22 row_shr:4 row_mask:0xf bank_mask:0xa
  v_add_f32_dpp v8, v8, v8 quad_perm:[2,3,0,1] row_mask:0xf bank_mask:0xf
  v_add_f32_dpp v12, v12, v12 quad_perm:[2,3,0,1] row_mask:0xf bank_mask:0xf
  v_add_f32_dpp v16, v16, v16 quad_perm:[2,3,0,1] row_mask:0xf bank_mask:0xf
  v_add_f32_dpp v20, v20, v20 quad_perm:[2,3,0,1] row_mask:0xf bank_mask:0xf
  v_cndmask_b32 v8, v8, v12, s[62:63]
  v_cndmask_b32 v16, v16, v20, s[62:63]
  s_nop 0
  s_nop 0
  v_add_f32_dpp v8, v8, v8 quad_perm:[1,0,3,2] row_mask:0xf bank_mask:0xf
  v_add_f32_dpp v16, v16, v16 quad_perm:[1,0,3,2] row_mask:0xf bank_mask:0xf
  v_cndmask_b32 v41, v8, v16, s[60:61]
  v_cvt_pk_bf16_f32 v42, v41, v41
  v_lshlrev_b32 v41, 16, v42
  v_mul_f32 v41, s66, v41
  v_cvt_pk_bf16_f32 v42, v41, v41
  v_lshlrev_b32 v41, 16, v42
  v_max_f32 v40, v40, v41
  ds_write_b32 v2, v41 offset:1024
  v_add_f32_dpp v38, v38, v38 row_ror:8 row_mask:0xf bank_mask:0x3
  s_nop 0
  s_nop 0
  v_add_f32_dpp v38, v39, v39 row_ror:8 row_mask:0xf bank_mask:0xc
  v_add_f32_dpp v36, v36, v36 row_shl:4 row_mask:0xf bank_mask:0x5
  s_nop 0
  s_nop 0
  v_add_f32_dpp v36, v38, v38 row_shr:4 row_mask:0xf bank_mask:0xa
  v_add_f32_dpp v24, v24, v24 quad_perm:[2,3,0,1] row_mask:0xf bank_mask:0xf
  v_add_f32_dpp v28, v28, v28 quad_perm:[2,3,0,1] row_mask:0xf bank_mask:0xf
  v_add_f32_dpp v32, v32, v32 quad_perm:[2,3,0,1] row_mask:0xf bank_mask:0xf
  v_add_f32_dpp v36, v36, v36 quad_perm:[2,3,0,1] row_mask:0xf bank_mask:0xf
  v_cndmask_b32 v24, v24, v28, s[62:63]
  v_cndmask_b32 v32, v32, v36, s[62:63]
  s_nop 0
  s_nop 0
  v_add_f32_dpp v24, v24, v24 quad_perm:[1,0,3,2] row_mask:0xf bank_mask:0xf
  v_add_f32_dpp v32, v32, v32 quad_perm:[1,0,3,2] row_mask:0xf bank_mask:0xf
  v_cndmask_b32 v43, v24, v32, s[60:61]
  v_cvt_pk_bf16_f32 v44, v43, v43
  v_lshlrev_b32 v43, 16, v44
  v_mul_f32 v43, s66, v43
  v_cvt_pk_bf16_f32 v44, v43, v43
  v_lshlrev_b32 v43, 16, v44
  v_max_f32 v40, v40, v43
  ds_write_b32 v2, v43 offset:256
  s_waitcnt lgkmcnt(0)
  s_cmp_lg_u32 s3, 0
  s_cbranch_scc1 L_ml_41
  buffer_load_dwordx2 v[50:51], v53, s[52:55], s49 offen
L_ml_41:
  s_waitcnt vmcnt(8)
  s_cmp_eq_u32 s68, 0
  s_cbranch_scc1 L_pw_42
  s_waitcnt vmcnt(7)
  s_cmp_eq_u32 s68, 1
  s_cbranch_scc1 L_pw_42
  s_waitcnt vmcnt(6)
  s_cmp_eq_u32 s68, 2
  s_cbranch_scc1 L_pw_42
  s_waitcnt vmcnt(5)
  s_cmp_eq_u32 s68, 3
  s_cbranch_scc1 L_pw_42
  s_waitcnt vmcnt(4)
L_pw_42:
  v_dot2_f32_bf16 v8, v64, v4, 0
  v_dot2_f32_bf16 v8, v65, v5, v8
  v_dot2_f32_bf16 v8, v66, v6, v8
  v_dot2_f32_bf16 v8, v67, v7, v8
  buffer_load_dwordx4 v[64:67], v1, s[44:47], s56 offen offset:0 nt
  v_dot2_f32_bf16 v24, v128, v4, 0
  v_dot2_f32_bf16 v24, v129, v5, v24
  v_dot2_f32_bf16 v24, v130, v6, v24
  v_dot2_f32_bf16 v24, v131, v7, v24
  s_waitcnt vmcnt(8)
  s_cmp_eq_u32 s68, 0
  s_cbranch_scc1 L_pw_43
  s_waitcnt vmcnt(7)
  s_cmp_eq_u32 s68, 1
  s_cbranch_scc1 L_pw_43
  s_waitcnt vmcnt(6)
  s_cmp_eq_u32 s68, 2
  s_cbranch_scc1 L_pw_43
  s_nop 0
  s_waitcnt vmcnt(5)
  s_cmp_eq_u32 s68, 3
  s_cbranch_scc1 L_pw_43
  s_waitcnt vmcnt(4)
L_pw_43:
  v_dot2_f32_bf16 v9, v68, v4, 0
  v_dot2_f32_bf16 v9, v69, v5, v9
  v_dot2_f32_bf16 v9, v70, v6, v9
  v_dot2_f32_bf16 v9, v71, v7, v9
  buffer_load_dwordx4 v[68:71], v1, s[44:47], s56 offen offset:1024 nt
  v_dot2_f32_bf16 v25, v132, v4, 0
  v_dot2_f32_bf16 v25, v133, v5, v25
  v_dot2_f32_bf16 v25, v134, v6, v25
  v_dot2_f32_bf16 v25, v135, v7, v25
  s_waitcnt vmcnt(8)
  s_cmp_eq_u32 s68, 0
  s_cbranch_scc1 L_pw_44
  s_waitcnt vmcnt(7)
  s_cmp_eq_u32 s68, 1
  s_cbranch_scc1 L_pw_44
  s_waitcnt vmcnt(6)
  s_cmp_eq_u32 s68, 2
  s_cbranch_scc1 L_pw_44
  s_nop 0
  s_waitcnt vmcnt(5)
  s_cmp_eq_u32 s68, 3
  s_cbranch_scc1 L_pw_44
  s_waitcnt vmcnt(4)
L_pw_44:
  v_dot2_f32_bf16 v10, v72, v4, 0
  v_dot2_f32_bf16 v10, v73, v5, v10
  v_dot2_f32_bf16 v10, v74, v6, v10
  v_dot2_f32_bf16 v10, v75, v7, v10
  buffer_load_dwordx4 v[72:75], v1, s[44:47], s56 offen offset:2048 nt
  v_add_f32_dpp v8, v8, v8 row_ror:8 row_mask:0xf bank_mask:0x3
  s_nop 0
  s_nop 0
  v_add_f32_dpp v8, v9, v9 row_ror:8 row_mask:0xf bank_mask:0xc
  v_dot2_f32_bf16 v26, v136, v4, 0
  v_dot2_f32_bf16 v26, v137, v5, v26
  v_dot2_f32_bf16 v26, v138, v6, v26
  v_dot2_f32_bf16 v26, v139, v7, v26
  v_add_f32_dpp v24, v24, v24 row_ror:8 row_mask:0xf bank_mask:0x3
  s_nop 1
  v_add_f32_dpp v24, v25, v25 row_ror:8 row_mask:0xf bank_mask:0xc
  s_waitcnt vmcnt(8)
  s_cmp_eq_u32 s68, 0
  s_cbranch_scc1 L_pw_45
  s_waitcnt vmcnt(7)
  s_cmp_eq_u32 s68, 1
  s_cbranch_scc1 L_pw_45
  s_waitcnt vmcnt(6)
  s_cmp_eq_u32 s68, 2
  s_cbranch_scc1 L_pw_45
  s_waitcnt vmcnt(5)
  s_cmp_eq_u32 s68, 3
  s_cbranch_scc1 L_pw_45
  s_waitcnt vmcnt(4)
L_pw_45:
  v_dot2_f32_bf16 v11, v76, v4, 0
  v_dot2_f32_bf16 v11, v77, v5, v11
  v_dot2_f32_bf16 v11, v78, v6, v11
  v_dot2_f32_bf16 v11, v79, v7, v11
  buffer_load_dwordx4 v[76:79], v1, s[44:47], s56 offen offset:3072 nt
  s_add_u32 s56, s56, 16384
  v_dot2_f32_bf16 v27, v140, v4, 0
  v_dot2_f32_bf16 v27, v141, v5, v27
  v_dot2_f32_bf16 v27, v142, v6, v27
  v_dot2_f32_bf16 v27, v143, v7, v27
  s_waitcnt vmcnt(8)
  s_cmp_eq_u32 s68, 0
  s_cbranch_scc1 L_pw_46
  s_waitcnt vmcnt(7)
  s_cmp_eq_u32 s68, 1
  s_cbranch_scc1 L_pw_46
  s_waitcnt vmcnt(6)
  s_cmp_eq_u32 s68, 2
  s_cbranch_scc1 L_pw_46
  s_nop 0
  s_waitcnt vmcnt(5)
  s_cmp_eq_u32 s68, 3
  s_cbranch_scc1 L_pw_46
  s_waitcnt vmcnt(4)
L_pw_46:
  v_dot2_f32_bf16 v12, v80, v4, 0
  v_dot2_f32_bf16 v12, v81, v5, v12
  v_dot2_f32_bf16 v12, v82, v6, v12
  v_dot2_f32_bf16 v12, v83, v7, v12
  buffer_load_dwordx4 v[80:83], v1, s[44:47], s56 offen offset:0 nt
  v_add_f32_dpp v10, v10, v10 row_ror:8 row_mask:0xf bank_mask:0x3
  s_nop 0
  s_nop 0
  v_add_f32_dpp v10, v11, v11 row_ror:8 row_mask:0xf bank_mask:0xc
  v_dot2_f32_bf16 v28, v144, v4, 0
  v_dot2_f32_bf16 v28, v145, v5, v28
  v_dot2_f32_bf16 v28, v146, v6, v28
  v_dot2_f32_bf16 v28, v147, v7, v28
  v_add_f32_dpp v26, v26, v26 row_ror:8 row_mask:0xf bank_mask:0x3
  s_nop 1
  v_add_f32_dpp v26, v27, v27 row_ror:8 row_mask:0xf bank_mask:0xc
  s_waitcnt vmcnt(8)
  s_cmp_eq_u32 s68, 0
  s_cbranch_scc1 L_pw_47
  s_waitcnt vmcnt(7)
  s_cmp_eq_u32 s68, 1
  s_cbranch_scc1 L_pw_47
  s_waitcnt vmcnt(6)
  s_cmp_eq_u32 s68, 2
  s_cbranch_scc1 L_pw_47
  s_waitcnt vmcnt(5)
  s_cmp_eq_u32 s68, 3
  s_cbranch_scc1 L_pw_47
  s_waitcnt vmcnt(4)
L_pw_47:
  v_dot2_f32_bf16 v13, v84, v4, 0
  v_dot2_f32_bf16 v13, v85, v5, v13
  v_dot2_f32_bf16 v13, v86, v6, v13
  v_dot2_f32_bf16 v13, v87, v7, v13
  buffer_load_dwordx4 v[84:87], v1, s[44:47], s56 offen offset:1024 nt
  v_add_f32_dpp v8, v8, v8 row_shl:4 row_mask:0xf bank_mask:0x5
  s_nop 0
  s_nop 0
  v_add_f32_dpp v8, v10, v10 row_shr:4 row_mask:0xf bank_mask:0xa
  v_dot2_f32_bf16 v29, v148, v4, 0
  v_dot2_f32_bf16 v29, v149, v5, v29
  v_dot2_f32_bf16 v29, v150, v6, v29
  v_dot2_f32_bf16 v29, v151, v7, v29
  v_add_f32_dpp v24, v24, v24 row_shl:4 row_mask:0xf bank_mask:0x5
  s_nop 1
  v_add_f32_dpp v24, v26, v26 row_shr:4 row_mask:0xf bank_mask:0xa
  s_waitcnt vmcnt(8)
  s_cmp_eq_u32 s68, 0
  s_cbranch_scc1 L_pw_48
  s_waitcnt vmcnt(7)
  s_cmp_eq_u32 s68, 1
  s_cbranch_scc1 L_pw_48
  s_waitcnt vmcnt(6)
  s_cmp_eq_u32 s68, 2
  s_cbranch_scc1 L_pw_48
  s_waitcnt vmcnt(5)
  s_cmp_eq_u32 s68, 3
  s_cbranch_scc1 L_pw_48
  s_waitcnt vmcnt(4)
L_pw_48:
  v_dot2_f32_bf16 v14, v88, v4, 0
  v_dot2_f32_bf16 v14, v89, v5, v14
  v_dot2_f32_bf16 v14, v90, v6, v14
  v_dot2_f32_bf16 v14, v91, v7, v14
  buffer_load_dwordx4 v[88:91], v1, s[44:47], s56 offen offset:2048 nt
  v_add_f32_dpp v12, v12, v12 row_ror:8 row_mask:0xf bank_mask:0x3
  s_nop 0
  s_nop 0
  v_add_f32_dpp v12, v13, v13 row_ror:8 row_mask:0xf bank_mask:0xc
  v_dot2_f32_bf16 v30, v152, v4, 0
  v_dot2_f32_bf16 v30, v153, v5, v30
  v_dot2_f32_bf16 v30, v154, v6, v30
  v_dot2_f32_bf16 v30, v155, v7, v30
  v_add_f32_dpp v28, v28, v28 row_ror:8 row_mask:0xf bank_mask:0x3
  s_nop 1
  v_add_f32_dpp v28, v29, v29 row_ror:8 row_mask:0xf bank_mask:0xc
  s_waitcnt vmcnt(8)
  s_cmp_eq_u32 s68, 0
  s_cbranch_scc1 L_pw_49
  s_waitcnt vmcnt(7)
  s_cmp_eq_u32 s68, 1
  s_cbranch_scc1 L_pw_49
  s_waitcnt vmcnt(6)
  s_cmp_eq_u32 s68, 2
  s_cbranch_scc1 L_pw_49
  s_waitcnt vmcnt(5)
  s_cmp_eq_u32 s68, 3
  s_cbranch_scc1 L_pw_49
  s_waitcnt vmcnt(4)
L_pw_49:
  v_dot2_f32_bf16 v15, v92, v4, 0
  v_dot2_f32_bf16 v15, v93, v5, v15
  v_dot2_f32_bf16 v15, v94, v6, v15
  v_dot2_f32_bf16 v15, v95, v7, v15
  buffer_load_dwordx4 v[92:95], v1, s[44:47], s56 offen offset:3072 nt
  s_add_u32 s56, s56, 16384
  v_dot2_f32_bf16 v31, v156, v4, 0
  v_dot2_f32_bf16 v31, v157, v5, v31
  v_dot2_f32_bf16 v31, v158, v6, v31
  v_dot2_f32_bf16 v31, v159, v7, v31
  s_waitcnt vmcnt(8)
  s_cmp_eq_u32 s68, 0
  s_cbranch_scc1 L_pw_50
  s_waitcnt vmcnt(7)
  s_cmp_eq_u32 s68, 1
  s_cbranch_scc1 L_pw_50
  s_waitcnt vmcnt(6)
  s_cmp_eq_u32 s68, 2
  s_cbranch_scc1 L_pw_50
  s_nop 0
  s_waitcnt vmcnt(5)
  s_cmp_eq_u32 s68, 3
  s_cbranch_scc1 L_pw_50
  s_waitcnt vmcnt(4)
L_pw_50:
  v_dot2_f32_bf16 v16, v96, v4, 0
  v_dot2_f32_bf16 v16, v97, v5, v16
  v_dot2_f32_bf16 v16, v98, v6, v16
  v_dot2_f32_bf16 v16, v99, v7, v16
  buffer_load_dwordx4 v[96:99], v1, s[44:47], s56 offen offset:0 nt
  v_add_f32_dpp v14, v14, v14 row_ror:8 row_mask:0xf bank_mask:0x3
  s_nop 0
  s_nop 0
  v_add_f32_dpp v14, v15, v15 row_ror:8 row_mask:0xf bank_mask:0xc
  v_dot2_f32_bf16 v32, v160, v4, 0
  v_dot2_f32_bf16 v32, v161, v5, v32
  v_dot2_f32_bf16 v32, v162, v6, v32
  v_dot2_f32_bf16 v32, v163, v7, v32
  v_add_f32_dpp v30, v30, v30 row_ror:8 row_mask:0xf bank_mask:0x3
  s_nop 1
  v_add_f32_dpp v30, v31, v31 row_ror:8 row_mask:0xf bank_mask:0xc
  s_waitcnt vmcnt(8)
  s_cmp_eq_u32 s68, 0
  s_cbranch_scc1 L_pw_51
  s_waitcnt vmcnt(7)
  s_cmp_eq_u32 s68, 1
  s_cbranch_scc1 L_pw_51
  s_waitcnt vmcnt(6)
  s_cmp_eq_u32 s68, 2
  s_cbranch_scc1 L_pw_51
  s_waitcnt vmcnt(5)
  s_cmp_eq_u32 s68, 3
  s_cbranch_scc1 L_pw_51
  s_waitcnt vmcnt(4)
L_pw_51:
  v_dot2_f32_bf16 v17, v100, v4, 0
  v_dot2_f32_bf16 v17, v101, v5, v17
  v_dot2_f32_bf16 v17, v102, v6, v17
  v_dot2_f32_bf16 v17, v103, v7, v17
  buffer_load_dwordx4 v[100:103], v1, s[44:47], s56 offen offset:1024 nt
  v_add_f32_dpp v12, v12, v12 row_shl:4 row_mask:0xf bank_mask:0x5
  s_nop 0
  s_nop 0
  v_add_f32_dpp v12, v14, v14 row_shr:4 row_mask:0xf bank_mask:0xa
  v_dot2_f32_bf16 v33, v164, v4, 0
  v_dot2_f32_bf16 v33, v165, v5, v33
  v_dot2_f32_bf16 v33, v166, v6, v33
  v_dot2_f32_bf16 v33, v167, v7, v33
  v_add_f32_dpp v28, v28, v28 row_shl:4 row_mask:0xf bank_mask:0x5
  s_nop 1
  v_add_f32_dpp v28, v30, v30 row_shr:4 row_mask:0xf bank_mask:0xa
  s_waitcnt vmcnt(8)
  s_cmp_eq_u32 s68, 0
  s_cbranch_scc1 L_pw_52
  s_waitcnt vmcnt(7)
  s_cmp_eq_u32 s68, 1
  s_cbranch_scc1 L_pw_52
  s_waitcnt vmcnt(6)
  s_cmp_eq_u32 s68, 2
  s_cbranch_scc1 L_pw_52
  s_waitcnt vmcnt(5)
  s_cmp_eq_u32 s68, 3
  s_cbranch_scc1 L_pw_52
  s_waitcnt vmcnt(4)
L_pw_52:
  v_dot2_f32_bf16 v18, v104, v4, 0
  v_dot2_f32_bf16 v18, v105, v5, v18
  v_dot2_f32_bf16 v18, v106, v6, v18
  v_dot2_f32_bf16 v18, v107, v7, v18
  buffer_load_dwordx4 v[104:107], v1, s[44:47], s56 offen offset:2048 nt
  v_add_f32_dpp v16, v16, v16 row_ror:8 row_mask:0xf bank_mask:0x3
  s_nop 0
  s_nop 0
  v_add_f32_dpp v16, v17, v17 row_ror:8 row_mask:0xf bank_mask:0xc
  v_dot2_f32_bf16 v34, v168, v4, 0
  v_dot2_f32_bf16 v34, v169, v5, v34
  v_dot2_f32_bf16 v34, v170, v6, v34
  v_dot2_f32_bf16 v34, v171, v7, v34
  v_add_f32_dpp v32, v32, v32 row_ror:8 row_mask:0xf bank_mask:0x3
  s_nop 1
  v_add_f32_dpp v32, v33, v33 row_ror:8 row_mask:0xf bank_mask:0xc
  s_waitcnt vmcnt(8)
  s_cmp_eq_u32 s68, 0
  s_cbranch_scc1 L_pw_53
  s_waitcnt vmcnt(7)
  s_cmp_eq_u32 s68, 1
  s_cbranch_scc1 L_pw_53
  s_waitcnt vmcnt(6)
  s_cmp_eq_u32 s68, 2
  s_cbranch_scc1 L_pw_53
  s_waitcnt vmcnt(5)
  s_cmp_eq_u32 s68, 3
  s_cbranch_scc1 L_pw_53
  s_waitcnt vmcnt(4)
L_pw_53:
  v_dot2_f32_bf16 v19, v108, v4, 0
  v_dot2_f32_bf16 v19, v109, v5, v19
  v_dot2_f32_bf16 v19, v110, v6, v19
  v_dot2_f32_bf16 v19, v111, v7, v19
  buffer_load_dwordx4 v[108:111], v1, s[44:47], s56 offen offset:3072 nt
  s_add_u32 s56, s56, 16384
  v_dot2_f32_bf16 v35, v172, v4, 0
  v_dot2_f32_bf16 v35, v173, v5, v35
  v_dot2_f32_bf16 v35, v174, v6, v35
  v_dot2_f32_bf16 v35, v175, v7, v35
  s_memrealtime s[72:73]
  ds_read_b32 v52, v60 offset:16
  s_waitcnt vmcnt(8)
  s_cmp_eq_u32 s68, 0
  s_cbranch_scc1 L_pw_54
  s_waitcnt vmcnt(7)
  s_cmp_eq_u32 s68, 1
  s_cbranch_scc1 L_pw_54
  s_waitcnt vmcnt(6)
  s_cmp_eq_u32 s68, 2
  s_cbranch_scc1 L_pw_54
  s_nop 0
  s_waitcnt vmcnt(5)
  s_cmp_eq_u32 s68, 3
  s_cbranch_scc1 L_pw_54
  s_waitcnt vmcnt(4)
L_pw_54:
  v_dot2_f32_bf16 v20, v112, v4, 0
  v_dot2_f32_bf16 v20, v113, v5, v20
  v_dot2_f32_bf16 v20, v114, v6, v20
  v_dot2_f32_bf16 v20, v115, v7, v20
  buffer_load_dwordx4 v[112:115], v1, s[44:47], s56 offen offset:0 nt
  v_add_f32_dpp v18, v18, v18 row_ror:8 row_mask:0xf bank_mask:0x3
  s_nop 0
  s_nop 0
  v_add_f32_dpp v18, v19, v19 row_ror:8 row_mask:0xf bank_mask:0xc
  v_dot2_f32_bf16 v36, v176, v4, 0
  v_dot2_f32_bf16 v36, v177, v5, v36
  v_dot2_f32_bf16 v36, v178, v6, v36
  v_dot2_f32_bf16 v36, v179, v7, v36
  v_add_f32_dpp v34, v34, v34 row_ror:8 row_mask:0xf bank_mask:0x3
  s_nop 1
  v_add_f32_dpp v34, v35, v35 row_ror:8 row_mask:0xf bank_mask:0xc
  s_waitcnt vmcnt(8)
  s_cmp_eq_u32 s68, 0
  s_cbranch_scc1 L_pw_55
  s_waitcnt vmcnt(7)
  s_cmp_eq_u32 s68, 1
  s_cbranch_scc1 L_pw_55
  s_waitcnt vmcnt(6)
  s_cmp_eq_u32 s68, 2
  s_cbranch_scc1 L_pw_55
  s_waitcnt vmcnt(5)
  s_cmp_eq_u32 s68, 3
  s_cbranch_scc1 L_pw_55
  s_waitcnt vmcnt(4)
L_pw_55:
  v_dot2_f32_bf16 v21, v116, v4, 0
  v_dot2_f32_bf16 v21, v117, v5, v21
  v_dot2_f32_bf16 v21, v118, v6, v21
  v_dot2_f32_bf16 v21, v119, v7, v21
  buffer_load_dwordx4 v[116:119], v1, s[44:47], s56 offen offset:1024 nt
  v_add_f32_dpp v16, v16, v16 row_shl:4 row_mask:0xf bank_mask:0x5
  s_nop 0
  s_nop 0
  v_add_f32_dpp v16, v18, v18 row_shr:4 row_mask:0xf bank_mask:0xa
  v_dot2_f32_bf16 v37, v180, v4, 0
  v_dot2_f32_bf16 v37, v181, v5, v37
  v_dot2_f32_bf16 v37, v182, v6, v37
  v_dot2_f32_bf16 v37, v183, v7, v37
  v_add_f32_dpp v32, v32, v32 row_shl:4 row_mask:0xf bank_mask:0x5
  s_nop 1
  v_add_f32_dpp v32, v34, v34 row_shr:4 row_mask:0xf bank_mask:0xa
  s_waitcnt vmcnt(8)
  s_cmp_eq_u32 s68, 0
  s_cbranch_scc1 L_pw_56
  s_waitcnt vmcnt(7)
  s_cmp_eq_u32 s68, 1
  s_cbranch_scc1 L_pw_56
  s_waitcnt vmcnt(6)
  s_cmp_eq_u32 s68, 2
  s_cbranch_scc1 L_pw_56
  s_waitcnt vmcnt(5)
  s_cmp_eq_u32 s68, 3
  s_cbranch_scc1 L_pw_56
  s_waitcnt vmcnt(4)
L_pw_56:
  v_dot2_f32_bf16 v22, v120, v4, 0
  v_dot2_f32_bf16 v22, v121, v5, v22
  v_dot2_f32_bf16 v22, v122, v6, v22
  v_dot2_f32_bf16 v22, v123, v7, v22
  buffer_load_dwordx4 v[120:123], v1, s[44:47], s56 offen offset:2048 nt
  v_add_f32_dpp v20, v20, v20 row_ror:8 row_mask:0xf bank_mask:0x3
  s_nop 0
  s_nop 0
  v_add_f32_dpp v20, v21, v21 row_ror:8 row_mask:0xf bank_mask:0xc
  v_dot2_f32_bf16 v38, v184, v4, 0
  v_dot2_f32_bf16 v38, v185, v5, v38
  v_dot2_f32_bf16 v38, v186, v6, v38
  v_dot2_f32_bf16 v38, v187, v7, v38
  v_add_f32_dpp v36, v36, v36 row_ror:8 row_mask:0xf bank_mask:0x3
  s_nop 0
  s_nop 0
  v_add_f32_dpp v36, v37, v37 row_ror:8 row_mask:0xf bank_mask:0xc
  s_waitcnt lgkmcnt(0)
  v_readfirstlane_b32 s73, v52
  s_sub_u32 s72, s72, 1733
  s_sub_u32 s71, s72, s73
  s_mov_b32 s68, 4
  s_cmp_gt_i32 s71, -110
  s_cselect_b32 s68, 3, s68
  s_cmp_gt_i32 s71, -20
  s_cselect_b32 s68, 2, s68
  s_cmp_gt_i32 s71, 50
  s_cselect_b32 s68, 1, s68
  s_cmp_gt_i32 s71, 90
  s_cselect_b32 s68, 0, s68
  s_cmp_lg_u32 s3, 0
  s_cbranch_scc1 L_ct_57
  s_cmp_eq_u32 s48, 0
  s_cbranch_scc1 L_cm_58
  v_mov_b32 v54, s72
  v_mov_b32 v55, s67
  s_add_u32 s50, s48, s49
  s_mov_b64 exec, 1
  buffer_store_dwordx2 v[54:55], v60, s[52:55], s50 offen sc1
  s_mov_b64 exec, -1
L_cm_58:
  s_add_u32 s49, s49, 256
  v_cmp_ne_u32 vcc, s67, v51
  v_subrev_u32 v56, s70, v50
  s_nop 0
  s_nop 0
  v_add_u32_dpp v56, v56, v56 quad_perm:[1,0,3,2] row_mask:0xf bank_mask:0xf
  s_nop 0
  s_nop 0
  v_add_u32_dpp v56, v56, v56 quad_perm:[2,3,0,1] row_mask:0xf bank_mask:0xf
  s_nop 0
  s_nop 0
  v_add_u32_dpp v56, v56, v56 row_half_mirror row_mask:0xf bank_mask:0xf
  v_ashrrev_i32 v56, 3, v56
  s_add_u32 s73, s70, 0
  v_add_u32_e64 v56, s73, v56
  s_cbranch_vccnz L_ct_57
  ds_write_b32 v60, v56 offset:16
L_ct_57:
  s_waitcnt vmcnt(8)
  s_cmp_eq_u32 s68, 0
  s_cbranch_scc1 L_pw_59
  s_waitcnt vmcnt(7)
  s_cmp_eq_u32 s68, 1
  s_cbranch_scc1 L_pw_59
  s_waitcnt vmcnt(6)
  s_cmp_eq_u32 s68, 2
  s_cbranch_scc1 L_pw_59
  s_waitcnt vmcnt(5)
  s_cmp_eq_u32 s68, 3
  s_cbranch_scc1 L_pw_59
  s_waitcnt vmcnt(4)
L_pw_59:
  v_dot2_f32_bf16 v23, v124, v4, 0
  v_dot2_f32_bf16 v23, v125, v5, v23
  v_dot2_f32_bf16 v23, v126, v6, v23
  v_dot2_f32_bf16 v23, v127, v7, v23
  buffer_load_dwordx4 v[124:127], v1, s[44:47], s56 offen offset:3072 nt
  s_add_u32 s56, s56, 16384
  v_dot2_f32_bf16 v39, v188, v4, 0
  v_dot2_f32_bf16 v39, v189, v5, v39
  v_dot2_f32_bf16 v39, v190, v6, v39
  v_dot2_f32_bf16 v39, v191, v7, v39
  v_add_f32_dpp v22, v22, v22 row_ror:8 row_mask:0xf bank_mask:0x3
  s_nop 0
  s_nop 0
  v_add_f32_dpp v22, v23, v23 row_ror:8 row_mask:0xf bank_mask:0xc
  v_add_f32_dpp v20, v20, v20 row_shl:4 row_mask:0xf bank_mask:0x5
  s_nop 0
  s_nop 0
  v_add_f32_dpp v20, v22, v22 row_shr:4 row_mask:0xf bank_mask:0xa
  v_add_f32_dpp v8, v8, v8 quad_perm:[2,3,0,1] row_mask:0xf bank_mask:0xf
  v_add_f32_dpp v12, v12, v12 quad_perm:[2,3,0,1] row_mask:0xf bank_mask:0xf
  v_add_f32_dpp v16, v16, v16 quad_perm:[2,3,0,1] row_mask:0xf bank_mask:0xf
  v_add_f32_dpp v20, v20, v20 quad_perm:[2,3,0,1] row_mask:0xf bank_mask:0xf
  v_cndmask_b32 v8, v8, v12, s[62:63]
  v_cndmask_b32 v16, v16, v20, s[62:63]
  s_nop 0
  s_nop 0
  v_add_f32_dpp v8, v8, v8 quad_perm:[1,0,3,2] row_mask:0xf bank_mask:0xf
  v_add_f32_dpp v16, v16, v16 quad_perm:[1,0,3,2] row_mask:0xf bank_mask:0xf
  v_cndmask_b32 v41, v8, v16, s[60:61]
  v_cvt_pk_bf16_f32 v42, v41, v41
  v_lshlrev_b32 v41, 16, v42
  v_mul_f32 v41, s66, v41
  v_cvt_pk_bf16_f32 v42, v41, v41
  v_lshlrev_b32 v41, 16, v42
  v_max_f32 v40, v40, v41
  ds_write_b32 v2, v41 offset:1280
  v_add_f32_dpp v38, v38, v38 row_ror:8 row_mask:0xf bank_mask:0x3
  s_nop 0
  s_nop 0
  v_add_f32_dpp v38, v39, v39 row_ror:8 row_mask:0xf bank_mask:0xc
  v_add_f32_dpp v36, v36, v36 row_shl:4 row_mask:0xf bank_mask:0x5
  s_nop 0
  s_nop 0
  v_add_f32_dpp v36, v38, v38 row_shr:4 row_mask:0xf bank_mask:0xa
  v_add_f32_dpp v24, v24, v24 quad_perm:[2,3,0,1] row_mask:0xf bank_mask:0xf
  v_add_f32_dpp v28, v28, v28 quad_perm:[2,3,0,1] row_mask:0xf bank_mask:0xf
  v_add_f32_dpp v32, v32, v32 quad_perm:[2,3,0,1] row_mask:0xf bank_mask:0xf
  v_add_f32_dpp v36, v36, v36 quad_perm:[2,3,0,1] row_mask:0xf bank_mask:0xf
  v_cndmask_b32 v24, v24, v28, s[62:63]
  v_cndmask_b32 v32, v32, v36, s[62:63]
  s_nop 0
  s_nop 0
  v_add_f32_dpp v24, v24, v24 quad_perm:[1,0,3,2] row_mask:0xf bank_mask:0xf
  v_add_f32_dpp v32, v32, v32 quad_perm:[1,0,3,2] row_mask:0xf bank_mask:0xf
  v_cndmask_b32 v43, v24, v32, s[60:61]
  v_cvt_pk_bf16_f32 v44, v43, v43
  v_lshlrev_b32 v43, 16, v44
  v_mul_f32 v43, s66, v43
  v_cvt_pk_bf16_f32 v44, v43, v43
  v_lshlrev_b32 v43, 16, v44
  v_max_f32 v40, v40, v43
  ds_write_b32 v2, v43 offset:768
  v_add_u32 v47, 1536, v2
  s_mov_b32 s57, 10
  s_mov_b32 s69, 1978
L_kloop:
  s_nop 7
  s_nop 3
  s_cmp_eq_u32 s57, 1
  s_cselect_b32 s44, s20, s44
  s_cselect_b32 s45, s21, s45
  s_cselect_b32 s56, s58, s56
  s_cmp_lg_u32 s3, 0
  s_cbranch_scc1 L_ml_60
  buffer_load_dwordx2 v[50:51], v53, s[52:55], s49 offen
L_ml_60:
  s_waitcnt vmcnt(8)
  s_cmp_eq_u32 s68, 0
  s_cbranch_scc1 L_pw_61
  s_waitcnt vmcnt(7)
  s_cmp_eq_u32 s68, 1
  s_cbranch_scc1 L_pw_61
  s_waitcnt vmcnt(6)
  s_cmp_eq_u32 s68, 2
  s_cbranch_scc1 L_pw_61
  s_waitcnt vmcnt(5)
  s_cmp_eq_u32 s68, 3
  s_cbranch_scc1 L_pw_61
  s_waitcnt vmcnt(4)
L_pw_61:
  v_dot2_f32_bf16 v8, v64, v4, 0
  v_dot2_f32_bf16 v8, v65, v5, v8
  v_dot2_f32_bf16 v8, v66, v6, v8
  v_dot2_f32_bf16 v8, v67, v7, v8
  buffer_load_dwordx4 v[64:67], v1, s[44:47], s56 offen offset:0 nt
  s_waitcnt vmcnt(8)
  s_cmp_eq_u32 s68, 0
  s_cbranch_scc1 L_pw_62
  s_waitcnt vmcnt(7)
  s_cmp_eq_u32 s68, 1
  s_cbranch_scc1 L_pw_62
  s_waitcnt vmcnt(6)
  s_cmp_eq_u32 s68, 2
  s_cbranch_scc1 L_pw_62
  s_nop 0
  s_waitcnt vmcnt(5)
  s_cmp_eq_u32 s68, 3
  s_cbranch_scc1 L_pw_62
  s_waitcnt vmcnt(4)
L_pw_62:
  v_dot2_f32_bf16 v9, v68, v4, 0
  v_dot2_f32_bf16 v9, v69, v5, v9
  v_dot2_f32_bf16 v9, v70, v6, v9
  v_dot2_f32_bf16 v9, v71, v7, v9
  buffer_load_dwordx4 v[68:71], v1, s[44:47], s56 offen offset:1024 nt
  s_waitcnt vmcnt(8)
  s_cmp_eq_u32 s68, 0
  s_cbranch_scc1 L_pw_63
  s_waitcnt vmcnt(7)
  s_cmp_eq_u32 s68, 1
  s_cbranch_scc1 L_pw_63
  s_waitcnt vmcnt(6)
  s_cmp_eq_u32 s68, 2
  s_cbranch_scc1 L_pw_63
  s_nop 0
  s_waitcnt vmcnt(5)
  s_cmp_eq_u32 s68, 3
  s_cbranch_scc1 L_pw_63
  s_waitcnt vmcnt(4)
L_pw_63:
  v_dot2_f32_bf16 v10, v72, v4, 0
  v_dot2_f32_bf16 v10, v73, v5, v10
  v_dot2_f32_bf16 v10, v74, v6, v10
  v_dot2_f32_bf16 v10, v75, v7, v10
  buffer_load_dwordx4 v[72:75], v1, s[44:47], s56 offen offset:2048 nt
  v_add_f32_dpp v8, v8, v8 row_ror:8 row_mask:0xf bank_mask:0x3
  s_nop 1
  v_add_f32_dpp v8, v9, v9 row_ror:8 row_mask:0xf bank_mask:0xc
  s_waitcnt vmcnt(8)
  s_cmp_eq_u32 s68, 0
  s_cbranch_scc1 L_pw_64
  s_waitcnt vmcnt(7)
  s_cmp_eq_u32 s68, 1
  s_cbranch_scc1 L_pw_64
  s_waitcnt vmcnt(6)
  s_cmp_eq_u32 s68, 2
  s_cbranch_scc1 L_pw_64
  s_waitcnt vmcnt(5)
  s_cmp_eq_u32 s68, 3
  s_cbranch_scc1 L_pw_64
  s_waitcnt vmcnt(4)
L_pw_64:
  v_dot2_f32_bf16 v11, v76, v4, 0
  v_dot2_f32_bf16 v11, v77, v5, v11
  v_dot2_f32_bf16 v11, v78, v6, v11
  v_dot2_f32_bf16 v11, v79, v7, v11
  buffer_load_dwordx4 v[76:79], v1, s[44:47], s56 offen offset:3072 nt
  s_add_u32 s56, s56, 16384
  s_waitcnt vmcnt(8)
  s_cmp_eq_u32 s68, 0
  s_cbranch_scc1 L_pw_65
  s_waitcnt vmcnt(7)
  s_cmp_eq_u32 s68, 1
  s_cbranch_scc1 L_pw_65
  s_waitcnt vmcnt(6)
  s_cmp_eq_u32 s68, 2
  s_cbranch_scc1 L_pw_65
  s_nop 0
  s_waitcnt vmcnt(5)
  s_cmp_eq_u32 s68, 3
  s_cbranch_scc1 L_pw_65
  s_waitcnt vmcnt(4)
L_pw_65:
  v_dot2_f32_bf16 v12, v80, v4, 0
  v_dot2_f32_bf16 v12, v81, v5, v12
  v_dot2_f32_bf16 v12, v82, v6, v12
  v_dot2_f32_bf16 v12, v83, v7, v12
  buffer_load_dwordx4 v[80:83], v1, s[44:47], s56 offen offset:0 nt
  v_add_f32_dpp v10, v10, v10 row_ror:8 row_mask:0xf bank_mask:0x3
  s_nop 1
  v_add_f32_dpp v10, v11, v11 row_ror:8 row_mask:0xf bank_mask:0xc
  s_waitcnt vmcnt(8)
  s_cmp_eq_u32 s68, 0
  s_cbranch_scc1 L_pw_66
  s_waitcnt vmcnt(7)
  s_cmp_eq_u32 s68, 1
  s_cbranch_scc1 L_pw_66
  s_waitcnt vmcnt(6)
  s_cmp_eq_u32 s68, 2
  s_cbranch_scc1 L_pw_66
  s_waitcnt vmcnt(5)
  s_cmp_eq_u32 s68, 3
  s_cbranch_scc1 L_pw_66
  s_waitcnt vmcnt(4)
L_pw_66:
  v_dot2_f32_bf16 v13, v84, v4, 0
  v_dot2_f32_bf16 v13, v85, v5, v13
  v_dot2_f32_bf16 v13, v86, v6, v13
  v_dot2_f32_bf16 v13, v87, v7, v13
  buffer_load_dwordx4 v[84:87], v1, s[44:47], s56 offen offset:1024 nt
  v_add_f32_dpp v8, v8, v8 row_shl:4 row_mask:0xf bank_mask:0x5
  s_nop 1
  v_add_f32_dpp v8, v10, v10 row_shr:4 row_mask:0xf bank_mask:0xa
  s_waitcnt vmcnt(8)
  s_cmp_eq_u32 s68, 0
  s_cbranch_scc1 L_pw_67
  s_waitcnt vmcnt(7)
  s_cmp_eq_u32 s68, 1
  s_cbranch_scc1 L_pw_67
  s_waitcnt vmcnt(6)
  s_cmp_eq_u32 s68, 2
  s_cbranch_scc1 L_pw_67
  s_waitcnt vmcnt(5)
  s_cmp_eq_u32 s68, 3
  s_cbranch_scc1 L_pw_67
  s_waitcnt vmcnt(4)
L_pw_67:
  v_dot2_f32_bf16 v14, v88, v4, 0
  v_dot2_f32_bf16 v14, v89, v5, v14
  v_dot2_f32_bf16 v14, v90, v6, v14
  v_dot2_f32_bf16 v14, v91, v7, v14
  buffer_load_dwordx4 v[88:91], v1, s[44:47], s56 offen offset:2048 nt
  v_add_f32_dpp v12, v12, v12 row_ror:8 row_mask:0xf bank_mask:0x3
  s_nop 1
  v_add_f32_dpp v12, v13, v13 row_ror:8 row_mask:0xf bank_mask:0xc
  s_waitcnt vmcnt(8)
  s_cmp_eq_u32 s68, 0
  s_cbranch_scc1 L_pw_68
  s_waitcnt vmcnt(7)
  s_cmp_eq_u32 s68, 1
  s_cbranch_scc1 L_pw_68
  s_waitcnt vmcnt(6)
  s_cmp_eq_u32 s68, 2
  s_cbranch_scc1 L_pw_68
  s_waitcnt vmcnt(5)
  s_cmp_eq_u32 s68, 3
  s_cbranch_scc1 L_pw_68
  s_waitcnt vmcnt(4)
L_pw_68:
  v_dot2_f32_bf16 v15, v92, v4, 0
  v_dot2_f32_bf16 v15, v93, v5, v15
  v_dot2_f32_bf16 v15, v94, v6, v15
  v_dot2_f32_bf16 v15, v95, v7, v15
  buffer_load_dwordx4 v[92:95], v1, s[44:47], s56 offen offset:3072 nt
  s_add_u32 s56, s56, 16384
  s_waitcnt vmcnt(8)
  s_cmp_eq_u32 s68, 0
  s_cbranch_scc1 L_pw_69
  s_waitcnt vmcnt(7)
  s_cmp_eq_u32 s68, 1
  s_cbranch_scc1 L_pw_69
  s_waitcnt vmcnt(6)
  s_cmp_eq_u32 s68, 2
  s_cbranch_scc1 L_pw_69
  s_nop 0
  s_waitcnt vmcnt(5)
  s_cmp_eq_u32 s68, 3
  s_cbranch_scc1 L_pw_69
  s_waitcnt vmcnt(4)
L_pw_69:
  v_dot2_f32_bf16 v16, v96, v4, 0
  v_dot2_f32_bf16 v16, v97, v5, v16
  v_dot2_f32_bf16 v16, v98, v6, v16
  v_dot2_f32_bf16 v16, v99, v7, v16
  buffer_load_dwordx4 v[96:99], v1, s[44:47], s56 offen offset:0 nt
  v_add_f32_dpp v14, v14, v14 row_ror:8 row_mask:0xf bank_mask:0x3
  s_nop 1
  v_add_f32_dpp v14, v15, v15 row_ror:8 row_mask:0xf bank_mask:0xc
  s_waitcnt vmcnt(8)
  s_cmp_eq_u32 s68, 0
  s_cbranch_scc1 L_pw_70
  s_waitcnt vmcnt(7)
  s_cmp_eq_u32 s68, 1
  s_cbranch_scc1 L_pw_70
  s_waitcnt vmcnt(6)
  s_cmp_eq_u32 s68, 2
  s_cbranch_scc1 L_pw_70
  s_waitcnt vmcnt(5)
  s_cmp_eq_u32 s68, 3
  s_cbranch_scc1 L_pw_70
  s_waitcnt vmcnt(4)
L_pw_70:
  v_dot2_f32_bf16 v17, v100, v4, 0
  v_dot2_f32_bf16 v17, v101, v5, v17
  v_dot2_f32_bf16 v17, v102, v6, v17
  v_dot2_f32_bf16 v17, v103, v7, v17
  buffer_load_dwordx4 v[100:103], v1, s[44:47], s56 offen offset:1024 nt
  v_add_f32_dpp v12, v12, v12 row_shl:4 row_mask:0xf bank_mask:0x5
  s_nop 1
  v_add_f32_dpp v12, v14, v14 row_shr:4 row_mask:0xf bank_mask:0xa
  s_waitcnt vmcnt(8)
  s_cmp_eq_u32 s68, 0
  s_cbranch_scc1 L_pw_71
  s_waitcnt vmcnt(7)
  s_cmp_eq_u32 s68, 1
  s_cbranch_scc1 L_pw_71
  s_waitcnt vmcnt(6)
  s_cmp_eq_u32 s68, 2
  s_cbranch_scc1 L_pw_71
  s_waitcnt vmcnt(5)
  s_cmp_eq_u32 s68, 3
  s_cbranch_scc1 L_pw_71
  s_waitcnt vmcnt(4)
L_pw_71:
  v_dot2_f32_bf16 v18, v104, v4, 0
  v_dot2_f32_bf16 v18, v105, v5, v18
  v_dot2_f32_bf16 v18, v106, v6, v18
  v_dot2_f32_bf16 v18, v107, v7, v18
  buffer_load_dwordx4 v[104:107], v1, s[44:47], s56 offen offset:2048 nt
  v_add_f32_dpp v16, v16, v16 row_ror:8 row_mask:0xf bank_mask:0x3
  s_nop 1
  v_add_f32_dpp v16, v17, v17 row_ror:8 row_mask:0xf bank_mask:0xc
  s_waitcnt vmcnt(8)
  s_cmp_eq_u32 s68, 0
  s_cbranch_scc1 L_pw_72
  s_waitcnt vmcnt(7)
  s_cmp_eq_u32 s68, 1
  s_cbranch_scc1 L_pw_72
  s_waitcnt vmcnt(6)
  s_cmp_eq_u32 s68, 2
  s_cbranch_scc1 L_pw_72
  s_waitcnt vmcnt(5)
  s_cmp_eq_u32 s68, 3
  s_cbranch_scc1 L_pw_72
  s_waitcnt vmcnt(4)
L_pw_72:
  v_dot2_f32_bf16 v19, v108, v4, 0
  v_dot2_f32_bf16 v19, v109, v5, v19
  v_dot2_f32_bf16 v19, v110, v6, v19
  v_dot2_f32_bf16 v19, v111, v7, v19
  buffer_load_dwordx4 v[108:111], v1, s[44:47], s56 offen offset:3072 nt
  s_add_u32 s56, s56, 16384
  s_memrealtime s[72:73]
  ds_read_b32 v52, v60 offset:16
  s_waitcnt vmcnt(8)
  s_cmp_eq_u32 s68, 0
  s_cbranch_scc1 L_pw_73
  s_waitcnt vmcnt(7)
  s_cmp_eq_u32 s68, 1
  s_cbranch_scc1 L_pw_73
  s_waitcnt vmcnt(6)
  s_cmp_eq_u32 s68, 2
  s_cbranch_scc1 L_pw_73
  s_nop 0
  s_waitcnt vmcnt(5)
  s_cmp_eq_u32 s68, 3
  s_cbranch_scc1 L_pw_73
  s_waitcnt vmcnt(4)
L_pw_73:
  v_dot2_f32_bf16 v20, v112, v4, 0
  v_dot2_f32_bf16 v20, v113, v5, v20
  v_dot2_f32_bf16 v20, v114, v6, v20
  v_dot2_f32_bf16 v20, v115, v7, v20
  buffer_load_dwordx4 v[112:115], v1, s[44:47], s56 offen offset:0 nt
  v_add_f32_dpp v18, v18, v18 row_ror:8 row_mask:0xf bank_mask:0x3
  s_nop 1
  v_add_f32_dpp v18, v19, v19 row_ror:8 row_mask:0xf bank_mask:0xc
  s_waitcnt vmcnt(8)
  s_cmp_eq_u32 s68, 0
  s_cbranch_scc1 L_pw_74
  s_waitcnt vmcnt(7)
  s_cmp_eq_u32 s68, 1
  s_cbranch_scc1 L_pw_74
  s_waitcnt vmcnt(6)
  s_cmp_eq_u32 s68, 2
  s_cbranch_scc1 L_pw_74
  s_waitcnt vmcnt(5)
  s_cmp_eq_u32 s68, 3
  s_cbranch_scc1 L_pw_74
  s_waitcnt vmcnt(4)
L_pw_74:
  v_dot2_f32_bf16 v21, v116, v4, 0
  v_dot2_f32_bf16 v21, v117, v5, v21
  v_dot2_f32_bf16 v21, v118, v6, v21
  v_dot2_f32_bf16 v21, v119, v7, v21
  buffer_load_dwordx4 v[116:119], v1, s[44:47], s56 offen offset:1024 nt
  v_add_f32_dpp v16, v16, v16 row_shl:4 row_mask:0xf bank_mask:0x5
  s_nop 1
  v_add_f32_dpp v16, v18, v18 row_shr:4 row_mask:0xf bank_mask:0xa
  s_waitcnt vmcnt(8)
  s_cmp_eq_u32 s68, 0
  s_cbranch_scc1 L_pw_75
  s_waitcnt vmcnt(7)
  s_cmp_eq_u32 s68, 1
  s_cbranch_scc1 L_pw_75
  s_waitcnt vmcnt(6)
  s_cmp_eq_u32 s68, 2
  s_cbranch_scc1 L_pw_75
  s_waitcnt vmcnt(5)
  s_cmp_eq_u32 s68, 3
  s_cbranch_scc1 L_pw_75
  s_waitcnt vmcnt(4)
L_pw_75:
  v_dot2_f32_bf16 v22, v120, v4, 0
  v_dot2_f32_bf16 v22, v121, v5, v22
  v_dot2_f32_bf16 v22, v122, v6, v22
  v_dot2_f32_bf16 v22, v123, v7, v22
  buffer_load_dwordx4 v[120:123], v1, s[44:47], s56 offen offset:2048 nt
  v_add_f32_dpp v20, v20, v20 row_ror:8 row_mask:0xf bank_mask:0x3
  s_nop 0
  s_nop 0
  v_add_f32_dpp v20, v21, v21 row_ror:8 row_mask:0xf bank_mask:0xc
  s_waitcnt lgkmcnt(0)
  v_readfirstlane_b32 s73, v52
  s_sub_u32 s72, s72, s69
  s_sub_u32 s71, s72, s73
  s_add_u32 s69, s69, 245
  s_mov_b32 s68, 4
  s_cmp_gt_i32 s71, -110
  s_cselect_b32 s68, 3, s68
  s_cmp_gt_i32 s71, -20
  s_cselect_b32 s68, 2, s68
  s_cmp_gt_i32 s71, 50
  s_cselect_b32 s68, 1, s68
  s_cmp_gt_i32 s71, 90
  s_cselect_b32 s68, 0, s68
  s_cmp_lg_u32 s3, 0
  s_cbranch_scc1 L_ct_76
  s_cmp_eq_u32 s48, 0
  s_cbranch_scc1 L_cm_77
  v_mov_b32 v54, s72
  v_mov_b32 v55, s67
  s_add_u32 s50, s48, s49
  s_mov_b64 exec, 1
  buffer_store_dwordx2 v[54:55], v60, s[52:55], s50 offen sc1
  s_mov_b64 exec, -1
L_cm_77:
  s_add_u32 s49, s49, 256
  v_cmp_ne_u32 vcc, s67, v51
  v_subrev_u32 v56, s70, v50
  s_nop 1
  v_add_u32_dpp v56, v56, v56 quad_perm:[1,0,3,2] row_mask:0xf bank_mask:0xf
  s_nop 0
  s_nop 0
  v_add_u32_dpp v56, v56, v56 quad_perm:[2,3,0,1] row_mask:0xf bank_mask:0xf
  s_nop 0
  s_nop 0
  v_add_u32_dpp v56, v56, v56 row_half_mirror row_mask:0xf bank_mask:0xf
  v_ashrrev_i32 v56, 3, v56
  s_add_u32 s73, s70, 0
  v_add_u32_e64 v56, s73, v56
  s_cbranch_vccnz L_ct_76
  ds_write_b32 v60, v56 offset:16
L_ct_76:
  s_waitcnt vmcnt(8)
  s_cmp_eq_u32 s68, 0
  s_cbranch_scc1 L_pw_78
  s_waitcnt vmcnt(7)
  s_cmp_eq_u32 s68, 1
  s_cbranch_scc1 L_pw_78
  s_waitcnt vmcnt(6)
  s_cmp_eq_u32 s68, 2
  s_cbranch_scc1 L_pw_78
  s_waitcnt vmcnt(5)
  s_cmp_eq_u32 s68, 3
  s_cbranch_scc1 L_pw_78
  s_waitcnt vmcnt(4)
L_pw_78:
  v_dot2_f32_bf16 v23, v124, v4, 0
  v_dot2_f32_bf16 v23, v125, v5, v23
  v_dot2_f32_bf16 v23, v126, v6, v23
  v_dot2_f32_bf16 v23, v127, v7, v23
  buffer_load_dwordx4 v[124:127], v1, s[44:47], s56 offen offset:3072 nt
  s_add_u32 s56, s56, 16384
  v_add_f32_dpp v22, v22, v22 row_ror:8 row_mask:0xf bank_mask:0x3
  s_nop 0
  s_nop 0
  v_add_f32_dpp v22, v23, v23 row_ror:8 row_mask:0xf bank_mask:0xc
  v_add_f32_dpp v20, v20, v20 row_shl:4 row_mask:0xf bank_mask:0x5
  s_nop 0
  s_nop 0
  v_add_f32_dpp v20, v22, v22 row_shr:4 row_mask:0xf bank_mask:0xa
  v_add_f32_dpp v8, v8, v8 quad_perm:[2,3,0,1] row_mask:0xf bank_mask:0xf
  v_add_f32_dpp v12, v12, v12 quad_perm:[2,3,0,1] row_mask:0xf bank_mask:0xf
  v_add_f32_dpp v16, v16, v16 quad_perm:[2,3,0,1] row_mask:0xf bank_mask:0xf
  v_add_f32_dpp v20, v20, v20 quad_perm:[2,3,0,1] row_mask:0xf bank_mask:0xf
  v_cndmask_b32 v8, v8, v12, s[62:63]
  v_cndmask_b32 v16, v16, v20, s[62:63]
  s_nop 0
  s_nop 0
  v_add_f32_dpp v8, v8, v8 quad_perm:[1,0,3,2] row_mask:0xf bank_mask:0xf
  v_add_f32_dpp v16, v16, v16 quad_perm:[1,0,3,2] row_mask:0xf bank_mask:0xf
  v_cndmask_b32 v41, v8, v16, s[60:61]
  v_cvt_pk_bf16_f32 v42, v41, v41
  v_lshlrev_b32 v41, 16, v42
  v_mul_f32 v41, s66, v41
  v_cvt_pk_bf16_f32 v42, v41, v41
  v_lshlrev_b32 v41, 16, v42
  v_max_f32 v40, v40, v41
  ds_write_b32 v47, v41 offset:0
  v_add_u32 v47, 256, v47
  s_sub_u32 s57, s57, 1
  s_cmp_lg_u32 s57, 0
  s_cbranch_scc1 L_kloop
  s_waitcnt vmcnt(8)
  s_cmp_eq_u32 s68, 0
  s_cbranch_scc1 L_pw_79
  s_waitcnt vmcnt(7)
  s_cmp_eq_u32 s68, 1
  s_cbranch_scc1 L_pw_79
  s_waitcnt vmcnt(6)
  s_cmp_eq_u32 s68, 2
  s_cbranch_scc1 L_pw_79
  s_waitcnt vmcnt(5)
  s_cmp_eq_u32 s68, 3
  s_cbranch_scc1 L_pw_79
  s_waitcnt vmcnt(4)
L_pw_79:
  buffer_load_dwordx4 v[128:131], v1, s[44:47], s56 offen offset:0 nt
  s_nop 0
  s_waitcnt lgkmcnt(0)
  ds_read2st64_b32 v[8:9], v2 offset0:0 offset1:1
  ds_read2st64_b32 v[10:11], v2 offset0:2 offset1:3
  ds_read2st64_b32 v[12:13], v2 offset0:4 offset1:5
  ds_read2st64_b32 v[14:15], v2 offset0:6 offset1:7
  ds_read2st64_b32 v[16:17], v2 offset0:8 offset1:9
  ds_read2st64_b32 v[18:19], v2 offset0:10 offset1:11
  ds_read2st64_b32 v[20:21], v2 offset0:12 offset1:13
  ds_read2st64_b32 v[22:23], v2 offset0:14 offset1:15
  v_max_f32_dpp v40, v40, v40 quad_perm:[1,0,3,2] row_mask:0xf bank_mask:0xf
  s_nop 0
  s_nop 0
  v_max_f32_dpp v40, v40, v40 quad_perm:[2,3,0,1] row_mask:0xf bank_mask:0xf
  s_nop 0
  s_nop 0
  v_max_f32_dpp v40, v40, v40 row_half_mirror row_mask:0xf bank_mask:0xf
  s_nop 0
  s_nop 0
  v_max_f32_dpp v40, v40, v40 row_mirror row_mask:0xf bank_mask:0xf
  v_mov_b32 v41, v40
  s_nop 1
  v_permlane16_swap_b32 v40, v41
  v_max_f32 v40, v40, v41
  v_mov_b32_e64 v41, v40
  s_nop 1
  v_permlane32_swap_b32 v40, v41
  v_max_f32 v40, v40, v41
  s_waitcnt vmcnt(8)
  s_cmp_eq_u32 s68, 0
  s_cbranch_scc1 L_pw_80
  s_waitcnt vmcnt(7)
  s_cmp_eq_u32 s68, 1
  s_cbranch_scc1 L_pw_80
  s_waitcnt vmcnt(6)
  s_cmp_eq_u32 s68, 2
  s_cbranch_scc1 L_pw_80
  s_waitcnt vmcnt(5)
  s_cmp_eq_u32 s68, 3
  s_cbranch_scc1 L_pw_80
  s_waitcnt vmcnt(4)
L_pw_80:
  buffer_load_dwordx4 v[132:135], v1, s[44:47], s56 offen offset:1024 nt
  s_waitcnt lgkmcnt(0)
  v_sub_f32 v8, v8, v40
  v_sub_f32 v9, v9, v40
  v_sub_f32 v10, v10, v40
  v_sub_f32 v11, v11, v40
  v_sub_f32 v12, v12, v40
  v_sub_f32 v13, v13, v40
  v_sub_f32 v14, v14, v40
  v_sub_f32 v15, v15, v40
  v_sub_f32 v16, v16, v40
  v_sub_f32 v17, v17, v40
  v_sub_f32 v18, v18, v40
  v_sub_f32 v19, v19, v40
  v_sub_f32 v20, v20, v40
  v_sub_f32 v21, v21, v40
  v_sub_f32 v22, v22, v40
  v_sub_f32_e64 v23, v23, v40
  v_mul_f32 v8, 0x3fb8aa3b, v8
  v_mul_f32 v9, 0x3fb8aa3b, v9
  v_mul_f32 v10, 0x3fb8aa3b, v10
  v_mul_f32 v11, 0x3fb8aa3b, v11
  v_mul_f32 v12, 0x3fb8aa3b, v12
  v_mul_f32 v13, 0x3fb8aa3b, v13
  v_mul_f32 v14, 0x3fb8aa3b, v14
  v_mul_f32 v15, 0x3fb8aa3b, v15
  v_mul_f32 v16, 0x3fb8aa3b, v16
  v_mul_f32 v17, 0x3fb8aa3b, v17
  v_mul_f32 v18, 0x3fb8aa3b, v18
  v_mul_f32 v19, 0x3fb8aa3b, v19
  v_mul_f32 v20, 0x3fb8aa3b, v20
  v_mul_f32 v21, 0x3fb8aa3b, v21
  v_mul_f32 v22, 0x3fb8aa3b, v22
  v_mul_f32 v23, 0x3fb8aa3b, v23
  s_waitcnt vmcnt(8)
  s_cmp_eq_u32 s68, 0
  s_cbranch_scc1 L_pw_81
  s_waitcnt vmcnt(7)
  s_cmp_eq_u32 s68, 1
  s_cbranch_scc1 L_pw_81
  s_waitcnt vmcnt(6)
  s_cmp_eq_u32 s68, 2
  s_cbranch_scc1 L_pw_81
  s_waitcnt vmcnt(5)
  s_cmp_eq_u32 s68, 3
  s_cbranch_scc1 L_pw_81
  s_waitcnt vmcnt(4)
L_pw_81:
  buffer_load_dwordx4 v[136:139], v1, s[44:47], s56 offen offset:2048 nt
  v_exp_f32 v8, v8
  v_exp_f32 v9, v9
  v_exp_f32 v10, v10
  v_exp_f32 v11, v11
  v_exp_f32 v12, v12
  v_exp_f32 v13, v13
  v_exp_f32 v14, v14
  v_exp_f32 v15, v15
  v_exp_f32 v16, v16
  v_exp_f32 v17, v17
  v_exp_f32 v18, v18
  v_exp_f32 v19, v19
  v_exp_f32 v20, v20
  v_exp_f32 v21, v21
  v_exp_f32 v22, v22
  v_exp_f32 v23, v23
  s_waitcnt vmcnt(8)
  s_cmp_eq_u32 s68, 0
  s_cbranch_scc1 L_pw_82
  s_waitcnt vmcnt(7)
  s_cmp_eq_u32 s68, 1
  s_cbranch_scc1 L_pw_82
  s_waitcnt vmcnt(6)
  s_cmp_eq_u32 s68, 2
  s_cbranch_scc1 L_pw_82
  s_waitcnt vmcnt(5)
  s_cmp_eq_u32 s68, 3
  s_cbranch_scc1 L_pw_82
  s_waitcnt vmcnt(4)
L_pw_82:
  buffer_load_dwordx4 v[140:143], v1, s[44:47], s56 offen offset:3072 nt
  s_add_u32 s56, s56, 16384
  v_add_f32 v32, v8, v16
  v_add_f32 v33, v9, v17
  v_add_f32 v34, v10, v18
  v_add_f32 v35, v11, v19
  v_add_f32 v36, v12, v20
  v_add_f32 v37, v13, v21
  v_add_f32 v38, v14, v22
  v_add_f32 v39, v15, v23
  v_add_f32 v32, v32, v36
  v_add_f32 v33, v33, v37
  v_add_f32 v34, v34, v38
  v_add_f32 v35, v35, v39
  v_add_f32 v32, v32, v34
  v_add_f32 v33, v33, v35
  v_add_f32 v41, v32, v33
  s_nop 1
  v_add_f32_dpp v41, v41, v41 quad_perm:[1,0,3,2] row_mask:0xf bank_mask:0xf
  s_nop 0
  s_nop 0
  v_add_f32_dpp v41, v41, v41 quad_perm:[2,3,0,1] row_mask:0xf bank_mask:0xf
  s_nop 0
  s_nop 0
  v_add_f32_dpp v41, v41, v41 row_half_mirror row_mask:0xf bank_mask:0xf
  s_nop 0
  s_nop 0
  v_add_f32_dpp v41, v41, v41 row_mirror row_mask:0xf bank_mask:0xf
  v_mov_b32 v42, v41
  s_nop 1
  v_permlane16_swap_b32 v41, v42
  v_add_f32 v41, v41, v42
  v_mov_b32 v42, v41
  s_nop 1
  v_permlane32_swap_b32 v41, v42
  v_add_f32 v41, v41, v42
  s_lshl_b32 s59, s3, 3
  v_mov_b32 v42, s59
  ds_write_b64 v42, v[40:41] offset:64
  v_mov_b32_e64 v42, 1
  s_waitcnt lgkmcnt(0)
  s_mov_b64 exec, 1
  ds_add_u32 v60, v42 offset:12
  s_mov_b64 exec, -1
  s_waitcnt vmcnt(8)
  s_cmp_eq_u32 s68, 0
  s_cbranch_scc1 L_pw_83
  s_waitcnt vmcnt(7)
  s_cmp_eq_u32 s68, 1
  s_cbranch_scc1 L_pw_83
  s_waitcnt vmcnt(6)
  s_cmp_eq_u32 s68, 2
  s_cbranch_scc1 L_pw_83
  s_waitcnt vmcnt(5)
  s_cmp_eq_u32 s68, 3
  s_cbranch_scc1 L_pw_83
  s_waitcnt vmcnt(4)
L_pw_83:
  buffer_load_dwordx4 v[144:147], v1, s[44:47], s56 offen offset:0 nt
  s_waitcnt vmcnt(8)
  s_cmp_eq_u32 s68, 0
  s_cbranch_scc1 L_pw_84
  s_waitcnt vmcnt(7)
  s_cmp_eq_u32 s68, 1
  s_cbranch_scc1 L_pw_84
  s_waitcnt vmcnt(6)
  s_cmp_eq_u32 s68, 2
  s_cbranch_scc1 L_pw_84
  s_waitcnt vmcnt(5)
  s_cmp_eq_u32 s68, 3
  s_cbranch_scc1 L_pw_84
  s_waitcnt vmcnt(4)
L_pw_84:
  buffer_load_dwordx4 v[148:151], v1, s[44:47], s56 offen offset:1024 nt
  s_waitcnt vmcnt(8)
  s_cmp_eq_u32 s68, 0
  s_cbranch_scc1 L_pw_85
  s_waitcnt vmcnt(7)
  s_cmp_eq_u32 s68, 1
  s_cbranch_scc1 L_pw_85
  s_waitcnt vmcnt(6)
  s_cmp_eq_u32 s68, 2
  s_cbranch_scc1 L_pw_85
  s_waitcnt vmcnt(5)
  s_cmp_eq_u32 s68, 3
  s_cbranch_scc1 L_pw_85
  s_waitcnt vmcnt(4)
L_pw_85:
  buffer_load_dwordx4 v[152:155], v1, s[44:47], s56 offen offset:2048 nt
  s_waitcnt vmcnt(8)
  s_cmp_eq_u32 s68, 0
  s_cbranch_scc1 L_pw_86
  s_waitcnt vmcnt(7)
  s_cmp_eq_u32 s68, 1
  s_cbranch_scc1 L_pw_86
  s_waitcnt vmcnt(6)
  s_cmp_eq_u32 s68, 2
  s_cbranch_scc1 L_pw_86
  s_nop 0
  s_waitcnt vmcnt(5)
  s_cmp_eq_u32 s68, 3
  s_cbranch_scc1 L_pw_86
  s_waitcnt vmcnt(4)
L_pw_86:
  buffer_load_dwordx4 v[156:159], v1, s[44:47], s56 offen offset:3072 nt
  s_add_u32 s56, s56, 16384
  s_waitcnt vmcnt(8)
  s_cmp_eq_u32 s68, 0
  s_cbranch_scc1 L_pw_87
  s_waitcnt vmcnt(7)
  s_cmp_eq_u32 s68, 1
  s_cbranch_scc1 L_pw_87
  s_waitcnt vmcnt(6)
  s_cmp_eq_u32 s68, 2
  s_cbranch_scc1 L_pw_87
  s_waitcnt vmcnt(5)
  s_cmp_eq_u32 s68, 3
  s_cbranch_scc1 L_pw_87
  s_waitcnt vmcnt(4)
L_pw_87:
  buffer_load_dwordx4 v[160:163], v1, s[44:47], s56 offen offset:0 nt
  s_waitcnt vmcnt(8)
  s_cmp_eq_u32 s68, 0
  s_cbranch_scc1 L_pw_88
  s_waitcnt vmcnt(7)
  s_cmp_eq_u32 s68, 1
  s_cbranch_scc1 L_pw_88
  s_waitcnt vmcnt(6)
  s_cmp_eq_u32 s68, 2
  s_cbranch_scc1 L_pw_88
  s_waitcnt vmcnt(5)
  s_cmp_eq_u32 s68, 3
  s_cbranch_scc1 L_pw_88
  s_waitcnt vmcnt(4)
L_pw_88:
  buffer_load_dwordx4 v[164:167], v1, s[44:47], s56 offen offset:1024 nt
  s_waitcnt vmcnt(8)
  s_cmp_eq_u32 s68, 0
  s_cbranch_scc1 L_pw_89
  s_waitcnt vmcnt(7)
  s_cmp_eq_u32 s68, 1
  s_cbranch_scc1 L_pw_89
  s_waitcnt vmcnt(6)
  s_cmp_eq_u32 s68, 2
  s_cbranch_scc1 L_pw_89
  s_waitcnt vmcnt(5)
  s_cmp_eq_u32 s68, 3
  s_cbranch_scc1 L_pw_89
  s_waitcnt vmcnt(4)
L_pw_89:
  buffer_load_dwordx4 v[168:171], v1, s[44:47], s56 offen offset:2048 nt
  s_waitcnt vmcnt(8)
  s_cmp_eq_u32 s68, 0
  s_cbranch_scc1 L_pw_90
  s_waitcnt vmcnt(7)
  s_cmp_eq_u32 s68, 1
  s_cbranch_scc1 L_pw_90
  s_waitcnt vmcnt(6)
  s_cmp_eq_u32 s68, 2
  s_cbranch_scc1 L_pw_90
  s_waitcnt vmcnt(5)
  s_cmp_eq_u32 s68, 3
  s_cbranch_scc1 L_pw_90
  s_waitcnt vmcnt(4)
L_pw_90:
  buffer_load_dwordx4 v[172:175], v1, s[44:47], s56 offen offset:3072 nt
  s_add_u32 s56, s56, 16384
  s_waitcnt vmcnt(8)
  s_cmp_eq_u32 s68, 0
  s_cbranch_scc1 L_pw_91
  s_waitcnt vmcnt(7)
  s_cmp_eq_u32 s68, 1
  s_cbranch_scc1 L_pw_91
  s_waitcnt vmcnt(6)
  s_cmp_eq_u32 s68, 2
  s_cbranch_scc1 L_pw_91
  s_waitcnt vmcnt(5)
  s_cmp_eq_u32 s68, 3
  s_cbranch_scc1 L_pw_91
  s_waitcnt vmcnt(4)
L_pw_91:
  buffer_load_dwordx4 v[176:179], v1, s[44:47], s56 offen offset:0 nt
  s_waitcnt vmcnt(8)
  s_cmp_eq_u32 s68, 0
  s_cbranch_scc1 L_pw_92
  s_waitcnt vmcnt(7)
  s_cmp_eq_u32 s68, 1
  s_cbranch_scc1 L_pw_92
  s_waitcnt vmcnt(6)
  s_cmp_eq_u32 s68, 2
  s_cbranch_scc1 L_pw_92
  s_waitcnt vmcnt(5)
  s_cmp_eq_u32 s68, 3
  s_cbranch_scc1 L_pw_92
  s_waitcnt vmcnt(4)
L_pw_92:
  buffer_load_dwordx4 v[180:183], v1, s[44:47], s56 offen offset:1024 nt
  s_waitcnt vmcnt(8)
  s_cmp_eq_u32 s68, 0
  s_cbranch_scc1 L_pw_93
  s_waitcnt vmcnt(7)
  s_cmp_eq_u32 s68, 1
  s_cbranch_scc1 L_pw_93
  s_waitcnt vmcnt(6)
  s_cmp_eq_u32 s68, 2
  s_cbranch_scc1 L_pw_93
  s_waitcnt vmcnt(5)
  s_cmp_eq_u32 s68, 3
  s_cbranch_scc1 L_pw_93
  s_waitcnt vmcnt(4)
L_pw_93:
  buffer_load_dwordx4 v[184:187], v1, s[44:47], s56 offen offset:2048 nt
  s_waitcnt vmcnt(8)
  s_cmp_eq_u32 s68, 0
  s_cbranch_scc1 L_pw_94
  s_waitcnt vmcnt(7)
  s_cmp_eq_u32 s68, 1
  s_cbranch_scc1 L_pw_94
  s_waitcnt vmcnt(6)
  s_cmp_eq_u32 s68, 2
  s_cbranch_scc1 L_pw_94
  s_waitcnt vmcnt(5)
  s_cmp_eq_u32 s68, 3
  s_cbranch_scc1 L_pw_94
  s_waitcnt vmcnt(4)
L_pw_94:
  buffer_load_dwordx4 v[188:191], v1, s[44:47], s56 offen offset:3072 nt
  s_add_u32 s56, s56, 16384
  buffer_load_dwordx4 v[192:195], v1, s[44:47], s56 offen offset:0 nt
  buffer_load_dwordx4 v[196:199], v1, s[44:47], s56 offen offset:1024 nt
  buffer_load_dwordx4 v[200:203], v1, s[44:47], s56 offen offset:2048 nt
  s_mov_b32 s79, 0
L_b2:
  s_nop 7
  s_nop 3
  ds_read_b32 v42, v60 offset:12
  s_waitcnt lgkmcnt(0)
  v_readfirstlane_b32 s74, v42
  s_cmp_ge_u32 s74, 4
  s_cbranch_scc1 L_b2_ok
  s_add_u32 s79, s79, 1
  s_cmp_lt_u32 s79, 800000
  s_cbranch_scc0 L_b2_ok
  s_sleep 1
  s_branch L_b2
L_b2_ok:
  s_nop 7
  s_nop 0
  s_nop 2
  ds_read_b128 v[32:35], v60 offset:64
  ds_read_b128 v[36:39], v60 offset:80
  s_waitcnt lgkmcnt(0)
  v_max_f32 v42, v32, v34
  v_max3_f32 v42, v42, v36, v38
  v_sub_f32 v32, v32, v42
  v_sub_f32 v34, v34, v42
  v_sub_f32 v36, v36, v42
  v_sub_f32 v38, v38, v42
  v_sub_f32_e64 v48, v40, v42
  v_mul_f32 v32, 0x3fb8aa3b, v32
  v_mul_f32 v34, 0x3fb8aa3b, v34
  v_mul_f32 v36, 0x3fb8aa3b, v36
  v_mul_f32 v38, 0x3fb8aa3b, v38
  v_mul_f32 v48, 0x3fb8aa3b, v48
  v_exp_f32 v32, v32
  v_exp_f32 v34, v34
  v_exp_f32 v36, v36
  v_exp_f32 v38, v38
  v_exp_f32_e64 v48, v48
  v_mul_f32 v41, v32, v33
  v_fmac_f32 v41, v34, v35
  v_fmac_f32 v41, v36, v37
  v_fmac_f32 v41, v38, v39
  v_rcp_f32 v41, v41
  s_nop 0
  v_mul_f32 v48, v48, v41
  s_waitcnt vmcnt(8)
  s_cmp_eq_u32 s68, 0
  s_cbranch_scc1 L_pw_95
  s_waitcnt vmcnt(7)
  s_cmp_eq_u32 s68, 1
  s_cbranch_scc1 L_pw_95
  s_waitcnt vmcnt(6)
  s_cmp_eq_u32 s68, 2
  s_cbranch_scc1 L_pw_95
  s_waitcnt vmcnt(5)
  s_cmp_eq_u32 s68, 3
  s_cbranch_scc1 L_pw_95
  s_waitcnt vmcnt(4)
L_pw_95:
  buffer_load_dwordx4 v[204:207], v1, s[44:47], s56 offen offset:3072 nt
  s_add_u32 s56, s56, 16384
  v_mul_f32 v8, v8, v48
  v_mul_f32 v9, v9, v48
  v_mul_f32 v10, v10, v48
  v_mul_f32 v11, v11, v48
  v_mul_f32 v12, v12, v48
  v_mul_f32 v13, v13, v48
  v_mul_f32 v14, v14, v48
  v_mul_f32 v15, v15, v48
  v_mul_f32 v16, v16, v48
  v_mul_f32 v17, v17, v48
  v_mul_f32 v18, v18, v48
  v_mul_f32 v19, v19, v48
  v_mul_f32 v20, v20, v48
  v_mul_f32 v21, v21, v48
  v_mul_f32 v22, v22, v48
  v_mul_f32 v23, v23, v48
  v_mov_b32_dpp v32, v8 row_ror:8 row_mask:0xf bank_mask:0xf
  v_mov_b32_dpp v33, v9 row_ror:8 row_mask:0xf bank_mask:0xf
  v_mov_b32_dpp v34, v10 row_ror:8 row_mask:0xf bank_mask:0xf
  v_mov_b32_dpp v35, v11 row_ror:8 row_mask:0xf bank_mask:0xf
  v_mov_b32_dpp v36, v12 row_ror:8 row_mask:0xf bank_mask:0xf
  v_mov_b32_dpp v37, v13 row_ror:8 row_mask:0xf bank_mask:0xf
  v_mov_b32_dpp v38, v14 row_ror:8 row_mask:0xf bank_mask:0xf
  v_mov_b32_dpp v39, v15 row_ror:8 row_mask:0xf bank_mask:0xf
  v_cvt_pk_bf16_f32 v8, v8, v32
  v_cvt_pk_bf16_f32 v9, v9, v33
  v_cvt_pk_bf16_f32 v10, v10, v34
  v_cvt_pk_bf16_f32 v11, v11, v35
  v_cvt_pk_bf16_f32 v12, v12, v36
  v_cvt_pk_bf16_f32 v13, v13, v37
  v_cvt_pk_bf16_f32 v14, v14, v38
  v_cvt_pk_bf16_f32 v15, v15, v39
  s_waitcnt vmcnt(8)
  s_cmp_eq_u32 s68, 0
  s_cbranch_scc1 L_pw_96
  s_waitcnt vmcnt(7)
  s_cmp_eq_u32 s68, 1
  s_cbranch_scc1 L_pw_96
  s_waitcnt vmcnt(6)
  s_cmp_eq_u32 s68, 2
  s_cbranch_scc1 L_pw_96
  s_nop 0
  s_waitcnt vmcnt(5)
  s_cmp_eq_u32 s68, 3
  s_cbranch_scc1 L_pw_96
  s_waitcnt vmcnt(4)
L_pw_96:
  buffer_load_dwordx4 v[208:211], v1, s[44:47], s56 offen offset:0 nt
  v_mov_b32_dpp v32, v16 row_ror:8 row_mask:0xf bank_mask:0xf
  v_mov_b32_dpp v33, v17 row_ror:8 row_mask:0xf bank_mask:0xf
  v_mov_b32_dpp v34, v18 row_ror:8 row_mask:0xf bank_mask:0xf
  v_mov_b32_dpp v35, v19 row_ror:8 row_mask:0xf bank_mask:0xf
  v_mov_b32_dpp v36, v20 row_ror:8 row_mask:0xf bank_mask:0xf
  v_mov_b32_dpp v37, v21 row_ror:8 row_mask:0xf bank_mask:0xf
  v_mov_b32_dpp v38, v22 row_ror:8 row_mask:0xf bank_mask:0xf
  v_mov_b32_dpp v39, v23 row_ror:8 row_mask:0xf bank_mask:0xf
  v_cvt_pk_bf16_f32 v16, v16, v32
  v_cvt_pk_bf16_f32 v17, v17, v33
  v_cvt_pk_bf16_f32 v18, v18, v34
  v_cvt_pk_bf16_f32 v19, v19, v35
  v_cvt_pk_bf16_f32 v20, v20, v36
  v_cvt_pk_bf16_f32 v21, v21, v37
  v_cvt_pk_bf16_f32 v22, v22, v38
  v_cvt_pk_bf16_f32 v23, v23, v39
  s_waitcnt vmcnt(8)
  s_cmp_eq_u32 s68, 0
  s_cbranch_scc1 L_pw_97
  s_waitcnt vmcnt(7)
  s_cmp_eq_u32 s68, 1
  s_cbranch_scc1 L_pw_97
  s_waitcnt vmcnt(6)
  s_cmp_eq_u32 s68, 2
  s_cbranch_scc1 L_pw_97
  s_nop 0
  s_waitcnt vmcnt(5)
  s_cmp_eq_u32 s68, 3
  s_cbranch_scc1 L_pw_97
  s_waitcnt vmcnt(4)
L_pw_97:
  buffer_load_dwordx4 v[212:215], v1, s[44:47], s56 offen offset:1024 nt
  ds_write2st64_b32 v2, v12, v13 offset0:4 offset1:5
  ds_write2st64_b32 v2, v14, v15 offset0:6 offset1:7
  ds_write2st64_b32 v2, v16, v17 offset0:8 offset1:9
  ds_write2st64_b32 v2, v18, v19 offset0:10 offset1:11
  ds_write2st64_b32 v2, v20, v21 offset0:12 offset1:13
  ds_write2st64_b32 v2, v22, v23 offset0:14 offset1:15
  v_mov_b32 v24, 0
  v_mov_b32 v25, 0
  v_mov_b32 v26, 0
  v_mov_b32 v27, 0
  v_mov_b32 v28, 0
  v_mov_b32 v29, 0
  v_mov_b32_e64 v30, 0
  v_mov_b32 v31, 0
  s_waitcnt vmcnt(6)
  v_perm_b32 v32, v132, v128, s64
  v_perm_b32 v33, v132, v128, s65
  v_perm_b32 v34, v133, v129, s64
  v_perm_b32 v35, v133, v129, s65
  v_perm_b32 v36, v134, v130, s64
  v_perm_b32 v37, v134, v130, s65
  v_perm_b32 v38, v135, v131, s64
  v_perm_b32 v39, v135, v131, s65
  s_waitcnt vmcnt(8)
  s_cmp_eq_u32 s68, 0
  s_cbranch_scc1 L_pw_98
  s_waitcnt vmcnt(7)
  s_cmp_eq_u32 s68, 1
  s_cbranch_scc1 L_pw_98
  s_waitcnt vmcnt(6)
  s_cmp_eq_u32 s68, 2
  s_cbranch_scc1 L_pw_98
  s_nop 0
  s_waitcnt vmcnt(5)
  s_cmp_eq_u32 s68, 3
  s_cbranch_scc1 L_pw_98
  s_waitcnt vmcnt(4)
L_pw_98:
  buffer_load_dwordx4 v[216:219], v1, s[44:47], s56 offen offset:2048 nt
  v_dot2c_f32_bf16_dpp v24, v9, v32 row_newbcast:0 row_mask:0xf bank_mask:0xf
  v_dot2c_f32_bf16_dpp v25, v9, v33 row_newbcast:0 row_mask:0xf bank_mask:0xf
  v_dot2c_f32_bf16_dpp v26, v9, v34 row_newbcast:0 row_mask:0xf bank_mask:0xf
  v_dot2c_f32_bf16_dpp v27, v9, v35 row_newbcast:0 row_mask:0xf bank_mask:0xf
  v_dot2c_f32_bf16_dpp v28, v9, v36 row_newbcast:0 row_mask:0xf bank_mask:0xf
  v_dot2c_f32_bf16_dpp v29, v9, v37 row_newbcast:0 row_mask:0xf bank_mask:0xf
  v_dot2c_f32_bf16_dpp v30, v9, v38 row_newbcast:0 row_mask:0xf bank_mask:0xf
  v_dot2c_f32_bf16_dpp v31, v9, v39 row_newbcast:0 row_mask:0xf bank_mask:0xf
  v_perm_b32 v32, v140, v136, s64
  v_perm_b32 v33, v140, v136, s65
  v_perm_b32 v34, v141, v137, s64
  v_perm_b32 v35, v141, v137, s65
  v_perm_b32 v36, v142, v138, s64
  v_perm_b32 v37, v142, v138, s65
  v_perm_b32 v38, v143, v139, s64
  v_perm_b32 v39, v143, v139, s65
  s_waitcnt vmcnt(8)
  s_cmp_eq_u32 s68, 0
  s_cbranch_scc1 L_pw_99
  s_waitcnt vmcnt(7)
  s_cmp_eq_u32 s68, 1
  s_cbranch_scc1 L_pw_99
  s_waitcnt vmcnt(6)
  s_cmp_eq_u32 s68, 2
  s_cbranch_scc1 L_pw_99
  s_nop 0
  s_waitcnt vmcnt(5)
  s_cmp_eq_u32 s68, 3
  s_cbranch_scc1 L_pw_99
  s_waitcnt vmcnt(4)
L_pw_99:
  buffer_load_dwordx4 v[220:223], v1, s[44:47], s56 offen offset:3072 nt
  s_add_u32 s56, s56, 16384
  v_dot2c_f32_bf16_dpp v24, v9, v32 row_newbcast:4 row_mask:0xf bank_mask:0xf
  v_dot2c_f32_bf16_dpp v25, v9, v33 row_newbcast:4 row_mask:0xf bank_mask:0xf
  v_dot2c_f32_bf16_dpp v26, v9, v34 row_newbcast:4 row_mask:0xf bank_mask:0xf
  v_dot2c_f32_bf16_dpp v27, v9, v35 row_newbcast:4 row_mask:0xf bank_mask:0xf
  v_dot2c_f32_bf16_dpp v28, v9, v36 row_newbcast:4 row_mask:0xf bank_mask:0xf
  v_dot2c_f32_bf16_dpp v29, v9, v37 row_newbcast:4 row_mask:0xf bank_mask:0xf
  v_dot2c_f32_bf16_dpp v30, v9, v38 row_newbcast:4 row_mask:0xf bank_mask:0xf
  v_dot2c_f32_bf16_dpp v31, v9, v39 row_newbcast:4 row_mask:0xf bank_mask:0xf
  v_perm_b32 v32, v148, v144, s64
  v_perm_b32 v33, v148, v144, s65
  v_perm_b32 v34, v149, v145, s64
  v_perm_b32 v35, v149, v145, s65
  v_perm_b32 v36, v150, v146, s64
  v_perm_b32 v37, v150, v146, s65
  v_perm_b32 v38, v151, v147, s64
  v_perm_b32 v39, v151, v147, s65
  s_waitcnt vmcnt(8)
  s_cmp_eq_u32 s68, 0
  s_cbranch_scc1 L_pw_100
  s_waitcnt vmcnt(7)
  s_cmp_eq_u32 s68, 1
  s_cbranch_scc1 L_pw_100
  s_waitcnt vmcnt(6)
  s_cmp_eq_u32 s68, 2
  s_cbranch_scc1 L_pw_100
  s_nop 0
  s_waitcnt vmcnt(5)
  s_cmp_eq_u32 s68, 3
  s_cbranch_scc1 L_pw_100
  s_waitcnt vmcnt(4)
L_pw_100:
  buffer_load_dwordx4 v[224:227], v1, s[44:47], s56 offen offset:0 nt
  v_dot2c_f32_bf16_dpp v24, v9, v32 row_newbcast:2 row_mask:0xf bank_mask:0xf
  v_dot2c_f32_bf16_dpp v25, v9, v33 row_newbcast:2 row_mask:0xf bank_mask:0xf
  v_dot2c_f32_bf16_dpp v26, v9, v34 row_newbcast:2 row_mask:0xf bank_mask:0xf
  v_dot2c_f32_bf16_dpp v27, v9, v35 row_newbcast:2 row_mask:0xf bank_mask:0xf
  v_dot2c_f32_bf16_dpp v28, v9, v36 row_newbcast:2 row_mask:0xf bank_mask:0xf
  v_dot2c_f32_bf16_dpp v29, v9, v37 row_newbcast:2 row_mask:0xf bank_mask:0xf
  v_dot2c_f32_bf16_dpp v30, v9, v38 row_newbcast:2 row_mask:0xf bank_mask:0xf
  v_dot2c_f32_bf16_dpp v31, v9, v39 row_newbcast:2 row_mask:0xf bank_mask:0xf
  v_perm_b32 v32, v156, v152, s64
  v_perm_b32 v33, v156, v152, s65
  v_perm_b32 v34, v157, v153, s64
  v_perm_b32 v35, v157, v153, s65
  v_perm_b32 v36, v158, v154, s64
  v_perm_b32 v37, v158, v154, s65
  v_perm_b32 v38, v159, v155, s64
  v_perm_b32 v39, v159, v155, s65
  s_waitcnt vmcnt(8)
  s_cmp_eq_u32 s68, 0
  s_cbranch_scc1 L_pw_101
  s_waitcnt vmcnt(7)
  s_cmp_eq_u32 s68, 1
  s_cbranch_scc1 L_pw_101
  s_waitcnt vmcnt(6)
  s_cmp_eq_u32 s68, 2
  s_cbranch_scc1 L_pw_101
  s_waitcnt vmcnt(5)
  s_cmp_eq_u32 s68, 3
  s_cbranch_scc1 L_pw_101
  s_waitcnt vmcnt(4)
L_pw_101:
  buffer_load_dwordx4 v[228:231], v1, s[44:47], s56 offen offset:1024 nt
  s_waitcnt vmcnt(8)
  s_cmp_eq_u32 s68, 0
  s_cbranch_scc1 L_pw_102
  s_waitcnt vmcnt(7)
  s_cmp_eq_u32 s68, 1
  s_cbranch_scc1 L_pw_102
  s_waitcnt vmcnt(6)
  s_cmp_eq_u32 s68, 2
  s_cbranch_scc1 L_pw_102
  s_waitcnt vmcnt(5)
  s_cmp_eq_u32 s68, 3
  s_cbranch_scc1 L_pw_102
  s_waitcnt vmcnt(4)
L_pw_102:
  buffer_load_dwordx4 v[232:235], v1, s[44:47], s56 offen offset:2048 nt
  v_dot2c_f32_bf16_dpp v24, v9, v32 row_newbcast:6 row_mask:0xf bank_mask:0xf
  v_dot2c_f32_bf16_dpp v25, v9, v33 row_newbcast:6 row_mask:0xf bank_mask:0xf
  v_dot2c_f32_bf16_dpp v26, v9, v34 row_newbcast:6 row_mask:0xf bank_mask:0xf
  v_dot2c_f32_bf16_dpp v27, v9, v35 row_newbcast:6 row_mask:0xf bank_mask:0xf
  v_dot2c_f32_bf16_dpp v28, v9, v36 row_newbcast:6 row_mask:0xf bank_mask:0xf
  v_dot2c_f32_bf16_dpp v29, v9, v37 row_newbcast:6 row_mask:0xf bank_mask:0xf
  v_dot2c_f32_bf16_dpp v30, v9, v38 row_newbcast:6 row_mask:0xf bank_mask:0xf
  v_dot2c_f32_bf16_dpp v31, v9, v39 row_newbcast:6 row_mask:0xf bank_mask:0xf
  v_perm_b32 v32, v164, v160, s64
  v_perm_b32 v33, v164, v160, s65
  v_perm_b32 v34, v165, v161, s64
  v_perm_b32 v35, v165, v161, s65
  v_perm_b32 v36, v166, v162, s64
  v_perm_b32 v37, v166, v162, s65
  v_perm_b32 v38, v167, v163, s64
  v_perm_b32 v39, v167, v163, s65
  s_waitcnt vmcnt(8)
  s_cmp_eq_u32 s68, 0
  s_cbranch_scc1 L_pw_103
  s_waitcnt vmcnt(7)
  s_cmp_eq_u32 s68, 1
  s_cbranch_scc1 L_pw_103
  s_waitcnt vmcnt(6)
  s_cmp_eq_u32 s68, 2
  s_cbranch_scc1 L_pw_103
  s_nop 0
  s_waitcnt vmcnt(5)
  s_cmp_eq_u32 s68, 3
  s_cbranch_scc1 L_pw_103
  s_waitcnt vmcnt(4)
L_pw_103:
  buffer_load_dwordx4 v[236:239], v1, s[44:47], s56 offen offset:3072 nt
  s_add_u32 s56, s56, 16384
  v_dot2c_f32_bf16_dpp v24, v9, v32 row_newbcast:1 row_mask:0xf bank_mask:0xf
  v_dot2c_f32_bf16_dpp v25, v9, v33 row_newbcast:1 row_mask:0xf bank_mask:0xf
  v_dot2c_f32_bf16_dpp v26, v9, v34 row_newbcast:1 row_mask:0xf bank_mask:0xf
  v_dot2c_f32_bf16_dpp v27, v9, v35 row_newbcast:1 row_mask:0xf bank_mask:0xf
  v_dot2c_f32_bf16_dpp v28, v9, v36 row_newbcast:1 row_mask:0xf bank_mask:0xf
  v_dot2c_f32_bf16_dpp v29, v9, v37 row_newbcast:1 row_mask:0xf bank_mask:0xf
  v_dot2c_f32_bf16_dpp v30, v9, v38 row_newbcast:1 row_mask:0xf bank_mask:0xf
  v_dot2c_f32_bf16_dpp v31, v9, v39 row_newbcast:1 row_mask:0xf bank_mask:0xf
  v_perm_b32 v32, v172, v168, s64
  v_perm_b32 v33, v172, v168, s65
  v_perm_b32 v34, v173, v169, s64
  v_perm_b32 v35, v173, v169, s65
  v_perm_b32 v36, v174, v170, s64
  v_perm_b32 v37, v174, v170, s65
  v_perm_b32 v38, v175, v171, s64
  v_perm_b32 v39, v175, v171, s65
  s_waitcnt vmcnt(8)
  s_cmp_eq_u32 s68, 0
  s_cbranch_scc1 L_pw_104
  s_waitcnt vmcnt(7)
  s_cmp_eq_u32 s68, 1
  s_cbranch_scc1 L_pw_104
  s_waitcnt vmcnt(6)
  s_cmp_eq_u32 s68, 2
  s_cbranch_scc1 L_pw_104
  s_nop 0
  s_waitcnt vmcnt(5)
  s_cmp_eq_u32 s68, 3
  s_cbranch_scc1 L_pw_104
  s_waitcnt vmcnt(4)
L_pw_104:
  buffer_load_dwordx4 v[240:243], v1, s[44:47], s56 offen offset:0 nt
  v_dot2c_f32_bf16_dpp v24, v9, v32 row_newbcast:5 row_mask:0xf bank_mask:0xf
  v_dot2c_f32_bf16_dpp v25, v9, v33 row_newbcast:5 row_mask:0xf bank_mask:0xf
  v_dot2c_f32_bf16_dpp v26, v9, v34 row_newbcast:5 row_mask:0xf bank_mask:0xf
  v_dot2c_f32_bf16_dpp v27, v9, v35 row_newbcast:5 row_mask:0xf bank_mask:0xf
  v_dot2c_f32_bf16_dpp v28, v9, v36 row_newbcast:5 row_mask:0xf bank_mask:0xf
  v_dot2c_f32_bf16_dpp v29, v9, v37 row_newbcast:5 row_mask:0xf bank_mask:0xf
  v_dot2c_f32_bf16_dpp v30, v9, v38 row_newbcast:5 row_mask:0xf bank_mask:0xf
  v_dot2c_f32_bf16_dpp v31, v9, v39 row_newbcast:5 row_mask:0xf bank_mask:0xf
  v_perm_b32 v32, v180, v176, s64
  v_perm_b32 v33, v180, v176, s65
  v_perm_b32 v34, v181, v177, s64
  v_perm_b32 v35, v181, v177, s65
  v_perm_b32 v36, v182, v178, s64
  v_perm_b32 v37, v182, v178, s65
  v_perm_b32 v38, v183, v179, s64
  v_perm_b32 v39, v183, v179, s65
  s_waitcnt vmcnt(8)
  s_cmp_eq_u32 s68, 0
  s_cbranch_scc1 L_pw_105
  s_waitcnt vmcnt(7)
  s_cmp_eq_u32 s68, 1
  s_cbranch_scc1 L_pw_105
  s_waitcnt vmcnt(6)
  s_cmp_eq_u32 s68, 2
  s_cbranch_scc1 L_pw_105
  s_nop 0
  s_waitcnt vmcnt(5)
  s_cmp_eq_u32 s68, 3
  s_cbranch_scc1 L_pw_105
  s_waitcnt vmcnt(4)
L_pw_105:
  buffer_load_dwordx4 v[244:247], v1, s[44:47], s56 offen offset:1024 nt
  v_dot2c_f32_bf16_dpp v24, v9, v32 row_newbcast:3 row_mask:0xf bank_mask:0xf
  v_dot2c_f32_bf16_dpp v25, v9, v33 row_newbcast:3 row_mask:0xf bank_mask:0xf
  v_dot2c_f32_bf16_dpp v26, v9, v34 row_newbcast:3 row_mask:0xf bank_mask:0xf
  v_dot2c_f32_bf16_dpp v27, v9, v35 row_newbcast:3 row_mask:0xf bank_mask:0xf
  v_dot2c_f32_bf16_dpp v28, v9, v36 row_newbcast:3 row_mask:0xf bank_mask:0xf
  v_dot2c_f32_bf16_dpp v29, v9, v37 row_newbcast:3 row_mask:0xf bank_mask:0xf
  v_dot2c_f32_bf16_dpp v30, v9, v38 row_newbcast:3 row_mask:0xf bank_mask:0xf
  v_dot2c_f32_bf16_dpp v31, v9, v39 row_newbcast:3 row_mask:0xf bank_mask:0xf
  v_perm_b32 v32, v188, v184, s64
  v_perm_b32 v33, v188, v184, s65
  v_perm_b32 v34, v189, v185, s64
  v_perm_b32 v35, v189, v185, s65
  v_perm_b32 v36, v190, v186, s64
  v_perm_b32 v37, v190, v186, s65
  v_perm_b32 v38, v191, v187, s64
  v_perm_b32 v39, v191, v187, s65
  s_waitcnt vmcnt(8)
  s_cmp_eq_u32 s68, 0
  s_cbranch_scc1 L_pw_106
  s_waitcnt vmcnt(7)
  s_cmp_eq_u32 s68, 1
  s_cbranch_scc1 L_pw_106
  s_waitcnt vmcnt(6)
  s_cmp_eq_u32 s68, 2
  s_cbranch_scc1 L_pw_106
  s_waitcnt vmcnt(5)
  s_cmp_eq_u32 s68, 3
  s_cbranch_scc1 L_pw_106
  s_waitcnt vmcnt(4)
L_pw_106:
  buffer_load_dwordx4 v[248:251], v1, s[44:47], s56 offen offset:2048 nt
  s_waitcnt vmcnt(8)
  s_cmp_eq_u32 s68, 0
  s_cbranch_scc1 L_pw_107
  s_waitcnt vmcnt(7)
  s_cmp_eq_u32 s68, 1
  s_cbranch_scc1 L_pw_107
  s_waitcnt vmcnt(6)
  s_cmp_eq_u32 s68, 2
  s_cbranch_scc1 L_pw_107
  s_waitcnt vmcnt(5)
  s_cmp_eq_u32 s68, 3
  s_cbranch_scc1 L_pw_107
  s_waitcnt vmcnt(4)
L_pw_107:
  buffer_load_dwordx4 v[252:255], v1, s[44:47], s56 offen offset:3072 nt
  s_add_u32 s56, s56, 16384
  v_dot2c_f32_bf16_dpp v24, v9, v32 row_newbcast:7 row_mask:0xf bank_mask:0xf
  v_dot2c_f32_bf16_dpp v25, v9, v33 row_newbcast:7 row_mask:0xf bank_mask:0xf
  v_dot2c_f32_bf16_dpp v26, v9, v34 row_newbcast:7 row_mask:0xf bank_mask:0xf
  v_dot2c_f32_bf16_dpp v27, v9, v35 row_newbcast:7 row_mask:0xf bank_mask:0xf
  v_dot2c_f32_bf16_dpp v28, v9, v36 row_newbcast:7 row_mask:0xf bank_mask:0xf
  v_dot2c_f32_bf16_dpp v29, v9, v37 row_newbcast:7 row_mask:0xf bank_mask:0xf
  v_dot2c_f32_bf16_dpp v30, v9, v38 row_newbcast:7 row_mask:0xf bank_mask:0xf
  v_dot2c_f32_bf16_dpp v31, v9, v39 row_newbcast:7 row_mask:0xf bank_mask:0xf
  s_memrealtime s[72:73]
  ds_read_b32 v52, v60 offset:16
  s_waitcnt lgkmcnt(0)
  v_readfirstlane_b32 s73, v52
  s_sub_u32 s72, s72, 4655
  s_sub_u32 s71, s72, s73
  s_mov_b32 s68, 4
  s_cmp_gt_i32 s71, -110
  s_cselect_b32 s68, 3, s68
  s_cmp_gt_i32 s71, -20
  s_cselect_b32 s68, 2, s68
  s_cmp_gt_i32 s71, 50
  s_cselect_b32 s68, 1, s68
  s_cmp_gt_i32 s71, 90
  s_cselect_b32 s68, 0, s68
  s_cmp_lg_u32 s3, 0
  s_cbranch_scc1 L_ct_108
  s_cmp_eq_u32 s48, 0
  s_cbranch_scc1 L_cm_109
  v_mov_b32 v54, s72
  v_mov_b32_e64 v55, s67
  s_add_u32 s50, s48, s49
  s_mov_b64 exec, 1
  buffer_store_dwordx2 v[54:55], v60, s[52:55], s50 offen sc1
  s_mov_b64 exec, -1
L_cm_109:
  s_add_u32 s49, s49, 256
L_ct_108:
  s_cmp_lg_u32 s3, 0
  s_cbranch_scc1 L_ml_110
  buffer_load_dwordx2 v[50:51], v53, s[52:55], s49 offen
L_ml_110:
  s_waitcnt vmcnt(7)
  s_cmp_eq_u32 s68, 0
  s_cbranch_scc1 L_pw_111
  s_waitcnt vmcnt(6)
  s_cmp_eq_u32 s68, 1
  s_cbranch_scc1 L_pw_111
  s_waitcnt vmcnt(5)
  s_cmp_eq_u32 s68, 2
  s_cbranch_scc1 L_pw_111
  s_waitcnt vmcnt(4)
  s_cmp_eq_u32 s68, 3
  s_cbranch_scc1 L_pw_111
  s_waitcnt vmcnt(3)
L_pw_111:
  v_perm_b32 v32, v68, v64, s64
  v_perm_b32 v33, v68, v64, s65
  v_perm_b32 v34, v69, v65, s64
  v_perm_b32 v35, v69, v65, s65
  v_perm_b32 v36, v70, v66, s64
  v_perm_b32 v37, v70, v66, s65
  v_perm_b32 v38, v71, v67, s64
  v_perm_b32 v39, v71, v67, s65
  buffer_load_dwordx4 v[64:67], v1, s[44:47], s56 offen offset:0 nt
  buffer_load_dwordx4 v[68:71], v1, s[44:47], s56 offen offset:1024 nt
  v_dot2c_f32_bf16_dpp v24, v8, v32 row_newbcast:0 row_mask:0xf bank_mask:0xf
  v_dot2c_f32_bf16_dpp v25, v8, v33 row_newbcast:0 row_mask:0xf bank_mask:0xf
  v_dot2c_f32_bf16_dpp v26, v8, v34 row_newbcast:0 row_mask:0xf bank_mask:0xf
  v_dot2c_f32_bf16_dpp v27, v8, v35 row_newbcast:0 row_mask:0xf bank_mask:0xf
  v_dot2c_f32_bf16_dpp v28, v8, v36 row_newbcast:0 row_mask:0xf bank_mask:0xf
  v_dot2c_f32_bf16_dpp v29, v8, v37 row_newbcast:0 row_mask:0xf bank_mask:0xf
  v_dot2c_f32_bf16_dpp v30, v8, v38 row_newbcast:0 row_mask:0xf bank_mask:0xf
  v_dot2c_f32_bf16_dpp v31, v8, v39 row_newbcast:0 row_mask:0xf bank_mask:0xf
  s_waitcnt vmcnt(7)
  s_cmp_eq_u32 s68, 0
  s_cbranch_scc1 L_pw_112
  s_waitcnt vmcnt(6)
  s_cmp_eq_u32 s68, 1
  s_cbranch_scc1 L_pw_112
  s_waitcnt vmcnt(5)
  s_cmp_eq_u32 s68, 2
  s_cbranch_scc1 L_pw_112
  s_nop 0
  s_waitcnt vmcnt(4)
  s_cmp_eq_u32 s68, 3
  s_cbranch_scc1 L_pw_112
  s_waitcnt vmcnt(3)
L_pw_112:
  v_perm_b32 v32, v76, v72, s64
  v_perm_b32 v33, v76, v72, s65
  v_perm_b32 v34, v77, v73, s64
  v_perm_b32 v35, v77, v73, s65
  v_perm_b32 v36, v78, v74, s64
  v_perm_b32 v37, v78, v74, s65
  v_perm_b32 v38, v79, v75, s64
  v_perm_b32 v39, v79, v75, s65
  buffer_load_dwordx4 v[72:75], v1, s[44:47], s56 offen offset:2048 nt
  buffer_load_dwordx4 v[76:79], v1, s[44:47], s56 offen offset:3072 nt
  s_add_u32 s56, s56, 16384
  v_dot2c_f32_bf16_dpp v24, v8, v32 row_newbcast:4 row_mask:0xf bank_mask:0xf
  v_dot2c_f32_bf16_dpp v25, v8, v33 row_newbcast:4 row_mask:0xf bank_mask:0xf
  v_dot2c_f32_bf16_dpp v26, v8, v34 row_newbcast:4 row_mask:0xf bank_mask:0xf
  v_dot2c_f32_bf16_dpp v27, v8, v35 row_newbcast:4 row_mask:0xf bank_mask:0xf
  v_dot2c_f32_bf16_dpp v28, v8, v36 row_newbcast:4 row_mask:0xf bank_mask:0xf
  v_dot2c_f32_bf16_dpp v29, v8, v37 row_newbcast:4 row_mask:0xf bank_mask:0xf
  v_dot2c_f32_bf16_dpp v30, v8, v38 row_newbcast:4 row_mask:0xf bank_mask:0xf
  v_dot2c_f32_bf16_dpp v31, v8, v39 row_newbcast:4 row_mask:0xf bank_mask:0xf
  s_waitcnt vmcnt(7)
  s_cmp_eq_u32 s68, 0
  s_cbranch_scc1 L_pw_113
  s_waitcnt vmcnt(6)
  s_cmp_eq_u32 s68, 1
  s_cbranch_scc1 L_pw_113
  s_waitcnt vmcnt(5)
  s_cmp_eq_u32 s68, 2
  s_cbranch_scc1 L_pw_113
  s_nop 0
  s_waitcnt vmcnt(4)
  s_cmp_eq_u32 s68, 3
  s_cbranch_scc1 L_pw_113
  s_waitcnt vmcnt(3)
L_pw_113:
  v_perm_b32 v32, v84, v80, s64
  v_perm_b32 v33, v84, v80, s65
  v_perm_b32 v34, v85, v81, s64
  v_perm_b32 v35, v85, v81, s65
  v_perm_b32 v36, v86, v82, s64
  v_perm_b32 v37, v86, v82, s65
  v_perm_b32 v38, v87, v83, s64
  v_perm_b32 v39, v87, v83, s65
  buffer_load_dwordx4 v[80:83], v1, s[44:47], s56 offen offset:0 nt
  buffer_load_dwordx4 v[84:87], v1, s[44:47], s56 offen offset:1024 nt
  v_dot2c_f32_bf16_dpp v24, v8, v32 row_newbcast:2 row_mask:0xf bank_mask:0xf
  v_dot2c_f32_bf16_dpp v25, v8, v33 row_newbcast:2 row_mask:0xf bank_mask:0xf
  v_dot2c_f32_bf16_dpp v26, v8, v34 row_newbcast:2 row_mask:0xf bank_mask:0xf
  v_dot2c_f32_bf16_dpp v27, v8, v35 row_newbcast:2 row_mask:0xf bank_mask:0xf
  v_dot2c_f32_bf16_dpp v28, v8, v36 row_newbcast:2 row_mask:0xf bank_mask:0xf
  v_dot2c_f32_bf16_dpp v29, v8, v37 row_newbcast:2 row_mask:0xf bank_mask:0xf
  v_dot2c_f32_bf16_dpp v30, v8, v38 row_newbcast:2 row_mask:0xf bank_mask:0xf
  v_dot2c_f32_bf16_dpp v31, v8, v39 row_newbcast:2 row_mask:0xf bank_mask:0xf
  s_waitcnt vmcnt(7)
  s_cmp_eq_u32 s68, 0
  s_cbranch_scc1 L_pw_114
  s_waitcnt vmcnt(6)
  s_cmp_eq_u32 s68, 1
  s_cbranch_scc1 L_pw_114
  s_waitcnt vmcnt(5)
  s_cmp_eq_u32 s68, 2
  s_cbranch_scc1 L_pw_114
  s_nop 0
  s_waitcnt vmcnt(4)
  s_cmp_eq_u32 s68, 3
  s_cbranch_scc1 L_pw_114
  s_waitcnt vmcnt(3)
L_pw_114:
  v_perm_b32 v32, v92, v88, s64
  v_perm_b32 v33, v92, v88, s65
  v_perm_b32 v34, v93, v89, s64
  v_perm_b32 v35, v93, v89, s65
  v_perm_b32 v36, v94, v90, s64
  v_perm_b32 v37, v94, v90, s65
  v_perm_b32 v38, v95, v91, s64
  v_perm_b32 v39, v95, v91, s65
  buffer_load_dwordx4 v[88:91], v1, s[44:47], s56 offen offset:2048 nt
  buffer_load_dwordx4 v[92:95], v1, s[44:47], s56 offen offset:3072 nt
  s_add_u32 s56, s56, 16384
  v_dot2c_f32_bf16_dpp v24, v8, v32 row_newbcast:6 row_mask:0xf bank_mask:0xf
  v_dot2c_f32_bf16_dpp v25, v8, v33 row_newbcast:6 row_mask:0xf bank_mask:0xf
  v_dot2c_f32_bf16_dpp v26, v8, v34 row_newbcast:6 row_mask:0xf bank_mask:0xf
  v_dot2c_f32_bf16_dpp v27, v8, v35 row_newbcast:6 row_mask:0xf bank_mask:0xf
  v_dot2c_f32_bf16_dpp v28, v8, v36 row_newbcast:6 row_mask:0xf bank_mask:0xf
  v_dot2c_f32_bf16_dpp v29, v8, v37 row_newbcast:6 row_mask:0xf bank_mask:0xf
  v_dot2c_f32_bf16_dpp v30, v8, v38 row_newbcast:6 row_mask:0xf bank_mask:0xf
  v_dot2c_f32_bf16_dpp v31, v8, v39 row_newbcast:6 row_mask:0xf bank_mask:0xf
  s_waitcnt vmcnt(7)
  s_cmp_eq_u32 s68, 0
  s_cbranch_scc1 L_pw_115
  s_waitcnt vmcnt(6)
  s_cmp_eq_u32 s68, 1
  s_cbranch_scc1 L_pw_115
  s_waitcnt vmcnt(5)
  s_cmp_eq_u32 s68, 2
  s_cbranch_scc1 L_pw_115
  s_nop 0
  s_waitcnt vmcnt(4)
  s_cmp_eq_u32 s68, 3
  s_cbranch_scc1 L_pw_115
  s_waitcnt vmcnt(3)
L_pw_115:
  v_perm_b32 v32, v100, v96, s64
  v_perm_b32 v33, v100, v96, s65
  v_perm_b32 v34, v101, v97, s64
  v_perm_b32 v35, v101, v97, s65
  v_perm_b32 v36, v102, v98, s64
  v_perm_b32 v37, v102, v98, s65
  v_perm_b32 v38, v103, v99, s64
  v_perm_b32 v39, v103, v99, s65
  buffer_load_dwordx4 v[96:99], v1, s[44:47], s56 offen offset:0 nt
  buffer_load_dwordx4 v[100:103], v1, s[44:47], s56 offen offset:1024 nt
  v_dot2c_f32_bf16_dpp v24, v8, v32 row_newbcast:1 row_mask:0xf bank_mask:0xf
  v_dot2c_f32_bf16_dpp v25, v8, v33 row_newbcast:1 row_mask:0xf bank_mask:0xf
  v_dot2c_f32_bf16_dpp v26, v8, v34 row_newbcast:1 row_mask:0xf bank_mask:0xf
  v_dot2c_f32_bf16_dpp v27, v8, v35 row_newbcast:1 row_mask:0xf bank_mask:0xf
  v_dot2c_f32_bf16_dpp v28, v8, v36 row_newbcast:1 row_mask:0xf bank_mask:0xf
  v_dot2c_f32_bf16_dpp v29, v8, v37 row_newbcast:1 row_mask:0xf bank_mask:0xf
  v_dot2c_f32_bf16_dpp v30, v8, v38 row_newbcast:1 row_mask:0xf bank_mask:0xf
  v_dot2c_f32_bf16_dpp v31, v8, v39 row_newbcast:1 row_mask:0xf bank_mask:0xf
  s_memrealtime s[72:73]
  ds_read_b32 v52, v60 offset:16
  s_waitcnt vmcnt(7)
  s_cmp_eq_u32 s68, 0
  s_cbranch_scc1 L_pw_116
  s_waitcnt vmcnt(6)
  s_cmp_eq_u32 s68, 1
  s_cbranch_scc1 L_pw_116
  s_waitcnt vmcnt(5)
  s_cmp_eq_u32 s68, 2
  s_cbranch_scc1 L_pw_116
  s_nop 0
  s_waitcnt vmcnt(4)
  s_cmp_eq_u32 s68, 3
  s_cbranch_scc1 L_pw_116
  s_waitcnt vmcnt(3)
L_pw_116:
  v_perm_b32 v32, v108, v104, s64
  v_perm_b32 v33, v108, v104, s65
  v_perm_b32 v34, v109, v105, s64
  v_perm_b32 v35, v109, v105, s65
  v_perm_b32 v36, v110, v106, s64
  v_perm_b32 v37, v110, v106, s65
  v_perm_b32 v38, v111, v107, s64
  v_perm_b32 v39, v111, v107, s65
  buffer_load_dwordx4 v[104:107], v1, s[44:47], s56 offen offset:2048 nt
  buffer_load_dwordx4 v[108:111], v1, s[44:47], s56 offen offset:3072 nt
  s_add_u32 s56, s56, 16384
  v_dot2c_f32_bf16_dpp v24, v8, v32 row_newbcast:5 row_mask:0xf bank_mask:0xf
  v_dot2c_f32_bf16_dpp v25, v8, v33 row_newbcast:5 row_mask:0xf bank_mask:0xf
  v_dot2c_f32_bf16_dpp v26, v8, v34 row_newbcast:5 row_mask:0xf bank_mask:0xf
  v_dot2c_f32_bf16_dpp v27, v8, v35 row_newbcast:5 row_mask:0xf bank_mask:0xf
  v_dot2c_f32_bf16_dpp v28, v8, v36 row_newbcast:5 row_mask:0xf bank_mask:0xf
  v_dot2c_f32_bf16_dpp v29, v8, v37 row_newbcast:5 row_mask:0xf bank_mask:0xf
  v_dot2c_f32_bf16_dpp v30, v8, v38 row_newbcast:5 row_mask:0xf bank_mask:0xf
  v_dot2c_f32_bf16_dpp v31, v8, v39 row_newbcast:5 row_mask:0xf bank_mask:0xf
  s_waitcnt vmcnt(7)
  s_cmp_eq_u32 s68, 0
  s_cbranch_scc1 L_pw_117
  s_waitcnt vmcnt(6)
  s_cmp_eq_u32 s68, 1
  s_cbranch_scc1 L_pw_117
  s_waitcnt vmcnt(5)
  s_cmp_eq_u32 s68, 2
  s_cbranch_scc1 L_pw_117
  s_nop 0
  s_waitcnt vmcnt(4)
  s_cmp_eq_u32 s68, 3
  s_cbranch_scc1 L_pw_117
  s_waitcnt vmcnt(3)
L_pw_117:
  v_perm_b32 v32, v116, v112, s64
  v_perm_b32 v33, v116, v112, s65
  v_perm_b32 v34, v117, v113, s64
  v_perm_b32 v35, v117, v113, s65
  v_perm_b32 v36, v118, v114, s64
  v_perm_b32 v37, v118, v114, s65
  v_perm_b32 v38, v119, v115, s64
  v_perm_b32 v39, v119, v115, s65
  buffer_load_dwordx4 v[112:115], v1, s[44:47], s56 offen offset:0 nt
  buffer_load_dwordx4 v[116:119], v1, s[44:47], s56 offen offset:1024 nt
  v_dot2c_f32_bf16_dpp v24, v8, v32 row_newbcast:3 row_mask:0xf bank_mask:0xf
  v_dot2c_f32_bf16_dpp v25, v8, v33 row_newbcast:3 row_mask:0xf bank_mask:0xf
  v_dot2c_f32_bf16_dpp v26, v8, v34 row_newbcast:3 row_mask:0xf bank_mask:0xf
  v_dot2c_f32_bf16_dpp v27, v8, v35 row_newbcast:3 row_mask:0xf bank_mask:0xf
  v_dot2c_f32_bf16_dpp v28, v8, v36 row_newbcast:3 row_mask:0xf bank_mask:0xf
  v_dot2c_f32_bf16_dpp v29, v8, v37 row_newbcast:3 row_mask:0xf bank_mask:0xf
  v_dot2c_f32_bf16_dpp v30, v8, v38 row_newbcast:3 row_mask:0xf bank_mask:0xf
  v_dot2c_f32_bf16_dpp v31, v8, v39 row_newbcast:3 row_mask:0xf bank_mask:0xf
  s_waitcnt lgkmcnt(0)
  v_readfirstlane_b32 s73, v52
  s_sub_u32 s72, s72, 4791
  s_sub_u32 s71, s72, s73
  s_mov_b32 s68, 4
  s_cmp_gt_i32 s71, -110
  s_cselect_b32 s68, 3, s68
  s_cmp_gt_i32 s71, -20
  s_cselect_b32 s68, 2, s68
  s_cmp_gt_i32 s71, 50
  s_cselect_b32 s68, 1, s68
  s_cmp_gt_i32 s71, 90
  s_cselect_b32 s68, 0, s68
  s_cmp_lg_u32 s3, 0
  s_cbranch_scc1 L_ct_118
  s_cmp_eq_u32 s48, 0
  s_cbranch_scc1 L_cm_119
  v_mov_b32 v54, s72
  v_mov_b32 v55, s67
  s_add_u32 s50, s48, s49
  s_mov_b64 exec, 1
  buffer_store_dwordx2 v[54:55], v60, s[52:55], s50 offen sc1
  s_mov_b64 exec, -1
L_cm_119:
  s_add_u32 s49, s49, 256
  v_cmp_ne_u32 vcc, s67, v51
  v_subrev_u32 v56, s70, v50
  s_nop 0
  s_nop 0
  v_add_u32_dpp v56, v56, v56 quad_perm:[1,0,3,2] row_mask:0xf bank_mask:0xf
  s_nop 0
  s_nop 0
  v_add_u32_dpp v56, v56, v56 quad_perm:[2,3,0,1] row_mask:0xf bank_mask:0xf
  s_nop 0
  s_nop 0
  v_add_u32_dpp v56, v56, v56 row_half_mirror row_mask:0xf bank_mask:0xf
  v_ashrrev_i32 v56, 3, v56
  s_add_u32 s73, s70, 0
  v_add_u32_e64 v56, s73, v56
  s_cbranch_vccnz L_ct_118
  ds_write_b32 v60, v56 offset:16
L_ct_118:
  s_waitcnt vmcnt(7)
  s_cmp_eq_u32 s68, 0
  s_cbranch_scc1 L_pw_120
  s_waitcnt vmcnt(6)
  s_cmp_eq_u32 s68, 1
  s_cbranch_scc1 L_pw_120
  s_waitcnt vmcnt(5)
  s_cmp_eq_u32 s68, 2
  s_cbranch_scc1 L_pw_120
  s_waitcnt vmcnt(4)
  s_cmp_eq_u32 s68, 3
  s_cbranch_scc1 L_pw_120
  s_waitcnt vmcnt(3)
L_pw_120:
  v_perm_b32 v32, v124, v120, s64
  v_perm_b32 v33, v124, v120, s65
  v_perm_b32 v34, v125, v121, s64
  v_perm_b32 v35, v125, v121, s65
  v_perm_b32 v36, v126, v122, s64
  v_perm_b32 v37, v126, v122, s65
  v_perm_b32 v38, v127, v123, s64
  v_perm_b32 v39, v127, v123, s65
  buffer_load_dwordx4 v[120:123], v1, s[44:47], s56 offen offset:2048 nt
  buffer_load_dwordx4 v[124:127], v1, s[44:47], s56 offen offset:3072 nt
  s_add_u32 s56, s56, 16384
  v_dot2c_f32_bf16_dpp v24, v8, v32 row_newbcast:7 row_mask:0xf bank_mask:0xf
  v_dot2c_f32_bf16_dpp v25, v8, v33 row_newbcast:7 row_mask:0xf bank_mask:0xf
  v_dot2c_f32_bf16_dpp v26, v8, v34 row_newbcast:7 row_mask:0xf bank_mask:0xf
  v_dot2c_f32_bf16_dpp v27, v8, v35 row_newbcast:7 row_mask:0xf bank_mask:0xf
  v_dot2c_f32_bf16_dpp v28, v8, v36 row_newbcast:7 row_mask:0xf bank_mask:0xf
  v_dot2c_f32_bf16_dpp v29, v8, v37 row_newbcast:7 row_mask:0xf bank_mask:0xf
  v_dot2c_f32_bf16_dpp v30, v8, v38 row_newbcast:7 row_mask:0xf bank_mask:0xf
  v_dot2c_f32_bf16_dpp v31, v8, v39 row_newbcast:7 row_mask:0xf bank_mask:0xf
  v_add_u32 v47, 1280, v2
  s_cmp_lg_u32 s3, 0
  s_cbranch_scc1 L_ml_121
  buffer_load_dwordx2 v[50:51], v53, s[52:55], s49 offen
L_ml_121:
  s_waitcnt vmcnt(7)
  s_cmp_eq_u32 s68, 0
  s_cbranch_scc1 L_pw_122
  s_waitcnt vmcnt(6)
  s_cmp_eq_u32 s68, 1
  s_cbranch_scc1 L_pw_122
  s_waitcnt vmcnt(5)
  s_cmp_eq_u32 s68, 2
  s_cbranch_scc1 L_pw_122
  s_nop 0
  s_waitcnt vmcnt(4)
  s_cmp_eq_u32 s68, 3
  s_cbranch_scc1 L_pw_122
  s_waitcnt vmcnt(3)
L_pw_122:
  v_perm_b32 v32, v68, v64, s64
  v_perm_b32 v33, v68, v64, s65
  v_perm_b32 v34, v69, v65, s64
  v_perm_b32 v35, v69, v65, s65
  v_perm_b32 v36, v70, v66, s64
  v_perm_b32 v37, v70, v66, s65
  v_perm_b32 v38, v71, v67, s64
  v_perm_b32 v39, v71, v67, s65
  buffer_load_dwordx4 v[64:67], v1, s[44:47], s56 offen offset:0 nt
  buffer_load_dwordx4 v[68:71], v1, s[44:47], s56 offen offset:1024 nt
  v_dot2c_f32_bf16_dpp v24, v11, v32 row_newbcast:0 row_mask:0xf bank_mask:0xf
  v_dot2c_f32_bf16_dpp v25, v11, v33 row_newbcast:0 row_mask:0xf bank_mask:0xf
  v_dot2c_f32_bf16_dpp v26, v11, v34 row_newbcast:0 row_mask:0xf bank_mask:0xf
  v_dot2c_f32_bf16_dpp v27, v11, v35 row_newbcast:0 row_mask:0xf bank_mask:0xf
  v_dot2c_f32_bf16_dpp v28, v11, v36 row_newbcast:0 row_mask:0xf bank_mask:0xf
  v_dot2c_f32_bf16_dpp v29, v11, v37 row_newbcast:0 row_mask:0xf bank_mask:0xf
  v_dot2c_f32_bf16_dpp v30, v11, v38 row_newbcast:0 row_mask:0xf bank_mask:0xf
  v_dot2c_f32_bf16_dpp v31, v11, v39 row_newbcast:0 row_mask:0xf bank_mask:0xf
  v_perm_b32 v32, v196, v192, s64
  v_perm_b32 v33, v196, v192, s65
  v_perm_b32 v34, v197, v193, s64
  v_perm_b32 v35, v197, v193, s65
  v_perm_b32 v36, v198, v194, s64
  v_perm_b32 v37, v198, v194, s65
  v_perm_b32 v38, v199, v195, s64
  v_perm_b32 v39, v199, v195, s65
  v_dot2c_f32_bf16_dpp v24, v10, v32 row_newbcast:0 row_mask:0xf bank_mask:0xf
  v_dot2c_f32_bf16_dpp v25, v10, v33 row_newbcast:0 row_mask:0xf bank_mask:0xf
  v_dot2c_f32_bf16_dpp v26, v10, v34 row_newbcast:0 row_mask:0xf bank_mask:0xf
  v_dot2c_f32_bf16_dpp v27, v10, v35 row_newbcast:0 row_mask:0xf bank_mask:0xf
  v_dot2c_f32_bf16_dpp v28, v10, v36 row_newbcast:0 row_mask:0xf bank_mask:0xf
  v_dot2c_f32_bf16_dpp v29, v10, v37 row_newbcast:0 row_mask:0xf bank_mask:0xf
  v_dot2c_f32_bf16_dpp v30, v10, v38 row_newbcast:0 row_mask:0xf bank_mask:0xf
  v_dot2c_f32_bf16_dpp v31, v10, v39 row_newbcast:0 row_mask:0xf bank_mask:0xf
  s_waitcnt vmcnt(7)
  s_cmp_eq_u32 s68, 0
  s_cbranch_scc1 L_pw_123
  s_waitcnt vmcnt(6)
  s_cmp_eq_u32 s68, 1
  s_cbranch_scc1 L_pw_123
  s_waitcnt vmcnt(5)
  s_cmp_eq_u32 s68, 2
  s_cbranch_scc1 L_pw_123
  s_nop 0
  s_waitcnt vmcnt(4)
  s_cmp_eq_u32 s68, 3
  s_cbranch_scc1 L_pw_123
  s_waitcnt vmcnt(3)
L_pw_123:
  v_perm_b32 v32, v76, v72, s64
  v_perm_b32 v33, v76, v72, s65
  v_perm_b32 v34, v77, v73, s64
  v_perm_b32 v35, v77, v73, s65
  v_perm_b32 v36, v78, v74, s64
  v_perm_b32 v37, v78, v74, s65
  v_perm_b32 v38, v79, v75, s64
  v_perm_b32 v39, v79, v75, s65
  buffer_load_dwordx4 v[72:75], v1, s[44:47], s56 offen offset:2048 nt
  buffer_load_dwordx4 v[76:79], v1, s[44:47], s56 offen offset:3072 nt
  s_add_u32 s56, s56, 16384
  v_dot2c_f32_bf16_dpp v24, v11, v32 row_newbcast:4 row_mask:0xf bank_mask:0xf
  v_dot2c_f32_bf16_dpp v25, v11, v33 row_newbcast:4 row_mask:0xf bank_mask:0xf
  v_dot2c_f32_bf16_dpp v26, v11, v34 row_newbcast:4 row_mask:0xf bank_mask:0xf
  v_dot2c_f32_bf16_dpp v27, v11, v35 row_newbcast:4 row_mask:0xf bank_mask:0xf
  v_dot2c_f32_bf16_dpp v28, v11, v36 row_newbcast:4 row_mask:0xf bank_mask:0xf
  v_dot2c_f32_bf16_dpp v29, v11, v37 row_newbcast:4 row_mask:0xf bank_mask:0xf
  v_dot2c_f32_bf16_dpp v30, v11, v38 row_newbcast:4 row_mask:0xf bank_mask:0xf
  v_dot2c_f32_bf16_dpp v31, v11, v39 row_newbcast:4 row_mask:0xf bank_mask:0xf
  v_perm_b32 v32, v204, v200, s64
  v_perm_b32 v33, v204, v200, s65
  v_perm_b32 v34, v205, v201, s64
  v_perm_b32 v35, v205, v201, s65
  v_perm_b32 v36, v206, v202, s64
  v_perm_b32 v37, v206, v202, s65
  v_perm_b32 v38, v207, v203, s64
  v_perm_b32 v39, v207, v203, s65
  v_dot2c_f32_bf16_dpp v24, v10, v32 row_newbcast:4 row_mask:0xf bank_mask:0xf
  v_dot2c_f32_bf16_dpp v25, v10, v33 row_newbcast:4 row_mask:0xf bank_mask:0xf
  v_dot2c_f32_bf16_dpp v26, v10, v34 row_newbcast:4 row_mask:0xf bank_mask:0xf
  v_dot2c_f32_bf16_dpp v27, v10, v35 row_newbcast:4 row_mask:0xf bank_mask:0xf
  v_dot2c_f32_bf16_dpp v28, v10, v36 row_newbcast:4 row_mask:0xf bank_mask:0xf
  v_dot2c_f32_bf16_dpp v29, v10, v37 row_newbcast:4 row_mask:0xf bank_mask:0xf
  v_dot2c_f32_bf16_dpp v30, v10, v38 row_newbcast:4 row_mask:0xf bank_mask:0xf
  v_dot2c_f32_bf16_dpp v31, v10, v39 row_newbcast:4 row_mask:0xf bank_mask:0xf
  s_waitcnt vmcnt(7)
  s_cmp_eq_u32 s68, 0
  s_cbranch_scc1 L_pw_124
  s_waitcnt vmcnt(6)
  s_cmp_eq_u32 s68, 1
  s_cbranch_scc1 L_pw_124
  s_waitcnt vmcnt(5)
  s_cmp_eq_u32 s68, 2
  s_cbranch_scc1 L_pw_124
  s_nop 0
  s_waitcnt vmcnt(4)
  s_cmp_eq_u32 s68, 3
  s_cbranch_scc1 L_pw_124
  s_waitcnt vmcnt(3)
L_pw_124:
  v_perm_b32 v32, v84, v80, s64
  v_perm_b32 v33, v84, v80, s65
  v_perm_b32 v34, v85, v81, s64
  v_perm_b32 v35, v85, v81, s65
  v_perm_b32 v36, v86, v82, s64
  v_perm_b32 v37, v86, v82, s65
  v_perm_b32 v38, v87, v83, s64
  v_perm_b32 v39, v87, v83, s65
  buffer_load_dwordx4 v[80:83], v1, s[44:47], s56 offen offset:0 nt
  buffer_load_dwordx4 v[84:87], v1, s[44:47], s56 offen offset:1024 nt
  v_dot2c_f32_bf16_dpp v24, v11, v32 row_newbcast:2 row_mask:0xf bank_mask:0xf
  v_dot2c_f32_bf16_dpp v25, v11, v33 row_newbcast:2 row_mask:0xf bank_mask:0xf
  v_dot2c_f32_bf16_dpp v26, v11, v34 row_newbcast:2 row_mask:0xf bank_mask:0xf
  v_dot2c_f32_bf16_dpp v27, v11, v35 row_newbcast:2 row_mask:0xf bank_mask:0xf
  v_dot2c_f32_bf16_dpp v28, v11, v36 row_newbcast:2 row_mask:0xf bank_mask:0xf
  v_dot2c_f32_bf16_dpp v29, v11, v37 row_newbcast:2 row_mask:0xf bank_mask:0xf
  v_dot2c_f32_bf16_dpp v30, v11, v38 row_newbcast:2 row_mask:0xf bank_mask:0xf
  v_dot2c_f32_bf16_dpp v31, v11, v39 row_newbcast:2 row_mask:0xf bank_mask:0xf
  v_perm_b32 v32, v212, v208, s64
  v_perm_b32 v33, v212, v208, s65
  v_perm_b32 v34, v213, v209, s64
  v_perm_b32 v35, v213, v209, s65
  v_perm_b32 v36, v214, v210, s64
  v_perm_b32 v37, v214, v210, s65
  v_perm_b32 v38, v215, v211, s64
  v_perm_b32 v39, v215, v211, s65
  v_dot2c_f32_bf16_dpp v24, v10, v32 row_newbcast:2 row_mask:0xf bank_mask:0xf
  v_dot2c_f32_bf16_dpp v25, v10, v33 row_newbcast:2 row_mask:0xf bank_mask:0xf
  v_dot2c_f32_bf16_dpp v26, v10, v34 row_newbcast:2 row_mask:0xf bank_mask:0xf
  v_dot2c_f32_bf16_dpp v27, v10, v35 row_newbcast:2 row_mask:0xf bank_mask:0xf
  v_dot2c_f32_bf16_dpp v28, v10, v36 row_newbcast:2 row_mask:0xf bank_mask:0xf
  v_dot2c_f32_bf16_dpp v29, v10, v37 row_newbcast:2 row_mask:0xf bank_mask:0xf
  v_dot2c_f32_bf16_dpp v30, v10, v38 row_newbcast:2 row_mask:0xf bank_mask:0xf
  v_dot2c_f32_bf16_dpp v31, v10, v39 row_newbcast:2 row_mask:0xf bank_mask:0xf
  s_waitcnt vmcnt(7)
  s_cmp_eq_u32 s68, 0
  s_cbranch_scc1 L_pw_125
  s_waitcnt vmcnt(6)
  s_cmp_eq_u32 s68, 1
  s_cbranch_scc1 L_pw_125
  s_waitcnt vmcnt(5)
  s_cmp_eq_u32 s68, 2
  s_cbranch_scc1 L_pw_125
  s_nop 0
  s_waitcnt vmcnt(4)
  s_cmp_eq_u32 s68, 3
  s_cbranch_scc1 L_pw_125
  s_waitcnt vmcnt(3)
L_pw_125:
  v_perm_b32 v32, v92, v88, s64
  v_perm_b32 v33, v92, v88, s65
  v_perm_b32 v34, v93, v89, s64
  v_perm_b32 v35, v93, v89, s65
  v_perm_b32 v36, v94, v90, s64
  v_perm_b32 v37, v94, v90, s65
  v_perm_b32 v38, v95, v91, s64
  v_perm_b32 v39, v95, v91, s65
  buffer_load_dwordx4 v[88:91], v1, s[44:47], s56 offen offset:2048 nt
  buffer_load_dwordx4 v[92:95], v1, s[44:47], s56 offen offset:3072 nt
  s_add_u32 s56, s56, 16384
  v_dot2c_f32_bf16_dpp v24, v11, v32 row_newbcast:6 row_mask:0xf bank_mask:0xf
  v_dot2c_f32_bf16_dpp v25, v11, v33 row_newbcast:6 row_mask:0xf bank_mask:0xf
  v_dot2c_f32_bf16_dpp v26, v11, v34 row_newbcast:6 row_mask:0xf bank_mask:0xf
  v_dot2c_f32_bf16_dpp v27, v11, v35 row_newbcast:6 row_mask:0xf bank_mask:0xf
  v_dot2c_f32_bf16_dpp v28, v11, v36 row_newbcast:6 row_mask:0xf bank_mask:0xf
  v_dot2c_f32_bf16_dpp v29, v11, v37 row_newbcast:6 row_mask:0xf bank_mask:0xf
  v_dot2c_f32_bf16_dpp v30, v11, v38 row_newbcast:6 row_mask:0xf bank_mask:0xf
  v_dot2c_f32_bf16_dpp v31, v11, v39 row_newbcast:6 row_mask:0xf bank_mask:0xf
  v_perm_b32 v32, v220, v216, s64
  v_perm_b32 v33, v220, v216, s65
  v_perm_b32 v34, v221, v217, s64
  v_perm_b32 v35, v221, v217, s65
  v_perm_b32 v36, v222, v218, s64
  v_perm_b32 v37, v222, v218, s65
  v_perm_b32 v38, v223, v219, s64
  v_perm_b32 v39, v223, v219, s65
  v_dot2c_f32_bf16_dpp v24, v10, v32 row_newbcast:6 row_mask:0xf bank_mask:0xf
  v_dot2c_f32_bf16_dpp v25, v10, v33 row_newbcast:6 row_mask:0xf bank_mask:0xf
  v_dot2c_f32_bf16_dpp v26, v10, v34 row_newbcast:6 row_mask:0xf bank_mask:0xf
  v_dot2c_f32_bf16_dpp v27, v10, v35 row_newbcast:6 row_mask:0xf bank_mask:0xf
  v_dot2c_f32_bf16_dpp v28, v10, v36 row_newbcast:6 row_mask:0xf bank_mask:0xf
  v_dot2c_f32_bf16_dpp v29, v10, v37 row_newbcast:6 row_mask:0xf bank_mask:0xf
  v_dot2c_f32_bf16_dpp v30, v10, v38 row_newbcast:6 row_mask:0xf bank_mask:0xf
  v_dot2c_f32_bf16_dpp v31, v10, v39 row_newbcast:6 row_mask:0xf bank_mask:0xf
  s_waitcnt vmcnt(7)
  s_cmp_eq_u32 s68, 0
  s_cbranch_scc1 L_pw_126
  s_waitcnt vmcnt(6)
  s_cmp_eq_u32 s68, 1
  s_cbranch_scc1 L_pw_126
  s_waitcnt vmcnt(5)
  s_cmp_eq_u32 s68, 2
  s_cbranch_scc1 L_pw_126
  s_nop 0
  s_waitcnt vmcnt(4)
  s_cmp_eq_u32 s68, 3
  s_cbranch_scc1 L_pw_126
  s_waitcnt vmcnt(3)
L_pw_126:
  v_perm_b32 v32, v100, v96, s64
  v_perm_b32 v33, v100, v96, s65
  v_perm_b32 v34, v101, v97, s64
  v_perm_b32 v35, v101, v97, s65
  v_perm_b32 v36, v102, v98, s64
  v_perm_b32 v37, v102, v98, s65
  v_perm_b32 v38, v103, v99, s64
  v_perm_b32 v39, v103, v99, s65
  buffer_load_dwordx4 v[96:99], v1, s[44:47], s56 offen offset:0 nt
  buffer_load_dwordx4 v[100:103], v1, s[44:47], s56 offen offset:1024 nt
  v_dot2c_f32_bf16_dpp v24, v11, v32 row_newbcast:1 row_mask:0xf bank_mask:0xf
  v_dot2c_f32_bf16_dpp v25, v11, v33 row_newbcast:1 row_mask:0xf bank_mask:0xf
  v_dot2c_f32_bf16_dpp v26, v11, v34 row_newbcast:1 row_mask:0xf bank_mask:0xf
  v_dot2c_f32_bf16_dpp v27, v11, v35 row_newbcast:1 row_mask:0xf bank_mask:0xf
  v_dot2c_f32_bf16_dpp v28, v11, v36 row_newbcast:1 row_mask:0xf bank_mask:0xf
  v_dot2c_f32_bf16_dpp v29, v11, v37 row_newbcast:1 row_mask:0xf bank_mask:0xf
  v_dot2c_f32_bf16_dpp v30, v11, v38 row_newbcast:1 row_mask:0xf bank_mask:0xf
  v_dot2c_f32_bf16_dpp v31, v11, v39 row_newbcast:1 row_mask:0xf bank_mask:0xf
  v_perm_b32 v32, v228, v224, s64
  v_perm_b32 v33, v228, v224, s65
  v_perm_b32 v34, v229, v225, s64
  v_perm_b32 v35, v229, v225, s65
  v_perm_b32 v36, v230, v226, s64
  v_perm_b32 v37, v230, v226, s65
  v_perm_b32 v38, v231, v227, s64
  v_perm_b32 v39, v231, v227, s65
  v_dot2c_f32_bf16_dpp v24, v10, v32 row_newbcast:1 row_mask:0xf bank_mask:0xf
  v_dot2c_f32_bf16_dpp v25, v10, v33 row_newbcast:1 row_mask:0xf bank_mask:0xf
  v_dot2c_f32_bf16_dpp v26, v10, v34 row_newbcast:1 row_mask:0xf bank_mask:0xf
  v_dot2c_f32_bf16_dpp v27, v10, v35 row_newbcast:1 row_mask:0xf bank_mask:0xf
  v_dot2c_f32_bf16_dpp v28, v10, v36 row_newbcast:1 row_mask:0xf bank_mask:0xf
  v_dot2c_f32_bf16_dpp v29, v10, v37 row_newbcast:1 row_mask:0xf bank_mask:0xf
  v_dot2c_f32_bf16_dpp v30, v10, v38 row_newbcast:1 row_mask:0xf bank_mask:0xf
  v_dot2c_f32_bf16_dpp v31, v10, v39 row_newbcast:1 row_mask:0xf bank_mask:0xf
  s_memrealtime s[72:73]
  ds_read_b32 v52, v60 offset:16
  s_waitcnt vmcnt(7)
  s_cmp_eq_u32 s68, 0
  s_cbranch_scc1 L_pw_127
  s_waitcnt vmcnt(6)
  s_cmp_eq_u32 s68, 1
  s_cbranch_scc1 L_pw_127
  s_waitcnt vmcnt(5)
  s_cmp_eq_u32 s68, 2
  s_cbranch_scc1 L_pw_127
  s_nop 0
  s_waitcnt vmcnt(4)
  s_cmp_eq_u32 s68, 3
  s_cbranch_scc1 L_pw_127
  s_waitcnt vmcnt(3)
L_pw_127:
  v_perm_b32 v32, v108, v104, s64
  v_perm_b32 v33, v108, v104, s65
  v_perm_b32 v34, v109, v105, s64
  v_perm_b32 v35, v109, v105, s65
  v_perm_b32 v36, v110, v106, s64
  v_perm_b32 v37, v110, v106, s65
  v_perm_b32 v38, v111, v107, s64
  v_perm_b32 v39, v111, v107, s65
  buffer_load_dwordx4 v[104:107], v1, s[44:47], s56 offen offset:2048 nt
  buffer_load_dwordx4 v[108:111], v1, s[44:47], s56 offen offset:3072 nt
  s_add_u32 s56, s56, 16384
  v_dot2c_f32_bf16_dpp v24, v11, v32 row_newbcast:5 row_mask:0xf bank_mask:0xf
  v_dot2c_f32_bf16_dpp v25, v11, v33 row_newbcast:5 row_mask:0xf bank_mask:0xf
  v_dot2c_f32_bf16_dpp v26, v11, v34 row_newbcast:5 row_mask:0xf bank_mask:0xf
  v_dot2c_f32_bf16_dpp v27, v11, v35 row_newbcast:5 row_mask:0xf bank_mask:0xf
  v_dot2c_f32_bf16_dpp v28, v11, v36 row_newbcast:5 row_mask:0xf bank_mask:0xf
  v_dot2c_f32_bf16_dpp v29, v11, v37 row_newbcast:5 row_mask:0xf bank_mask:0xf
  v_dot2c_f32_bf16_dpp v30, v11, v38 row_newbcast:5 row_mask:0xf bank_mask:0xf
  v_dot2c_f32_bf16_dpp v31, v11, v39 row_newbcast:5 row_mask:0xf bank_mask:0xf
  v_perm_b32 v32, v236, v232, s64
  v_perm_b32 v33, v236, v232, s65
  v_perm_b32 v34, v237, v233, s64
  v_perm_b32 v35, v237, v233, s65
  v_perm_b32 v36, v238, v234, s64
  v_perm_b32 v37, v238, v234, s65
  v_perm_b32 v38, v239, v235, s64
  v_perm_b32 v39, v239, v235, s65
  v_dot2c_f32_bf16_dpp v24, v10, v32 row_newbcast:5 row_mask:0xf bank_mask:0xf
  v_dot2c_f32_bf16_dpp v25, v10, v33 row_newbcast:5 row_mask:0xf bank_mask:0xf
  v_dot2c_f32_bf16_dpp v26, v10, v34 row_newbcast:5 row_mask:0xf bank_mask:0xf
  v_dot2c_f32_bf16_dpp v27, v10, v35 row_newbcast:5 row_mask:0xf bank_mask:0xf
  v_dot2c_f32_bf16_dpp v28, v10, v36 row_newbcast:5 row_mask:0xf bank_mask:0xf
  v_dot2c_f32_bf16_dpp v29, v10, v37 row_newbcast:5 row_mask:0xf bank_mask:0xf
  v_dot2c_f32_bf16_dpp v30, v10, v38 row_newbcast:5 row_mask:0xf bank_mask:0xf
  v_dot2c_f32_bf16_dpp v31, v10, v39 row_newbcast:5 row_mask:0xf bank_mask:0xf
  s_waitcnt vmcnt(7)
  s_cmp_eq_u32 s68, 0
  s_cbranch_scc1 L_pw_128
  s_waitcnt vmcnt(6)
  s_cmp_eq_u32 s68, 1
  s_cbranch_scc1 L_pw_128
  s_waitcnt vmcnt(5)
  s_cmp_eq_u32 s68, 2
  s_cbranch_scc1 L_pw_128
  s_nop 0
  s_waitcnt vmcnt(4)
  s_cmp_eq_u32 s68, 3
  s_cbranch_scc1 L_pw_128
  s_waitcnt vmcnt(3)
L_pw_128:
  v_perm_b32 v32, v116, v112, s64
  v_perm_b32 v33, v116, v112, s65
  v_perm_b32 v34, v117, v113, s64
  v_perm_b32 v35, v117, v113, s65
  v_perm_b32 v36, v118, v114, s64
  v_perm_b32 v37, v118, v114, s65
  v_perm_b32 v38, v119, v115, s64
  v_perm_b32 v39, v119, v115, s65
  buffer_load_dwordx4 v[112:115], v1, s[44:47], s56 offen offset:0 nt
  buffer_load_dwordx4 v[116:119], v1, s[44:47], s56 offen offset:1024 nt
  v_dot2c_f32_bf16_dpp v24, v11, v32 row_newbcast:3 row_mask:0xf bank_mask:0xf
  v_dot2c_f32_bf16_dpp v25, v11, v33 row_newbcast:3 row_mask:0xf bank_mask:0xf
  v_dot2c_f32_bf16_dpp v26, v11, v34 row_newbcast:3 row_mask:0xf bank_mask:0xf
  v_dot2c_f32_bf16_dpp v27, v11, v35 row_newbcast:3 row_mask:0xf bank_mask:0xf
  v_dot2c_f32_bf16_dpp v28, v11, v36 row_newbcast:3 row_mask:0xf bank_mask:0xf
  v_dot2c_f32_bf16_dpp v29, v11, v37 row_newbcast:3 row_mask:0xf bank_mask:0xf
  v_dot2c_f32_bf16_dpp v30, v11, v38 row_newbcast:3 row_mask:0xf bank_mask:0xf
  v_dot2c_f32_bf16_dpp v31, v11, v39 row_newbcast:3 row_mask:0xf bank_mask:0xf
  v_perm_b32 v32, v244, v240, s64
  v_perm_b32 v33, v244, v240, s65
  v_perm_b32 v34, v245, v241, s64
  v_perm_b32 v35, v245, v241, s65
  v_perm_b32 v36, v246, v242, s64
  v_perm_b32 v37, v246, v242, s65
  v_perm_b32 v38, v247, v243, s64
  v_perm_b32 v39, v247, v243, s65
  v_dot2c_f32_bf16_dpp v24, v10, v32 row_newbcast:3 row_mask:0xf bank_mask:0xf
  v_dot2c_f32_bf16_dpp v25, v10, v33 row_newbcast:3 row_mask:0xf bank_mask:0xf
  v_dot2c_f32_bf16_dpp v26, v10, v34 row_newbcast:3 row_mask:0xf bank_mask:0xf
  v_dot2c_f32_bf16_dpp v27, v10, v35 row_newbcast:3 row_mask:0xf bank_mask:0xf
  v_dot2c_f32_bf16_dpp v28, v10, v36 row_newbcast:3 row_mask:0xf bank_mask:0xf
  v_dot2c_f32_bf16_dpp v29, v10, v37 row_newbcast:3 row_mask:0xf bank_mask:0xf
  v_dot2c_f32_bf16_dpp v30, v10, v38 row_newbcast:3 row_mask:0xf bank_mask:0xf
  v_dot2c_f32_bf16_dpp v31, v10, v39 row_newbcast:3 row_mask:0xf bank_mask:0xf
  s_waitcnt lgkmcnt(0)
  v_readfirstlane_b32 s73, v52
  s_sub_u32 s72, s72, 5009
  s_sub_u32 s71, s72, s73
  s_mov_b32 s68, 4
  s_cmp_gt_i32 s71, -110
  s_cselect_b32 s68, 3, s68
  s_cmp_gt_i32 s71, -20
  s_cselect_b32 s68, 2, s68
  s_cmp_gt_i32 s71, 50
  s_cselect_b32 s68, 1, s68
  s_cmp_gt_i32 s71, 90
  s_cselect_b32 s68, 0, s68
  s_cmp_lg_u32 s3, 0
  s_cbranch_scc1 L_ct_129
  s_cmp_eq_u32 s48, 0
  s_cbranch_scc1 L_cm_130
  v_mov_b32 v54, s72
  v_mov_b32 v55, s67
  s_add_u32 s50, s48, s49
  s_mov_b64 exec, 1
  buffer_store_dwordx2 v[54:55], v60, s[52:55], s50 offen sc1
  s_mov_b64 exec, -1
L_cm_130:
  s_add_u32 s49, s49, 256
  v_cmp_ne_u32 vcc, s67, v51
  v_subrev_u32 v56, s70, v50
  s_nop 0
  s_nop 0
  v_add_u32_dpp v56, v56, v56 quad_perm:[1,0,3,2] row_mask:0xf bank_mask:0xf
  s_nop 0
  s_nop 0
  v_add_u32_dpp v56, v56, v56 quad_perm:[2,3,0,1] row_mask:0xf bank_mask:0xf
  s_nop 0
  s_nop 0
  v_add_u32_dpp v56, v56, v56 row_half_mirror row_mask:0xf bank_mask:0xf
  v_ashrrev_i32 v56, 3, v56
  s_add_u32 s73, s70, 0
  v_add_u32_e64 v56, s73, v56
  s_cbranch_vccnz L_ct_129
  ds_write_b32 v60, v56 offset:16
L_ct_129:
  s_waitcnt vmcnt(7)
  s_cmp_eq_u32 s68, 0
  s_cbranch_scc1 L_pw_131
  s_waitcnt vmcnt(6)
  s_cmp_eq_u32 s68, 1
  s_cbranch_scc1 L_pw_131
  s_waitcnt vmcnt(5)
  s_cmp_eq_u32 s68, 2
  s_cbranch_scc1 L_pw_131
  s_waitcnt vmcnt(4)
  s_cmp_eq_u32 s68, 3
  s_cbranch_scc1 L_pw_131
  s_waitcnt vmcnt(3)
L_pw_131:
  v_perm_b32 v32, v124, v120, s64
  v_perm_b32 v33, v124, v120, s65
  v_perm_b32 v34, v125, v121, s64
  v_perm_b32 v35, v125, v121, s65
  v_perm_b32 v36, v126, v122, s64
  v_perm_b32 v37, v126, v122, s65
  v_perm_b32 v38, v127, v123, s64
  v_perm_b32 v39, v127, v123, s65
  buffer_load_dwordx4 v[120:123], v1, s[44:47], s56 offen offset:2048 nt
  buffer_load_dwordx4 v[124:127], v1, s[44:47], s56 offen offset:3072 nt
  s_add_u32 s56, s56, 16384
  v_dot2c_f32_bf16_dpp v24, v11, v32 row_newbcast:7 row_mask:0xf bank_mask:0xf
  v_dot2c_f32_bf16_dpp v25, v11, v33 row_newbcast:7 row_mask:0xf bank_mask:0xf
  v_dot2c_f32_bf16_dpp v26, v11, v34 row_newbcast:7 row_mask:0xf bank_mask:0xf
  v_dot2c_f32_bf16_dpp v27, v11, v35 row_newbcast:7 row_mask:0xf bank_mask:0xf
  v_dot2c_f32_bf16_dpp v28, v11, v36 row_newbcast:7 row_mask:0xf bank_mask:0xf
  v_dot2c_f32_bf16_dpp v29, v11, v37 row_newbcast:7 row_mask:0xf bank_mask:0xf
  v_dot2c_f32_bf16_dpp v30, v11, v38 row_newbcast:7 row_mask:0xf bank_mask:0xf
  v_dot2c_f32_bf16_dpp v31, v11, v39 row_newbcast:7 row_mask:0xf bank_mask:0xf
  v_perm_b32 v32, v252, v248, s64
  v_perm_b32 v33, v252, v248, s65
  v_perm_b32 v34, v253, v249, s64
  v_perm_b32 v35, v253, v249, s65
  v_perm_b32 v36, v254, v250, s64
  v_perm_b32 v37, v254, v250, s65
  v_perm_b32 v38, v255, v251, s64
  v_perm_b32 v39, v255, v251, s65
  v_dot2c_f32_bf16_dpp v24, v10, v32 row_newbcast:7 row_mask:0xf bank_mask:0xf
  v_dot2c_f32_bf16_dpp v25, v10, v33 row_newbcast:7 row_mask:0xf bank_mask:0xf
  v_dot2c_f32_bf16_dpp v26, v10, v34 row_newbcast:7 row_mask:0xf bank_mask:0xf
  v_dot2c_f32_bf16_dpp v27, v10, v35 row_newbcast:7 row_mask:0xf bank_mask:0xf
  v_dot2c_f32_bf16_dpp v28, v10, v36 row_newbcast:7 row_mask:0xf bank_mask:0xf
  v_dot2c_f32_bf16_dpp v29, v10, v37 row_newbcast:7 row_mask:0xf bank_mask:0xf
  v_dot2c_f32_bf16_dpp v30, v10, v38 row_newbcast:7 row_mask:0xf bank_mask:0xf
  v_dot2c_f32_bf16_dpp v31, v10, v39 row_newbcast:7 row_mask:0xf bank_mask:0xf
  v_mov_b32 v43, v12
  s_mov_b32 s57, 11
  s_mov_b32 s69, 5254
L_vloop:
  s_nop 7
  s_nop 3
  ds_read_b32 v44, v47
  v_add_u32 v47, 256, v47
  s_cmp_lg_u32 s3, 0
  s_cbranch_scc1 L_ml_132
  buffer_load_dwordx2 v[50:51], v53, s[52:55], s49 offen
L_ml_132:
  s_memrealtime s[72:73]
  ds_read_b32 v52, v60 offset:16
  s_waitcnt vmcnt(7)
  s_cmp_eq_u32 s68, 0
  s_cbranch_scc1 L_pw_133
  s_waitcnt vmcnt(6)
  s_cmp_eq_u32 s68, 1
  s_cbranch_scc1 L_pw_133
  s_waitcnt vmcnt(5)
  s_cmp_eq_u32 s68, 2
  s_cbranch_scc1 L_pw_133
  s_nop 0
  s_waitcnt vmcnt(4)
  s_cmp_eq_u32 s68, 3
  s_cbranch_scc1 L_pw_133
  s_waitcnt vmcnt(3)
L_pw_133:
  v_perm_b32 v32, v68, v64, s64
  v_perm_b32 v33, v68, v64, s65
  v_perm_b32 v34, v69, v65, s64
  v_perm_b32 v35, v69, v65, s65
  v_perm_b32 v36, v70, v66, s64
  v_perm_b32 v37, v70, v66, s65
  v_perm_b32 v38, v71, v67, s64
  v_perm_b32 v39, v71, v67, s65
  buffer_load_dwordx4 v[64:67], v1, s[44:47], s56 offen offset:0 nt
  buffer_load_dwordx4 v[68:71], v1, s[44:47], s56 offen offset:1024 nt
  v_dot2c_f32_bf16_dpp v24, v43, v32 row_newbcast:0 row_mask:0xf bank_mask:0xf
  v_dot2c_f32_bf16_dpp v25, v43, v33 row_newbcast:0 row_mask:0xf bank_mask:0xf
  v_dot2c_f32_bf16_dpp v26, v43, v34 row_newbcast:0 row_mask:0xf bank_mask:0xf
  v_dot2c_f32_bf16_dpp v27, v43, v35 row_newbcast:0 row_mask:0xf bank_mask:0xf
  v_dot2c_f32_bf16_dpp v28, v43, v36 row_newbcast:0 row_mask:0xf bank_mask:0xf
  v_dot2c_f32_bf16_dpp v29, v43, v37 row_newbcast:0 row_mask:0xf bank_mask:0xf
  v_dot2c_f32_bf16_dpp v30, v43, v38 row_newbcast:0 row_mask:0xf bank_mask:0xf
  v_dot2c_f32_bf16_dpp v31, v43, v39 row_newbcast:0 row_mask:0xf bank_mask:0xf
  s_waitcnt lgkmcnt(0)
  v_readfirstlane_b32 s73, v52
  s_sub_u32 s72, s72, s69
  s_sub_u32 s71, s72, s73
  s_mov_b32 s68, 4
  s_cmp_gt_i32 s71, -178
  s_cselect_b32 s68, 3, s68
  s_cmp_gt_i32 s71, -153
  s_cselect_b32 s68, 2, s68
  s_cmp_gt_i32 s71, -133
  s_cselect_b32 s68, 1, s68
  s_cmp_gt_i32 s71, -113
  s_cselect_b32 s68, 0, s68
  s_waitcnt vmcnt(7)
  s_cmp_eq_u32 s68, 0
  s_cbranch_scc1 L_pw_134
  s_waitcnt vmcnt(6)
  s_cmp_eq_u32 s68, 1
  s_cbranch_scc1 L_pw_134
  s_waitcnt vmcnt(5)
  s_cmp_eq_u32 s68, 2
  s_cbranch_scc1 L_pw_134
  s_waitcnt vmcnt(4)
  s_cmp_eq_u32 s68, 3
  s_cbranch_scc1 L_pw_134
  s_waitcnt vmcnt(3)
L_pw_134:
  v_perm_b32 v32, v76, v72, s64
  v_perm_b32 v33, v76, v72, s65
  v_perm_b32 v34, v77, v73, s64
  v_perm_b32 v35, v77, v73, s65
  v_perm_b32 v36, v78, v74, s64
  v_perm_b32 v37, v78, v74, s65
  v_perm_b32 v38, v79, v75, s64
  v_perm_b32 v39, v79, v75, s65
  buffer_load_dwordx4 v[72:75], v1, s[44:47], s56 offen offset:2048 nt
  buffer_load_dwordx4 v[76:79], v1, s[44:47], s56 offen offset:3072 nt
  s_add_u32 s56, s56, 16384
  v_dot2c_f32_bf16_dpp v24, v43, v32 row_newbcast:4 row_mask:0xf bank_mask:0xf
  v_dot2c_f32_bf16_dpp v25, v43, v33 row_newbcast:4 row_mask:0xf bank_mask:0xf
  v_dot2c_f32_bf16_dpp v26, v43, v34 row_newbcast:4 row_mask:0xf bank_mask:0xf
  v_dot2c_f32_bf16_dpp v27, v43, v35 row_newbcast:4 row_mask:0xf bank_mask:0xf
  v_dot2c_f32_bf16_dpp v28, v43, v36 row_newbcast:4 row_mask:0xf bank_mask:0xf
  v_dot2c_f32_bf16_dpp v29, v43, v37 row_newbcast:4 row_mask:0xf bank_mask:0xf
  v_dot2c_f32_bf16_dpp v30, v43, v38 row_newbcast:4 row_mask:0xf bank_mask:0xf
  v_dot2c_f32_bf16_dpp v31, v43, v39 row_newbcast:4 row_mask:0xf bank_mask:0xf
  s_memrealtime s[72:73]
  ds_read_b32 v52, v60 offset:16
  s_waitcnt vmcnt(7)
  s_cmp_eq_u32 s68, 0
  s_cbranch_scc1 L_pw_135
  s_waitcnt vmcnt(6)
  s_cmp_eq_u32 s68, 1
  s_cbranch_scc1 L_pw_135
  s_waitcnt vmcnt(5)
  s_cmp_eq_u32 s68, 2
  s_cbranch_scc1 L_pw_135
  s_nop 0
  s_waitcnt vmcnt(4)
  s_cmp_eq_u32 s68, 3
  s_cbranch_scc1 L_pw_135
  s_waitcnt vmcnt(3)
L_pw_135:
  v_perm_b32 v32, v84, v80, s64
  v_perm_b32 v33, v84, v80, s65
  v_perm_b32 v34, v85, v81, s64
  v_perm_b32 v35, v85, v81, s65
  v_perm_b32 v36, v86, v82, s64
  v_perm_b32 v37, v86, v82, s65
  v_perm_b32 v38, v87, v83, s64
  v_perm_b32 v39, v87, v83, s65
  buffer_load_dwordx4 v[80:83], v1, s[44:47], s56 offen offset:0 nt
  buffer_load_dwordx4 v[84:87], v1, s[44:47], s56 offen offset:1024 nt
  v_dot2c_f32_bf16_dpp v24, v43, v32 row_newbcast:2 row_mask:0xf bank_mask:0xf
  v_dot2c_f32_bf16_dpp v25, v43, v33 row_newbcast:2 row_mask:0xf bank_mask:0xf
  v_dot2c_f32_bf16_dpp v26, v43, v34 row_newbcast:2 row_mask:0xf bank_mask:0xf
  v_dot2c_f32_bf16_dpp v27, v43, v35 row_newbcast:2 row_mask:0xf bank_mask:0xf
  v_dot2c_f32_bf16_dpp v28, v43, v36 row_newbcast:2 row_mask:0xf bank_mask:0xf
  v_dot2c_f32_bf16_dpp v29, v43, v37 row_newbcast:2 row_mask:0xf bank_mask:0xf
  v_dot2c_f32_bf16_dpp v30, v43, v38 row_newbcast:2 row_mask:0xf bank_mask:0xf
  v_dot2c_f32_bf16_dpp v31, v43, v39 row_newbcast:2 row_mask:0xf bank_mask:0xf
  s_waitcnt lgkmcnt(0)
  v_readfirstlane_b32 s73, v52
  s_sub_u32 s72, s72, s69
  s_sub_u32 s71, s72, s73
  s_mov_b32 s68, 4
  s_cmp_gt_i32 s71, -124
  s_cselect_b32 s68, 3, s68
  s_cmp_gt_i32 s71, -99
  s_cselect_b32 s68, 2, s68
  s_cmp_gt_i32 s71, -79
  s_cselect_b32 s68, 1, s68
  s_cmp_gt_i32 s71, -59
  s_cselect_b32 s68, 0, s68
  s_waitcnt vmcnt(7)
  s_cmp_eq_u32 s68, 0
  s_cbranch_scc1 L_pw_136
  s_waitcnt vmcnt(6)
  s_cmp_eq_u32 s68, 1
  s_cbranch_scc1 L_pw_136
  s_waitcnt vmcnt(5)
  s_cmp_eq_u32 s68, 2
  s_cbranch_scc1 L_pw_136
  s_waitcnt vmcnt(4)
  s_cmp_eq_u32 s68, 3
  s_cbranch_scc1 L_pw_136
  s_waitcnt vmcnt(3)
L_pw_136:
  v_perm_b32 v32, v92, v88, s64
  v_perm_b32 v33, v92, v88, s65
  v_perm_b32 v34, v93, v89, s64
  v_perm_b32 v35, v93, v89, s65
  v_perm_b32 v36, v94, v90, s64
  v_perm_b32 v37, v94, v90, s65
  v_perm_b32 v38, v95, v91, s64
  v_perm_b32 v39, v95, v91, s65
  buffer_load_dwordx4 v[88:91], v1, s[44:47], s56 offen offset:2048 nt
  buffer_load_dwordx4 v[92:95], v1, s[44:47], s56 offen offset:3072 nt
  s_add_u32 s56, s56, 16384
  v_dot2c_f32_bf16_dpp v24, v43, v32 row_newbcast:6 row_mask:0xf bank_mask:0xf
  v_dot2c_f32_bf16_dpp v25, v43, v33 row_newbcast:6 row_mask:0xf bank_mask:0xf
  v_dot2c_f32_bf16_dpp v26, v43, v34 row_newbcast:6 row_mask:0xf bank_mask:0xf
  v_dot2c_f32_bf16_dpp v27, v43, v35 row_newbcast:6 row_mask:0xf bank_mask:0xf
  v_dot2c_f32_bf16_dpp v28, v43, v36 row_newbcast:6 row_mask:0xf bank_mask:0xf
  v_dot2c_f32_bf16_dpp v29, v43, v37 row_newbcast:6 row_mask:0xf bank_mask:0xf
  v_dot2c_f32_bf16_dpp v30, v43, v38 row_newbcast:6 row_mask:0xf bank_mask:0xf
  v_dot2c_f32_bf16_dpp v31, v43, v39 row_newbcast:6 row_mask:0xf bank_mask:0xf
  s_memrealtime s[72:73]
  ds_read_b32 v52, v60 offset:16
  s_waitcnt vmcnt(7)
  s_cmp_eq_u32 s68, 0
  s_cbranch_scc1 L_pw_137
  s_waitcnt vmcnt(6)
  s_cmp_eq_u32 s68, 1
  s_cbranch_scc1 L_pw_137
  s_waitcnt vmcnt(5)
  s_cmp_eq_u32 s68, 2
  s_cbranch_scc1 L_pw_137
  s_nop 0
  s_waitcnt vmcnt(4)
  s_cmp_eq_u32 s68, 3
  s_cbranch_scc1 L_pw_137
  s_waitcnt vmcnt(3)
L_pw_137:
  v_perm_b32 v32, v100, v96, s64
  v_perm_b32 v33, v100, v96, s65
  v_perm_b32 v34, v101, v97, s64
  v_perm_b32 v35, v101, v97, s65
  v_perm_b32 v36, v102, v98, s64
  v_perm_b32 v37, v102, v98, s65
  v_perm_b32 v38, v103, v99, s64
  v_perm_b32 v39, v103, v99, s65
  buffer_load_dwordx4 v[96:99], v1, s[44:47], s56 offen offset:0 nt
  buffer_load_dwordx4 v[100:103], v1, s[44:47], s56 offen offset:1024 nt
  v_dot2c_f32_bf16_dpp v24, v43, v32 row_newbcast:1 row_mask:0xf bank_mask:0xf
  v_dot2c_f32_bf16_dpp v25, v43, v33 row_newbcast:1 row_mask:0xf bank_mask:0xf
  v_dot2c_f32_bf16_dpp v26, v43, v34 row_newbcast:1 row_mask:0xf bank_mask:0xf
  v_dot2c_f32_bf16_dpp v27, v43, v35 row_newbcast:1 row_mask:0xf bank_mask:0xf
  v_dot2c_f32_bf16_dpp v28, v43, v36 row_newbcast:1 row_mask:0xf bank_mask:0xf
  v_dot2c_f32_bf16_dpp v29, v43, v37 row_newbcast:1 row_mask:0xf bank_mask:0xf
  v_dot2c_f32_bf16_dpp v30, v43, v38 row_newbcast:1 row_mask:0xf bank_mask:0xf
  v_dot2c_f32_bf16_dpp v31, v43, v39 row_newbcast:1 row_mask:0xf bank_mask:0xf
  s_nop 0
  s_waitcnt lgkmcnt(0)
  v_readfirstlane_b32 s73, v52
  s_sub_u32 s72, s72, s69
  s_sub_u32 s71, s72, s73
  s_mov_b32 s68, 4
  s_cmp_gt_i32 s71, -69
  s_cselect_b32 s68, 3, s68
  s_cmp_gt_i32 s71, -44
  s_cselect_b32 s68, 2, s68
  s_cmp_gt_i32 s71, -24
  s_cselect_b32 s68, 1, s68
  s_cmp_gt_i32 s71, -4
  s_cselect_b32 s68, 0, s68
  s_waitcnt vmcnt(7)
  s_cmp_eq_u32 s68, 0
  s_cbranch_scc1 L_pw_138
  s_waitcnt vmcnt(6)
  s_cmp_eq_u32 s68, 1
  s_cbranch_scc1 L_pw_138
  s_waitcnt vmcnt(5)
  s_cmp_eq_u32 s68, 2
  s_cbranch_scc1 L_pw_138
  s_waitcnt vmcnt(4)
  s_cmp_eq_u32 s68, 3
  s_cbranch_scc1 L_pw_138
  s_waitcnt vmcnt(3)
L_pw_138:
  v_perm_b32 v32, v108, v104, s64
  v_perm_b32 v33, v108, v104, s65
  v_perm_b32 v34, v109, v105, s64
  v_perm_b32 v35, v109, v105, s65
  v_perm_b32 v36, v110, v106, s64
  v_perm_b32 v37, v110, v106, s65
  v_perm_b32 v38, v111, v107, s64
  v_perm_b32 v39, v111, v107, s65
  buffer_load_dwordx4 v[104:107], v1, s[44:47], s56 offen offset:2048 nt
  buffer_load_dwordx4 v[108:111], v1, s[44:47], s56 offen offset:3072 nt
  s_add_u32 s56, s56, 16384
  v_dot2c_f32_bf16_dpp v24, v43, v32 row_newbcast:5 row_mask:0xf bank_mask:0xf
  v_dot2c_f32_bf16_dpp v25, v43, v33 row_newbcast:5 row_mask:0xf bank_mask:0xf
  v_dot2c_f32_bf16_dpp v26, v43, v34 row_newbcast:5 row_mask:0xf bank_mask:0xf
  v_dot2c_f32_bf16_dpp v27, v43, v35 row_newbcast:5 row_mask:0xf bank_mask:0xf
  v_dot2c_f32_bf16_dpp v28, v43, v36 row_newbcast:5 row_mask:0xf bank_mask:0xf
  v_dot2c_f32_bf16_dpp v29, v43, v37 row_newbcast:5 row_mask:0xf bank_mask:0xf
  v_dot2c_f32_bf16_dpp v30, v43, v38 row_newbcast:5 row_mask:0xf bank_mask:0xf
  v_dot2c_f32_bf16_dpp v31, v43, v39 row_newbcast:5 row_mask:0xf bank_mask:0xf
  s_memrealtime s[72:73]
  ds_read_b32 v52, v60 offset:16
  s_waitcnt vmcnt(7)
  s_cmp_eq_u32 s68, 0
  s_cbranch_scc1 L_pw_139
  s_waitcnt vmcnt(6)
  s_cmp_eq_u32 s68, 1
  s_cbranch_scc1 L_pw_139
  s_waitcnt vmcnt(5)
  s_cmp_eq_u32 s68, 2
  s_cbranch_scc1 L_pw_139
  s_nop 0
  s_waitcnt vmcnt(4)
  s_cmp_eq_u32 s68, 3
  s_cbranch_scc1 L_pw_139
  s_waitcnt vmcnt(3)
L_pw_139:
  v_perm_b32 v32, v116, v112, s64
  v_perm_b32 v33, v116, v112, s65
  v_perm_b32 v34, v117, v113, s64
  v_perm_b32 v35, v117, v113, s65
  v_perm_b32 v36, v118, v114, s64
  v_perm_b32 v37, v118, v114, s65
  v_perm_b32 v38, v119, v115, s64
  v_perm_b32 v39, v119, v115, s65
  buffer_load_dwordx4 v[112:115], v1, s[44:47], s56 offen offset:0 nt
  buffer_load_dwordx4 v[116:119], v1, s[44:47], s56 offen offset:1024 nt
  v_dot2c_f32_bf16_dpp v24, v43, v32 row_newbcast:3 row_mask:0xf bank_mask:0xf
  v_dot2c_f32_bf16_dpp v25, v43, v33 row_newbcast:3 row_mask:0xf bank_mask:0xf
  v_dot2c_f32_bf16_dpp v26, v43, v34 row_newbcast:3 row_mask:0xf bank_mask:0xf
  v_dot2c_f32_bf16_dpp v27, v43, v35 row_newbcast:3 row_mask:0xf bank_mask:0xf
  v_dot2c_f32_bf16_dpp v28, v43, v36 row_newbcast:3 row_mask:0xf bank_mask:0xf
  v_dot2c_f32_bf16_dpp v29, v43, v37 row_newbcast:3 row_mask:0xf bank_mask:0xf
  v_dot2c_f32_bf16_dpp v30, v43, v38 row_newbcast:3 row_mask:0xf bank_mask:0xf
  v_dot2c_f32_bf16_dpp v31, v43, v39 row_newbcast:3 row_mask:0xf bank_mask:0xf
  s_waitcnt lgkmcnt(0)
  v_readfirstlane_b32 s73, v52
  s_sub_u32 s72, s72, s69
  s_sub_u32 s71, s72, s73
  s_add_u32 s69, s69, 218
  s_mov_b32 s68, 4
  s_cmp_gt_i32 s71, -15
  s_cselect_b32 s68, 3, s68
  s_cmp_gt_i32 s71, 10
  s_cselect_b32 s68, 2, s68
  s_cmp_gt_i32 s71, 30
  s_cselect_b32 s68, 1, s68
  s_cmp_gt_i32 s71, 50
  s_cselect_b32 s68, 0, s68
  s_cmp_lg_u32 s3, 0
  s_cbranch_scc1 L_ct_140
  s_cmp_eq_u32 s48, 0
  s_cbranch_scc1 L_cm_141
  v_mov_b32 v54, s72
  v_mov_b32 v55, s67
  s_add_u32 s50, s48, s49
  s_mov_b64 exec, 1
  buffer_store_dwordx2 v[54:55], v60, s[52:55], s50 offen sc1
  s_mov_b64 exec, -1
L_cm_141:
  s_add_u32 s49, s49, 256
  v_cmp_ne_u32 vcc, s67, v51
  v_subrev_u32 v56, s70, v50
  s_nop 0
  s_nop 0
  v_add_u32_dpp v56, v56, v56 quad_perm:[1,0,3,2] row_mask:0xf bank_mask:0xf
  s_nop 0
  s_nop 0
  v_add_u32_dpp v56, v56, v56 quad_perm:[2,3,0,1] row_mask:0xf bank_mask:0xf
  s_nop 0
  s_nop 0
  v_add_u32_dpp v56, v56, v56 row_half_mirror row_mask:0xf bank_mask:0xf
  v_ashrrev_i32 v56, 3, v56
  s_add_u32 s73, s70, 0
  v_add_u32_e64 v56, s73, v56
  s_cbranch_vccnz L_ct_140
  ds_write_b32 v60, v56 offset:16
L_ct_140:
  s_waitcnt vmcnt(7)
  s_cmp_eq_u32 s68, 0
  s_cbranch_scc1 L_pw_142
  s_waitcnt vmcnt(6)
  s_cmp_eq_u32 s68, 1
  s_cbranch_scc1 L_pw_142
  s_waitcnt vmcnt(5)
  s_cmp_eq_u32 s68, 2
  s_cbranch_scc1 L_pw_142
  s_waitcnt vmcnt(4)
  s_cmp_eq_u32 s68, 3
  s_cbranch_scc1 L_pw_142
  s_waitcnt vmcnt(3)
L_pw_142:
  v_perm_b32 v32, v124, v120, s64
  v_perm_b32 v33, v124, v120, s65
  v_perm_b32 v34, v125, v121, s64
  v_perm_b32 v35, v125, v121, s65
  v_perm_b32 v36, v126, v122, s64
  v_perm_b32 v37, v126, v122, s65
  v_perm_b32 v38, v127, v123, s64
  v_perm_b32 v39, v127, v123, s65
  buffer_load_dwordx4 v[120:123], v1, s[44:47], s56 offen offset:2048 nt
  buffer_load_dwordx4 v[124:127], v1, s[44:47], s56 offen offset:3072 nt
  s_add_u32 s56, s56, 16384
  v_dot2c_f32_bf16_dpp v24, v43, v32 row_newbcast:7 row_mask:0xf bank_mask:0xf
  v_dot2c_f32_bf16_dpp v25, v43, v33 row_newbcast:7 row_mask:0xf bank_mask:0xf
  v_dot2c_f32_bf16_dpp v26, v43, v34 row_newbcast:7 row_mask:0xf bank_mask:0xf
  v_dot2c_f32_bf16_dpp v27, v43, v35 row_newbcast:7 row_mask:0xf bank_mask:0xf
  v_dot2c_f32_bf16_dpp v28, v43, v36 row_newbcast:7 row_mask:0xf bank_mask:0xf
  v_dot2c_f32_bf16_dpp v29, v43, v37 row_newbcast:7 row_mask:0xf bank_mask:0xf
  v_dot2c_f32_bf16_dpp v30, v43, v38 row_newbcast:7 row_mask:0xf bank_mask:0xf
  v_dot2c_f32_bf16_dpp v31, v43, v39 row_newbcast:7 row_mask:0xf bank_mask:0xf
  s_waitcnt lgkmcnt(0)
  v_mov_b32 v43, v44
  s_sub_u32 s57, s57, 1
  s_cmp_lg_u32 s57, 0
  s_cbranch_scc1 L_vloop
  v_lshlrev_b32 v41, 5, v45
  v_lshl_add_u32 v41, v46, 3, v41
  s_lshl_b32 s59, s3, 9
  v_add_u32 v41, s59, v41
  v_mov_b32 v42, 1
L_vlast:
  s_waitcnt vmcnt(14)
  v_perm_b32 v32, v68, v64, s64
  v_perm_b32 v33, v68, v64, s65
  v_perm_b32 v34, v69, v65, s64
  v_perm_b32 v35, v69, v65, s65
  v_perm_b32 v36, v70, v66, s64
  v_perm_b32 v37, v70, v66, s65
  v_perm_b32 v38, v71, v67, s64
  v_perm_b32 v39, v71, v67, s65
  v_dot2c_f32_bf16_dpp v24, v43, v32 row_newbcast:0 row_mask:0xf bank_mask:0xf
  v_dot2c_f32_bf16_dpp v25, v43, v33 row_newbcast:0 row_mask:0xf bank_mask:0xf
  v_dot2c_f32_bf16_dpp v26, v43, v34 row_newbcast:0 row_mask:0xf bank_mask:0xf
  v_dot2c_f32_bf16_dpp v27, v43, v35 row_newbcast:0 row_mask:0xf bank_mask:0xf
  v_dot2c_f32_bf16_dpp v28, v43, v36 row_newbcast:0 row_mask:0xf bank_mask:0xf
  v_dot2c_f32_bf16_dpp v29, v43, v37 row_newbcast:0 row_mask:0xf bank_mask:0xf
  v_dot2c_f32_bf16_dpp v30, v43, v38 row_newbcast:0 row_mask:0xf bank_mask:0xf
  v_dot2c_f32_bf16_dpp v31, v43, v39 row_newbcast:0 row_mask:0xf bank_mask:0xf
  s_nop 0
  s_waitcnt vmcnt(12)
  v_perm_b32 v32, v76, v72, s64
  v_perm_b32 v33, v76, v72, s65
  v_perm_b32 v34, v77, v73, s64
  v_perm_b32 v35, v77, v73, s65
  v_perm_b32 v36, v78, v74, s64
  v_perm_b32 v37, v78, v74, s65
  v_perm_b32 v38, v79, v75, s64
  v_perm_b32 v39, v79, v75, s65
  v_dot2c_f32_bf16_dpp v24, v43, v32 row_newbcast:4 row_mask:0xf bank_mask:0xf
  v_dot2c_f32_bf16_dpp v25, v43, v33 row_newbcast:4 row_mask:0xf bank_mask:0xf
  v_dot2c_f32_bf16_dpp v26, v43, v34 row_newbcast:4 row_mask:0xf bank_mask:0xf
  v_dot2c_f32_bf16_dpp v27, v43, v35 row_newbcast:4 row_mask:0xf bank_mask:0xf
  v_dot2c_f32_bf16_dpp v28, v43, v36 row_newbcast:4 row_mask:0xf bank_mask:0xf
  v_dot2c_f32_bf16_dpp v29, v43, v37 row_newbcast:4 row_mask:0xf bank_mask:0xf
  v_dot2c_f32_bf16_dpp v30, v43, v38 row_newbcast:4 row_mask:0xf bank_mask:0xf
  v_dot2c_f32_bf16_dpp v31, v43, v39 row_newbcast:4 row_mask:0xf bank_mask:0xf
  s_nop 0
  s_waitcnt vmcnt(10)
  v_perm_b32 v32, v84, v80, s64
  v_perm_b32 v33, v84, v80, s65
  v_perm_b32 v34, v85, v81, s64
  v_perm_b32 v35, v85, v81, s65
  v_perm_b32 v36, v86, v82, s64
  v_perm_b32 v37, v86, v82, s65
  v_perm_b32 v38, v87, v83, s64
  v_perm_b32 v39, v87, v83, s65
  v_dot2c_f32_bf16_dpp v24, v43, v32 row_newbcast:2 row_mask:0xf bank_mask:0xf
  v_dot2c_f32_bf16_dpp v25, v43, v33 row_newbcast:2 row_mask:0xf bank_mask:0xf
  v_dot2c_f32_bf16_dpp v26, v43, v34 row_newbcast:2 row_mask:0xf bank_mask:0xf
  v_dot2c_f32_bf16_dpp v27, v43, v35 row_newbcast:2 row_mask:0xf bank_mask:0xf
  v_dot2c_f32_bf16_dpp v28, v43, v36 row_newbcast:2 row_mask:0xf bank_mask:0xf
  v_dot2c_f32_bf16_dpp v29, v43, v37 row_newbcast:2 row_mask:0xf bank_mask:0xf
  v_dot2c_f32_bf16_dpp v30, v43, v38 row_newbcast:2 row_mask:0xf bank_mask:0xf
  v_dot2c_f32_bf16_dpp v31, v43, v39 row_newbcast:2 row_mask:0xf bank_mask:0xf
  s_nop 0
  s_waitcnt vmcnt(8)
  v_perm_b32 v32, v92, v88, s64
  v_perm_b32 v33, v92, v88, s65
  v_perm_b32 v34, v93, v89, s64
  v_perm_b32 v35, v93, v89, s65
  v_perm_b32 v36, v94, v90, s64
  v_perm_b32 v37, v94, v90, s65
  v_perm_b32 v38, v95, v91, s64
  v_perm_b32 v39, v95, v91, s65
  v_dot2c_f32_bf16_dpp v24, v43, v32 row_newbcast:6 row_mask:0xf bank_mask:0xf
  v_dot2c_f32_bf16_dpp v25, v43, v33 row_newbcast:6 row_mask:0xf bank_mask:0xf
  v_dot2c_f32_bf16_dpp v26, v43, v34 row_newbcast:6 row_mask:0xf bank_mask:0xf
  v_dot2c_f32_bf16_dpp v27, v43, v35 row_newbcast:6 row_mask:0xf bank_mask:0xf
  v_dot2c_f32_bf16_dpp v28, v43, v36 row_newbcast:6 row_mask:0xf bank_mask:0xf
  v_dot2c_f32_bf16_dpp v29, v43, v37 row_newbcast:6 row_mask:0xf bank_mask:0xf
  v_dot2c_f32_bf16_dpp v30, v43, v38 row_newbcast:6 row_mask:0xf bank_mask:0xf
  v_dot2c_f32_bf16_dpp v31, v43, v39 row_newbcast:6 row_mask:0xf bank_mask:0xf
  s_nop 0
  s_waitcnt vmcnt(6)
  v_perm_b32 v32, v100, v96, s64
  v_perm_b32 v33, v100, v96, s65
  v_perm_b32 v34, v101, v97, s64
  v_perm_b32 v35, v101, v97, s65
  v_perm_b32 v36, v102, v98, s64
  v_perm_b32 v37, v102, v98, s65
  v_perm_b32 v38, v103, v99, s64
  v_perm_b32 v39, v103, v99, s65
  v_dot2c_f32_bf16_dpp v24, v43, v32 row_newbcast:1 row_mask:0xf bank_mask:0xf
  v_dot2c_f32_bf16_dpp v25, v43, v33 row_newbcast:1 row_mask:0xf bank_mask:0xf
  v_dot2c_f32_bf16_dpp v26, v43, v34 row_newbcast:1 row_mask:0xf bank_mask:0xf
  v_dot2c_f32_bf16_dpp v27, v43, v35 row_newbcast:1 row_mask:0xf bank_mask:0xf
  v_dot2c_f32_bf16_dpp v28, v43, v36 row_newbcast:1 row_mask:0xf bank_mask:0xf
  v_dot2c_f32_bf16_dpp v29, v43, v37 row_newbcast:1 row_mask:0xf bank_mask:0xf
  v_dot2c_f32_bf16_dpp v30, v43, v38 row_newbcast:1 row_mask:0xf bank_mask:0xf
  v_dot2c_f32_bf16_dpp v31, v43, v39 row_newbcast:1 row_mask:0xf bank_mask:0xf
  s_nop 0
  s_waitcnt vmcnt(4)
  v_perm_b32 v32, v108, v104, s64
  v_perm_b32 v33, v108, v104, s65
  v_perm_b32 v34, v109, v105, s64
  v_perm_b32 v35, v109, v105, s65
  v_perm_b32 v36, v110, v106, s64
  v_perm_b32 v37, v110, v106, s65
  v_perm_b32 v38, v111, v107, s64
  v_perm_b32 v39, v111, v107, s65
  v_dot2c_f32_bf16_dpp v24, v43, v32 row_newbcast:5 row_mask:0xf bank_mask:0xf
  v_dot2c_f32_bf16_dpp v25, v43, v33 row_newbcast:5 row_mask:0xf bank_mask:0xf
  v_dot2c_f32_bf16_dpp v26, v43, v34 row_newbcast:5 row_mask:0xf bank_mask:0xf
  v_dot2c_f32_bf16_dpp v27, v43, v35 row_newbcast:5 row_mask:0xf bank_mask:0xf
  v_dot2c_f32_bf16_dpp v28, v43, v36 row_newbcast:5 row_mask:0xf bank_mask:0xf
  v_dot2c_f32_bf16_dpp v29, v43, v37 row_newbcast:5 row_mask:0xf bank_mask:0xf
  v_dot2c_f32_bf16_dpp v30, v43, v38 row_newbcast:5 row_mask:0xf bank_mask:0xf
  v_dot2c_f32_bf16_dpp v31, v43, v39 row_newbcast:5 row_mask:0xf bank_mask:0xf
  s_nop 0
  s_waitcnt vmcnt(2)
  v_perm_b32 v32, v116, v112, s64
  v_perm_b32 v33, v116, v112, s65
  v_perm_b32 v34, v117, v113, s64
  v_perm_b32 v35, v117, v113, s65
  v_perm_b32 v36, v118, v114, s64
  v_perm_b32 v37, v118, v114, s65
  v_perm_b32 v38, v119, v115, s64
  v_perm_b32 v39, v119, v115, s65
  v_dot2c_f32_bf16_dpp v24, v43, v32 row_newbcast:3 row_mask:0xf bank_mask:0xf
  v_dot2c_f32_bf16_dpp v25, v43, v33 row_newbcast:3 row_mask:0xf bank_mask:0xf
  v_dot2c_f32_bf16_dpp v26, v43, v34 row_newbcast:3 row_mask:0xf bank_mask:0xf
  v_dot2c_f32_bf16_dpp v27, v43, v35 row_newbcast:3 row_mask:0xf bank_mask:0xf
  v_dot2c_f32_bf16_dpp v28, v43, v36 row_newbcast:3 row_mask:0xf bank_mask:0xf
  v_dot2c_f32_bf16_dpp v29, v43, v37 row_newbcast:3 row_mask:0xf bank_mask:0xf
  v_dot2c_f32_bf16_dpp v30, v43, v38 row_newbcast:3 row_mask:0xf bank_mask:0xf
  v_dot2c_f32_bf16_dpp v31, v43, v39 row_newbcast:3 row_mask:0xf bank_mask:0xf
  s_nop 0
  s_waitcnt vmcnt(0)
  v_perm_b32 v32, v124, v120, s64
  v_perm_b32 v33, v124, v120, s65
  v_perm_b32 v34, v125, v121, s64
  v_perm_b32 v35, v125, v121, s65
  v_perm_b32 v36, v126, v122, s64
  v_perm_b32 v37, v126, v122, s65
  v_perm_b32 v38, v127, v123, s64
  v_perm_b32 v39, v127, v123, s65
  v_dot2c_f32_bf16_dpp v24, v43, v32 row_newbcast:7 row_mask:0xf bank_mask:0xf
  v_dot2c_f32_bf16_dpp v25, v43, v33 row_newbcast:7 row_mask:0xf bank_mask:0xf
  v_dot2c_f32_bf16_dpp v26, v43, v34 row_newbcast:7 row_mask:0xf bank_mask:0xf
  v_dot2c_f32_bf16_dpp v27, v43, v35 row_newbcast:7 row_mask:0xf bank_mask:0xf
  v_dot2c_f32_bf16_dpp v28, v43, v36 row_newbcast:7 row_mask:0xf bank_mask:0xf
  v_dot2c_f32_bf16_dpp v29, v43, v37 row_newbcast:7 row_mask:0xf bank_mask:0xf
  v_dot2c_f32_bf16_dpp v30, v43, v38 row_newbcast:7 row_mask:0xf bank_mask:0xf
  v_dot2c_f32_bf16_dpp v31, v43, v39 row_newbcast:7 row_mask:0xf bank_mask:0xf
  v_permlane32_swap_b32 v24, v28
  v_permlane32_swap_b32 v25, v29
  v_permlane32_swap_b32 v26, v30
  v_permlane32_swap_b32 v27, v31
  v_add_f32 v24, v24, v28
  v_add_f32 v25, v25, v29
  v_add_f32 v26, v26, v30
  v_add_f32 v27, v27, v31
  s_nop 0
  v_permlane16_swap_b32 v24, v26
  v_permlane16_swap_b32 v25, v27
  v_add_f32 v24, v24, v26
  v_add_f32_e64 v25, v25, v27
  ds_write_b64 v41, v[24:25] offset:2304
  s_and_b32 exec_lo, 1, s34
  s_and_b32 exec_hi, 0, s34
  ds_add_u32 v60, v42 offset:8
  s_mov_b64 exec, s[34:35]
  s_waitcnt lgkmcnt(1)
  s_cbranch_execz L_tb_143
  s_barrier
L_tb_143:
  s_cbranch_execz L_t1
  s_waitcnt lgkmcnt(0)
  s_endpgm
L_service:
  s_nop 7
  s_nop 0
  s_nop 2
  s_setprio 2
  s_sub_u32 s72, s3, 4
  s_lshr_b32 s73, s2, 5
  s_and_b32 s74, s2, 31
  s_and_b32 s79, s2, 7
  s_lshl_b32 s79, s79, 1
  s_bfe_u32 s75, s2, 0x10003
  s_or_b32 s79, s79, s75
  s_and_b32 s75, s2, 16
  s_or_b32 s79, s79, s75
  s_mov_b32 s74, s79
  s_and_b32 s75, s2, 7
  s_lshr_b32 s76, s2, 3
  s_mul_i32 s88, s75, 11
  s_add_u32 s88, s88, s76
  s_cmp_lt_u32 s2, 88
  s_cselect_b32 s88, s88, 255
  s_lshl_b32 s89, s75, 2
  s_add_u32 s89, s89, s76
  s_sub_u32 s89, s89, 12
  s_sub_u32 s76, s2, 96
  s_cmp_lt_u32 s76, 32
  s_cselect_b32 s89, s89, 255
  v_and_b32 v2, 15, v0
  v_lshrrev_b32 v3, 4, v0
  s_lshl_b32 s77, s73, 1
  v_add_u32 v123, s77, v2
  v_and_b32 v123, 15, v123
  v_mov_b32 v9, v123
  v_mov_b32 v4, 0
  v_lshlrev_b32 v5, 2, v2
  ds_write_b32 v5, v4 offset:0
  s_mov_b32 s82, 0x05040100
  s_mov_b32 s83, 0x07060302
  s_mov_b32 s84, -1
  s_mov_b32 s85, 0
  s_mul_i32 s86, s72, 12288
  s_add_u32 s86, s86, 39424
  s_waitcnt lgkmcnt(0)
  s_mov_b32 s52, s42
  s_mov_b32 s53, s43
  s_mov_b32 s54, 1073741824
  s_mov_b32 s55, 0x00020000
  s_mov_b32 s44, s16
  s_mov_b32 s45, s17
  s_mov_b32 s46, 8192
  s_mov_b32 s47, 0x00020000
  s_mov_b32 s48, s22
  s_mov_b32 s49, s23
  s_mov_b32 s50, 4194304
  s_mov_b32 s51, 0x00020000
  buffer_load_dword v8, v4, s[52:55], 0 offen offset:0 sc1
  s_lshl_b32 s77, s73, 10
  buffer_load_dwordx4 v[12:15], v1, s[44:47], s77 offen
  v_lshlrev_b32 v4, 4, v9
  v_lshl_add_u32 v4, v3, 2, v4
  s_lshl_b32 s78, s72, 8
  s_add_u32 s77, s77, s78
  buffer_load_dword v16, v4, s[44:47], s77 offen
  v_lshlrev_b32 v4, 4, v2
  v_lshl_add_u32 v4, v3, 14, v4
  s_lshl_b32 s77, s72, 20
  s_lshl_b32 s78, s79, 8
  s_add_u32 s77, s77, s78
  s_mov_b32 s75, s77
  s_lshl_b32 s76, s73, 17
  s_add_u32 s77, s75, s76
  s_barrier
  buffer_load_dwordx4 v[128:131], v4, s[48:51], s77 offen
  s_add_u32 s77, s77, 8192
  buffer_load_dwordx4 v[132:135], v4, s[48:51], s77 offen
  s_add_u32 s77, s77, 57344
  buffer_load_dwordx4 v[136:139], v4, s[48:51], s77 offen
  s_add_u32 s77, s77, 8192
  buffer_load_dwordx4 v[140:143], v4, s[48:51], s77 offen
  s_add_u32 s76, s76, 131072
  s_and_b32 s76, s76, 0xfffff
  s_add_u32 s77, s75, s76
  v_lshrrev_b32 v10, 1, v9
  v_lshlrev_b32_e64 v10, 9, v10
  v_and_b32 v5, 1, v9
  v_lshl_add_u32 v10, v5, 5, v10
  v_lshl_add_u32 v10, v3, 3, v10
  s_lshl_b32 s90, s73, 6
  s_lshl_b32 s91, s72, 12
  s_add_u32 s90, s90, s91
  s_add_u32 s90, s90, 4096
  s_add_u32 s91, s90, 16384
  buffer_load_dwordx4 v[144:147], v4, s[48:51], s77 offen
  s_add_u32 s77, s77, 8192
  buffer_load_dwordx4 v[148:151], v4, s[48:51], s77 offen
  s_add_u32 s77, s77, 57344
  s_waitcnt vmcnt(5)
  buffer_load_dwordx4 v[152:155], v4, s[48:51], s77 offen
  s_add_u32 s77, s77, 8192
  s_waitcnt vmcnt(5)
  buffer_load_dwordx4 v[156:159], v4, s[48:51], s77 offen
  s_add_u32 s76, s76, 131072
  s_and_b32 s76, s76, 0xfffff
  s_add_u32 s77, s75, s76
  s_waitcnt vmcnt(5)
  buffer_load_dwordx4 v[160:163], v4, s[48:51], s77 offen
  s_add_u32 s77, s77, 8192
  s_waitcnt vmcnt(5)
  buffer_load_dwordx4 v[164:167], v4, s[48:51], s77 offen
  s_add_u32 s77, s77, 57344
  s_waitcnt vmcnt(5)
  buffer_load_dwordx4 v[168:171], v4, s[48:51], s77 offen
  s_add_u32 s77, s77, 8192
  s_nop 0
  s_waitcnt vmcnt(5)
  buffer_load_dwordx4 v[172:175], v4, s[48:51], s77 offen
  s_add_u32 s76, s76, 131072
  s_and_b32 s76, s76, 0xfffff
  s_add_u32 s77, s75, s76
  s_waitcnt vmcnt(5)
  buffer_load_dwordx4 v[176:179], v4, s[48:51], s77 offen
  s_add_u32 s77, s77, 8192
  s_waitcnt vmcnt(5)
  buffer_load_dwordx4 v[180:183], v4, s[48:51], s77 offen
  s_add_u32 s77, s77, 57344
  s_waitcnt vmcnt(5)
  buffer_load_dwordx4 v[184:187], v4, s[48:51], s77 offen
  s_add_u32 s77, s77, 8192
  s_nop 0
  s_waitcnt vmcnt(5)
  buffer_load_dwordx4 v[188:191], v4, s[48:51], s77 offen
  s_add_u32 s76, s76, 131072
  s_and_b32 s76, s76, 0xfffff
  s_add_u32 s77, s75, s76
  s_waitcnt vmcnt(5)
  buffer_load_dwordx4 v[192:195], v4, s[48:51], s77 offen
  s_add_u32 s77, s77, 8192
  s_waitcnt vmcnt(5)
  buffer_load_dwordx4 v[196:199], v4, s[48:51], s77 offen
  s_add_u32 s77, s77, 57344
  s_waitcnt vmcnt(5)
  buffer_load_dwordx4 v[200:203], v4, s[48:51], s77 offen
  s_add_u32 s77, s77, 8192
  s_nop 0
  s_waitcnt vmcnt(5)
  buffer_load_dwordx4 v[204:207], v4, s[48:51], s77 offen
  s_add_u32 s76, s76, 131072
  s_and_b32 s76, s76, 0xfffff
  s_add_u32 s77, s75, s76
  s_waitcnt vmcnt(5)
  buffer_load_dwordx4 v[208:211], v4, s[48:51], s77 offen
  s_add_u32 s77, s77, 8192
  s_waitcnt vmcnt(5)
  buffer_load_dwordx4 v[212:215], v4, s[48:51], s77 offen
  s_add_u32 s77, s77, 57344
  s_waitcnt vmcnt(5)
  buffer_load_dwordx4 v[216:219], v4, s[48:51], s77 offen
  s_add_u32 s77, s77, 8192
  s_nop 0
  s_waitcnt vmcnt(5)
  buffer_load_dwordx4 v[220:223], v4, s[48:51], s77 offen
  s_add_u32 s76, s76, 131072
  s_and_b32 s76, s76, 0xfffff
  s_add_u32 s77, s75, s76
  s_waitcnt vmcnt(5)
  buffer_load_dwordx4 v[224:227], v4, s[48:51], s77 offen
  s_add_u32 s77, s77, 8192
  s_waitcnt vmcnt(5)
  buffer_load_dwordx4 v[228:231], v4, s[48:51], s77 offen
  s_add_u32 s77, s77, 57344
  s_waitcnt vmcnt(5)
  buffer_load_dwordx4 v[232:235], v4, s[48:51], s77 offen
  s_add_u32 s77, s77, 8192
  s_nop 0
  s_waitcnt vmcnt(5)
  buffer_load_dwordx4 v[236:239], v4, s[48:51], s77 offen
  s_add_u32 s76, s76, 131072
  s_and_b32 s76, s76, 0xfffff
  s_add_u32 s77, s75, s76
  s_waitcnt vmcnt(5)
  buffer_load_dwordx4 v[240:243], v4, s[48:51], s77 offen
  s_add_u32 s77, s77, 8192
  s_waitcnt vmcnt(5)
  buffer_load_dwordx4 v[244:247], v4, s[48:51], s77 offen
  s_add_u32 s77, s77, 57344
  s_waitcnt vmcnt(5)
  buffer_load_dwordx4 v[248:251], v4, s[48:51], s77 offen
  s_add_u32 s77, s77, 8192
  s_nop 0
  s_waitcnt vmcnt(5)
  buffer_load_dwordx4 v[252:255], v4, s[48:51], s77 offen
  buffer_load_dwordx2 v[68:69], v10, s[52:55], s90 offen sc1
  buffer_load_dwordx2 v[70:71], v10, s[52:55], s91 offen sc1
  s_mov_b32 s56, s34
  s_mov_b32 s57, s35
  s_mov_b32 s58, 8192
  s_mov_b32 s59, 0x00020000
  s_mov_b32 s60, s36
  s_mov_b32 s61, s37
  s_mov_b32 s62, 3145728
  s_mov_b32 s63, 0x00020000
  s_mov_b32 s64, s38
  s_mov_b32 s65, s39
  s_mov_b32 s66, 8192
  s_mov_b32 s67, 0x00020000
  s_mov_b32 s68, s40
  s_mov_b32 s69, s41
  s_mov_b32 s70, 256
  s_mov_b32 s71, 0x00020000
  s_waitcnt vmcnt(32)
  v_readfirstlane_b32 s80, v8
  s_add_u32 s80, s80, 1540483477
  v_lshlrev_b32_e64 v28, 16, v12
  v_and_b32 v29, 0xffff0000, v12
  v_lshlrev_b32_e64 v30, 16, v13
  v_and_b32 v31, 0xffff0000, v13
  v_lshlrev_b32_e64 v32, 16, v14
  v_and_b32 v33, 0xffff0000, v14
  v_lshlrev_b32_e64 v34, 16, v15
  v_and_b32 v35, 0xffff0000, v15
  v_add_f32 v36, v28, v29
  v_add_f32 v36, v36, v30
  v_add_f32 v36, v36, v31
  v_add_f32 v36, v36, v32
  v_add_f32 v36, v36, v33
  v_add_f32 v36, v36, v34
  v_add_f32 v36, v36, v35
  s_nop 1
  v_add_f32_dpp v36, v36, v36 quad_perm:[1,0,3,2] row_mask:0xf bank_mask:0xf
  s_nop 0
  s_nop 0
  v_add_f32_dpp v36, v36, v36 quad_perm:[2,3,0,1] row_mask:0xf bank_mask:0xf
  s_nop 0
  s_nop 0
  v_add_f32_dpp v36, v36, v36 row_half_mirror row_mask:0xf bank_mask:0xf
  s_nop 0
  s_nop 0
  v_add_f32_dpp v36, v36, v36 row_mirror row_mask:0xf bank_mask:0xf
  v_mov_b32 v39, v36
  s_nop 1
  v_permlane16_swap_b32 v36, v39
  v_add_f32 v36, v36, v39
  v_mov_b32 v39, v36
  s_nop 1
  v_permlane32_swap_b32 v36, v39
  v_add_f32 v36, v36, v39
  v_mul_f32 v36, 0x3b000000, v36
  v_sub_f32 v39, v28, v36
  v_mul_f32 v37, v39, v39
  v_sub_f32 v39, v29, v36
  v_fmac_f32 v37, v39, v39
  v_sub_f32 v39, v30, v36
  v_fmac_f32 v37, v39, v39
  v_sub_f32 v39, v31, v36
  v_fmac_f32 v37, v39, v39
  v_sub_f32 v39, v32, v36
  v_fmac_f32 v37, v39, v39
  v_sub_f32 v39, v33, v36
  v_fmac_f32 v37, v39, v39
  v_sub_f32 v39, v34, v36
  v_fmac_f32 v37, v39, v39
  v_sub_f32 v39, v35, v36
  v_fmac_f32 v37, v39, v39
  s_nop 0
  s_nop 0
  v_add_f32_dpp v37, v37, v37 quad_perm:[1,0,3,2] row_mask:0xf bank_mask:0xf
  s_nop 0
  s_nop 0
  v_add_f32_dpp v37, v37, v37 quad_perm:[2,3,0,1] row_mask:0xf bank_mask:0xf
  s_nop 0
  s_nop 0
  v_add_f32_dpp v37, v37, v37 row_half_mirror row_mask:0xf bank_mask:0xf
  s_nop 0
  s_nop 0
  v_add_f32_dpp v37, v37, v37 row_mirror row_mask:0xf bank_mask:0xf
  v_mov_b32 v39, v37
  s_nop 1
  v_permlane16_swap_b32 v37, v39
  v_add_f32 v37, v37, v39
  v_mov_b32 v39, v37
  s_nop 1
  v_permlane32_swap_b32 v37, v39
  v_add_f32 v37, v37, v39
  v_mul_f32 v37, 0x3b000000, v37
  v_cvt_pk_bf16_f32 v39, v36, v37
  v_lshlrev_b32_e64 v36, 16, v39
  v_and_b32 v37, 0xffff0000, v39
  v_add_f32 v37, 0x3727c5ac, v37
  v_cvt_pk_bf16_f32 v39, v37, v37
  v_lshlrev_b32_e64 v37, 16, v39
  v_sqrt_f32 v37, v37
  s_nop 0
  v_cvt_pk_bf16_f32 v39, v37, v37
  v_lshlrev_b32 v37, 16, v39
  v_rcp_f32 v38, v37
  v_lshlrev_b32_e64 v41, 16, v16
  v_and_b32 v42, 0xffff0000, v16
  v_sub_f32 v41, v41, v36
  v_sub_f32 v42, v42, v36
  v_cvt_pk_bf16_f32 v39, v41, v42
  v_lshlrev_b32_e64 v41, 16, v39
  v_and_b32 v42, 0xffff0000, v39
  v_mul_f32 v39, v41, v38
  v_mul_f32 v40, v42, v38
  v_fma_f32 v41, -v39, v37, v41
  v_fma_f32 v42, -v40, v37, v42
  v_fma_f32 v41, v41, v38, v39
  v_fma_f32 v42, v42, v38, v40
  v_cvt_pk_bf16_f32 v39, v41, v42
  v_lshlrev_b32 v41, 16, v39
  v_and_b32 v42, 0xffff0000, v39
  s_waitcnt vmcnt(32)
  v_perm_b32 v127, v132, v128, s82
  v_perm_b32 v132, v132, v128, s83
  v_perm_b32 v128, v133, v129, s82
  v_perm_b32 v133, v133, v129, s83
  v_perm_b32 v129, v134, v130, s82
  v_perm_b32 v134, v134, v130, s83
  v_perm_b32 v130, v135, v131, s82
  v_perm_b32 v135, v135, v131, s83
  s_nop 0
  s_waitcnt vmcnt(30)
  v_perm_b32 v131, v140, v136, s82
  v_perm_b32 v140, v140, v136, s83
  v_perm_b32 v136, v141, v137, s82
  v_perm_b32 v141, v141, v137, s83
  v_perm_b32 v137, v142, v138, s82
  v_perm_b32 v142, v142, v138, s83
  v_perm_b32 v138, v143, v139, s82
  v_perm_b32 v143, v143, v139, s83
  s_nop 0
  s_waitcnt vmcnt(28)
  v_perm_b32 v139, v148, v144, s82
  v_perm_b32 v148, v148, v144, s83
  v_perm_b32 v144, v149, v145, s82
  v_perm_b32 v149, v149, v145, s83
  v_perm_b32 v145, v150, v146, s82
  v_perm_b32 v150, v150, v146, s83
  v_perm_b32 v146, v151, v147, s82
  v_perm_b32 v151, v151, v147, s83
  s_nop 0
  s_waitcnt vmcnt(26)
  v_perm_b32 v147, v156, v152, s82
  v_perm_b32 v156, v156, v152, s83
  v_perm_b32 v152, v157, v153, s82
  v_perm_b32 v157, v157, v153, s83
  v_perm_b32 v153, v158, v154, s82
  v_perm_b32 v158, v158, v154, s83
  v_perm_b32 v154, v159, v155, s82
  v_perm_b32 v159, v159, v155, s83
  s_nop 0
  s_waitcnt vmcnt(24)
  v_perm_b32 v155, v164, v160, s82
  v_perm_b32 v164, v164, v160, s83
  v_perm_b32 v160, v165, v161, s82
  v_perm_b32 v165, v165, v161, s83
  v_perm_b32 v161, v166, v162, s82
  v_perm_b32 v166, v166, v162, s83
  v_perm_b32 v162, v167, v163, s82
  v_perm_b32 v167, v167, v163, s83
  s_nop 0
  s_waitcnt vmcnt(22)
  v_perm_b32 v163, v172, v168, s82
  v_perm_b32 v172, v172, v168, s83
  v_perm_b32 v168, v173, v169, s82
  v_perm_b32 v173, v173, v169, s83
  v_perm_b32 v169, v174, v170, s82
  v_perm_b32 v174, v174, v170, s83
  v_perm_b32 v170, v175, v171, s82
  v_perm_b32 v175, v175, v171, s83
  s_nop 0
  s_waitcnt vmcnt(20)
  v_perm_b32 v171, v180, v176, s82
  v_perm_b32 v180, v180, v176, s83
  v_perm_b32 v176, v181, v177, s82
  v_perm_b32 v181, v181, v177, s83
  v_perm_b32 v177, v182, v178, s82
  v_perm_b32 v182, v182, v178, s83
  v_perm_b32 v178, v183, v179, s82
  v_perm_b32 v183, v183, v179, s83
  s_nop 0
  s_waitcnt vmcnt(18)
  v_perm_b32 v179, v188, v184, s82
  v_perm_b32 v188, v188, v184, s83
  v_perm_b32 v184, v189, v185, s82
  v_perm_b32 v189, v189, v185, s83
  v_perm_b32 v185, v190, v186, s82
  v_perm_b32 v190, v190, v186, s83
  v_perm_b32 v186, v191, v187, s82
  v_perm_b32 v191, v191, v187, s83
  s_nop 0
  s_waitcnt vmcnt(16)
  v_perm_b32 v187, v196, v192, s82
  v_perm_b32 v196, v196, v192, s83
  v_perm_b32 v192, v197, v193, s82
  v_perm_b32 v197, v197, v193, s83
  v_perm_b32 v193, v198, v194, s82
  v_perm_b32 v198, v198, v194, s83
  v_perm_b32 v194, v199, v195, s82
  v_perm_b32 v199, v199, v195, s83
  s_nop 0
  s_waitcnt vmcnt(14)
  v_perm_b32 v195, v204, v200, s82
  v_perm_b32 v204, v204, v200, s83
  v_perm_b32 v200, v205, v201, s82
  v_perm_b32 v205, v205, v201, s83
  v_perm_b32 v201, v206, v202, s82
  v_perm_b32 v206, v206, v202, s83
  v_perm_b32 v202, v207, v203, s82
  v_perm_b32 v207, v207, v203, s83
  s_nop 0
  s_waitcnt vmcnt(12)
  v_perm_b32 v203, v212, v208, s82
  v_perm_b32 v212, v212, v208, s83
  v_perm_b32 v208, v213, v209, s82
  v_perm_b32 v213, v213, v209, s83
  v_perm_b32 v209, v214, v210, s82
  v_perm_b32 v214, v214, v210, s83
  v_perm_b32 v210, v215, v211, s82
  v_perm_b32 v215, v215, v211, s83
  s_nop 0
  s_waitcnt vmcnt(10)
  v_perm_b32 v211, v220, v216, s82
  v_perm_b32 v220, v220, v216, s83
  v_perm_b32 v216, v221, v217, s82
  v_perm_b32 v221, v221, v217, s83
  v_perm_b32 v217, v222, v218, s82
  v_perm_b32 v222, v222, v218, s83
  v_perm_b32 v218, v223, v219, s82
  v_perm_b32 v223, v223, v219, s83
  s_nop 0
  s_waitcnt vmcnt(8)
  v_perm_b32 v219, v228, v224, s82
  v_perm_b32 v228, v228, v224, s83
  v_perm_b32 v224, v229, v225, s82
  v_perm_b32 v229, v229, v225, s83
  v_perm_b32 v225, v230, v226, s82
  v_perm_b32 v230, v230, v226, s83
  v_perm_b32 v226, v231, v227, s82
  v_perm_b32 v231, v231, v227, s83
  v_mov_b32 v44, 0
  v_mov_b32 v45, 0
  v_mov_b32 v46, 0
  v_mov_b32 v47, 0
  v_mov_b32 v48, 0
  v_mov_b32 v49, 0
  v_mov_b32 v50, 0
  v_mov_b32 v51, 0
  s_mov_b32 s81, 0
  s_waitcnt vmcnt(0)
  s_branch L_poll_sa_chk
L_poll_sa:
  s_nop 7
  s_nop 0
  s_nop 2
  buffer_load_dwordx2 v[68:69], v10, s[52:55], s90 offen sc1
  buffer_load_dwordx2 v[70:71], v10, s[52:55], s91 offen sc1
  s_waitcnt vmcnt(0)
L_poll_sa_chk:
  s_nop 7
  s_nop 3
  v_xor_b32 v7, s80, v69
  v_bitop3_b32 v7, v71, s80, v7 bitop3:0xbe
  v_cmp_ne_u32_e64 vcc, 0, v7
  s_cbranch_vccz L_poll_sa_ok
  s_add_u32 s81, s81, 1
  s_cmp_lt_u32 s81, 100000
  s_cbranch_scc0 L_poll_sa_ok
  s_sleep 1
  s_branch L_poll_sa
L_poll_sa_ok:
  s_nop 7
  s_nop 3
  v_lshlrev_b32 v39, 16, v70
  v_and_b32 v40, 0xffff0000, v70
  v_add_f32 v39, 1.0, v39
  v_add_f32 v40, 1.0, v40
  v_cvt_pk_bf16_f32 v70, v39, v40
  v_lshlrev_b32_e64 v39, 16, v70
  v_and_b32 v40, 0xffff0000, v70
  v_mul_f32 v41, v41, v39
  v_mul_f32 v42, v42, v40
  v_cvt_pk_bf16_f32 v7, v41, v42
  v_lshlrev_b32_e64 v41, 16, v7
  v_and_b32 v42, 0xffff0000, v7
  v_lshlrev_b32_e64 v39, 16, v68
  v_and_b32 v40, 0xffff0000, v68
  v_add_f32 v41, v41, v39
  v_add_f32 v42, v42, v40
  v_cvt_pk_bf16_f32 v43, v41, v42
  s_nop 0
  s_nop 0
  v_dot2c_f32_bf16_dpp v44, v43, v127 row_newbcast:0 row_mask:0xf bank_mask:0xf
  v_dot2c_f32_bf16_dpp v45, v43, v132 row_newbcast:0 row_mask:0xf bank_mask:0xf
  v_dot2c_f32_bf16_dpp v46, v43, v128 row_newbcast:0 row_mask:0xf bank_mask:0xf
  v_dot2c_f32_bf16_dpp v47, v43, v133 row_newbcast:0 row_mask:0xf bank_mask:0xf
  v_dot2c_f32_bf16_dpp v48, v43, v129 row_newbcast:0 row_mask:0xf bank_mask:0xf
  v_dot2c_f32_bf16_dpp v49, v43, v134 row_newbcast:0 row_mask:0xf bank_mask:0xf
  v_dot2c_f32_bf16_dpp v50, v43, v130 row_newbcast:0 row_mask:0xf bank_mask:0xf
  v_dot2c_f32_bf16_dpp v51, v43, v135 row_newbcast:0 row_mask:0xf bank_mask:0xf
  v_dot2c_f32_bf16_dpp v44, v43, v131 row_newbcast:1 row_mask:0xf bank_mask:0xf
  v_dot2c_f32_bf16_dpp v45, v43, v140 row_newbcast:1 row_mask:0xf bank_mask:0xf
  v_dot2c_f32_bf16_dpp v46, v43, v136 row_newbcast:1 row_mask:0xf bank_mask:0xf
  v_dot2c_f32_bf16_dpp v47, v43, v141 row_newbcast:1 row_mask:0xf bank_mask:0xf
  v_dot2c_f32_bf16_dpp v48, v43, v137 row_newbcast:1 row_mask:0xf bank_mask:0xf
  v_dot2c_f32_bf16_dpp v49, v43, v142 row_newbcast:1 row_mask:0xf bank_mask:0xf
  v_dot2c_f32_bf16_dpp v50, v43, v138 row_newbcast:1 row_mask:0xf bank_mask:0xf
  v_dot2c_f32_bf16_dpp v51, v43, v143 row_newbcast:1 row_mask:0xf bank_mask:0xf
  v_dot2c_f32_bf16_dpp v44, v43, v139 row_newbcast:2 row_mask:0xf bank_mask:0xf
  v_dot2c_f32_bf16_dpp v45, v43, v148 row_newbcast:2 row_mask:0xf bank_mask:0xf
  v_dot2c_f32_bf16_dpp v46, v43, v144 row_newbcast:2 row_mask:0xf bank_mask:0xf
  v_dot2c_f32_bf16_dpp v47, v43, v149 row_newbcast:2 row_mask:0xf bank_mask:0xf
  v_dot2c_f32_bf16_dpp v48, v43, v145 row_newbcast:2 row_mask:0xf bank_mask:0xf
  v_dot2c_f32_bf16_dpp v49, v43, v150 row_newbcast:2 row_mask:0xf bank_mask:0xf
  v_dot2c_f32_bf16_dpp v50, v43, v146 row_newbcast:2 row_mask:0xf bank_mask:0xf
  v_dot2c_f32_bf16_dpp v51, v43, v151 row_newbcast:2 row_mask:0xf bank_mask:0xf
  v_dot2c_f32_bf16_dpp v44, v43, v147 row_newbcast:3 row_mask:0xf bank_mask:0xf
  v_dot2c_f32_bf16_dpp v45, v43, v156 row_newbcast:3 row_mask:0xf bank_mask:0xf
  v_dot2c_f32_bf16_dpp v46, v43, v152 row_newbcast:3 row_mask:0xf bank_mask:0xf
  v_dot2c_f32_bf16_dpp v47, v43, v157 row_newbcast:3 row_mask:0xf bank_mask:0xf
  v_dot2c_f32_bf16_dpp v48, v43, v153 row_newbcast:3 row_mask:0xf bank_mask:0xf
  v_dot2c_f32_bf16_dpp v49, v43, v158 row_newbcast:3 row_mask:0xf bank_mask:0xf
  v_dot2c_f32_bf16_dpp v50, v43, v154 row_newbcast:3 row_mask:0xf bank_mask:0xf
  v_dot2c_f32_bf16_dpp v51, v43, v159 row_newbcast:3 row_mask:0xf bank_mask:0xf
  v_dot2c_f32_bf16_dpp v44, v43, v155 row_newbcast:4 row_mask:0xf bank_mask:0xf
  v_dot2c_f32_bf16_dpp v45, v43, v164 row_newbcast:4 row_mask:0xf bank_mask:0xf
  v_dot2c_f32_bf16_dpp v46, v43, v160 row_newbcast:4 row_mask:0xf bank_mask:0xf
  v_dot2c_f32_bf16_dpp v47, v43, v165 row_newbcast:4 row_mask:0xf bank_mask:0xf
  v_dot2c_f32_bf16_dpp v48, v43, v161 row_newbcast:4 row_mask:0xf bank_mask:0xf
  v_dot2c_f32_bf16_dpp v49, v43, v166 row_newbcast:4 row_mask:0xf bank_mask:0xf
  v_dot2c_f32_bf16_dpp v50, v43, v162 row_newbcast:4 row_mask:0xf bank_mask:0xf
  v_dot2c_f32_bf16_dpp v51, v43, v167 row_newbcast:4 row_mask:0xf bank_mask:0xf
  v_dot2c_f32_bf16_dpp v44, v43, v163 row_newbcast:5 row_mask:0xf bank_mask:0xf
  v_dot2c_f32_bf16_dpp v45, v43, v172 row_newbcast:5 row_mask:0xf bank_mask:0xf
  v_dot2c_f32_bf16_dpp v46, v43, v168 row_newbcast:5 row_mask:0xf bank_mask:0xf
  v_dot2c_f32_bf16_dpp v47, v43, v173 row_newbcast:5 row_mask:0xf bank_mask:0xf
  v_dot2c_f32_bf16_dpp v48, v43, v169 row_newbcast:5 row_mask:0xf bank_mask:0xf
  v_dot2c_f32_bf16_dpp v49, v43, v174 row_newbcast:5 row_mask:0xf bank_mask:0xf
  v_dot2c_f32_bf16_dpp v50, v43, v170 row_newbcast:5 row_mask:0xf bank_mask:0xf
  v_dot2c_f32_bf16_dpp v51, v43, v175 row_newbcast:5 row_mask:0xf bank_mask:0xf
  v_dot2c_f32_bf16_dpp v44, v43, v171 row_newbcast:6 row_mask:0xf bank_mask:0xf
  v_dot2c_f32_bf16_dpp v45, v43, v180 row_newbcast:6 row_mask:0xf bank_mask:0xf
  v_dot2c_f32_bf16_dpp v46, v43, v176 row_newbcast:6 row_mask:0xf bank_mask:0xf
  v_dot2c_f32_bf16_dpp v47, v43, v181 row_newbcast:6 row_mask:0xf bank_mask:0xf
  v_dot2c_f32_bf16_dpp v48, v43, v177 row_newbcast:6 row_mask:0xf bank_mask:0xf
  v_dot2c_f32_bf16_dpp v49, v43, v182 row_newbcast:6 row_mask:0xf bank_mask:0xf
  v_dot2c_f32_bf16_dpp v50, v43, v178 row_newbcast:6 row_mask:0xf bank_mask:0xf
  v_dot2c_f32_bf16_dpp v51, v43, v183 row_newbcast:6 row_mask:0xf bank_mask:0xf
  v_dot2c_f32_bf16_dpp v44, v43, v179 row_newbcast:7 row_mask:0xf bank_mask:0xf
  v_dot2c_f32_bf16_dpp v45, v43, v188 row_newbcast:7 row_mask:0xf bank_mask:0xf
  v_dot2c_f32_bf16_dpp v46, v43, v184 row_newbcast:7 row_mask:0xf bank_mask:0xf
  v_dot2c_f32_bf16_dpp v47, v43, v189 row_newbcast:7 row_mask:0xf bank_mask:0xf
  v_dot2c_f32_bf16_dpp v48, v43, v185 row_newbcast:7 row_mask:0xf bank_mask:0xf
  v_dot2c_f32_bf16_dpp v49, v43, v190 row_newbcast:7 row_mask:0xf bank_mask:0xf
  v_dot2c_f32_bf16_dpp v50, v43, v186 row_newbcast:7 row_mask:0xf bank_mask:0xf
  v_dot2c_f32_bf16_dpp v51, v43, v191 row_newbcast:7 row_mask:0xf bank_mask:0xf
  v_dot2c_f32_bf16_dpp v44, v43, v187 row_newbcast:8 row_mask:0xf bank_mask:0xf
  v_dot2c_f32_bf16_dpp v45, v43, v196 row_newbcast:8 row_mask:0xf bank_mask:0xf
  v_dot2c_f32_bf16_dpp v46, v43, v192 row_newbcast:8 row_mask:0xf bank_mask:0xf
  v_dot2c_f32_bf16_dpp v47, v43, v197 row_newbcast:8 row_mask:0xf bank_mask:0xf
  v_dot2c_f32_bf16_dpp v48, v43, v193 row_newbcast:8 row_mask:0xf bank_mask:0xf
  v_dot2c_f32_bf16_dpp v49, v43, v198 row_newbcast:8 row_mask:0xf bank_mask:0xf
  v_dot2c_f32_bf16_dpp v50, v43, v194 row_newbcast:8 row_mask:0xf bank_mask:0xf
  v_dot2c_f32_bf16_dpp v51, v43, v199 row_newbcast:8 row_mask:0xf bank_mask:0xf
  v_dot2c_f32_bf16_dpp v44, v43, v195 row_newbcast:9 row_mask:0xf bank_mask:0xf
  v_dot2c_f32_bf16_dpp v45, v43, v204 row_newbcast:9 row_mask:0xf bank_mask:0xf
  v_dot2c_f32_bf16_dpp v46, v43, v200 row_newbcast:9 row_mask:0xf bank_mask:0xf
  v_dot2c_f32_bf16_dpp v47, v43, v205 row_newbcast:9 row_mask:0xf bank_mask:0xf
  v_dot2c_f32_bf16_dpp v48, v43, v201 row_newbcast:9 row_mask:0xf bank_mask:0xf
  v_dot2c_f32_bf16_dpp v49, v43, v206 row_newbcast:9 row_mask:0xf bank_mask:0xf
  v_dot2c_f32_bf16_dpp v50, v43, v202 row_newbcast:9 row_mask:0xf bank_mask:0xf
  v_dot2c_f32_bf16_dpp v51, v43, v207 row_newbcast:9 row_mask:0xf bank_mask:0xf
  v_dot2c_f32_bf16_dpp v44, v43, v203 row_newbcast:10 row_mask:0xf bank_mask:0xf
  v_dot2c_f32_bf16_dpp v45, v43, v212 row_newbcast:10 row_mask:0xf bank_mask:0xf
  v_dot2c_f32_bf16_dpp v46, v43, v208 row_newbcast:10 row_mask:0xf bank_mask:0xf
  v_dot2c_f32_bf16_dpp v47, v43, v213 row_newbcast:10 row_mask:0xf bank_mask:0xf
  v_dot2c_f32_bf16_dpp v48, v43, v209 row_newbcast:10 row_mask:0xf bank_mask:0xf
  v_dot2c_f32_bf16_dpp v49, v43, v214 row_newbcast:10 row_mask:0xf bank_mask:0xf
  v_dot2c_f32_bf16_dpp v50, v43, v210 row_newbcast:10 row_mask:0xf bank_mask:0xf
  v_dot2c_f32_bf16_dpp v51, v43, v215 row_newbcast:10 row_mask:0xf bank_mask:0xf
  v_dot2c_f32_bf16_dpp v44, v43, v211 row_newbcast:11 row_mask:0xf bank_mask:0xf
  v_dot2c_f32_bf16_dpp v45, v43, v220 row_newbcast:11 row_mask:0xf bank_mask:0xf
  v_dot2c_f32_bf16_dpp v46, v43, v216 row_newbcast:11 row_mask:0xf bank_mask:0xf
  v_dot2c_f32_bf16_dpp v47, v43, v221 row_newbcast:11 row_mask:0xf bank_mask:0xf
  v_dot2c_f32_bf16_dpp v48, v43, v217 row_newbcast:11 row_mask:0xf bank_mask:0xf
  v_dot2c_f32_bf16_dpp v49, v43, v222 row_newbcast:11 row_mask:0xf bank_mask:0xf
  v_dot2c_f32_bf16_dpp v50, v43, v218 row_newbcast:11 row_mask:0xf bank_mask:0xf
  v_dot2c_f32_bf16_dpp v51, v43, v223 row_newbcast:11 row_mask:0xf bank_mask:0xf
  v_dot2c_f32_bf16_dpp v44, v43, v219 row_newbcast:12 row_mask:0xf bank_mask:0xf
  v_dot2c_f32_bf16_dpp v45, v43, v228 row_newbcast:12 row_mask:0xf bank_mask:0xf
  v_dot2c_f32_bf16_dpp v46, v43, v224 row_newbcast:12 row_mask:0xf bank_mask:0xf
  v_dot2c_f32_bf16_dpp v47, v43, v229 row_newbcast:12 row_mask:0xf bank_mask:0xf
  v_dot2c_f32_bf16_dpp v48, v43, v225 row_newbcast:12 row_mask:0xf bank_mask:0xf
  v_dot2c_f32_bf16_dpp v49, v43, v230 row_newbcast:12 row_mask:0xf bank_mask:0xf
  v_dot2c_f32_bf16_dpp v50, v43, v226 row_newbcast:12 row_mask:0xf bank_mask:0xf
  v_dot2c_f32_bf16_dpp v51, v43, v231 row_newbcast:12 row_mask:0xf bank_mask:0xf
  s_nop 0
  s_waitcnt vmcnt(6)
  v_perm_b32 v227, v236, v232, s82
  v_perm_b32 v236, v236, v232, s83
  v_perm_b32 v232, v237, v233, s82
  v_perm_b32 v237, v237, v233, s83
  v_perm_b32 v233, v238, v234, s82
  v_perm_b32 v238, v238, v234, s83
  v_perm_b32 v234, v239, v235, s82
  v_perm_b32 v239, v239, v235, s83
  v_dot2c_f32_bf16_dpp v44, v43, v227 row_newbcast:13 row_mask:0xf bank_mask:0xf
  v_dot2c_f32_bf16_dpp v45, v43, v236 row_newbcast:13 row_mask:0xf bank_mask:0xf
  v_dot2c_f32_bf16_dpp v46, v43, v232 row_newbcast:13 row_mask:0xf bank_mask:0xf
  v_dot2c_f32_bf16_dpp v47, v43, v237 row_newbcast:13 row_mask:0xf bank_mask:0xf
  v_dot2c_f32_bf16_dpp v48, v43, v233 row_newbcast:13 row_mask:0xf bank_mask:0xf
  v_dot2c_f32_bf16_dpp v49, v43, v238 row_newbcast:13 row_mask:0xf bank_mask:0xf
  v_dot2c_f32_bf16_dpp v50, v43, v234 row_newbcast:13 row_mask:0xf bank_mask:0xf
  v_dot2c_f32_bf16_dpp v51, v43, v239 row_newbcast:13 row_mask:0xf bank_mask:0xf
  s_nop 0
  s_waitcnt vmcnt(4)
  v_perm_b32 v235, v244, v240, s82
  v_perm_b32 v244, v244, v240, s83
  v_perm_b32 v240, v245, v241, s82
  v_perm_b32 v245, v245, v241, s83
  v_perm_b32 v241, v246, v242, s82
  v_perm_b32 v246, v246, v242, s83
  v_perm_b32 v242, v247, v243, s82
  v_perm_b32 v247, v247, v243, s83
  v_dot2c_f32_bf16_dpp v44, v43, v235 row_newbcast:14 row_mask:0xf bank_mask:0xf
  v_dot2c_f32_bf16_dpp v45, v43, v244 row_newbcast:14 row_mask:0xf bank_mask:0xf
  v_dot2c_f32_bf16_dpp v46, v43, v240 row_newbcast:14 row_mask:0xf bank_mask:0xf
  v_dot2c_f32_bf16_dpp v47, v43, v245 row_newbcast:14 row_mask:0xf bank_mask:0xf
  v_dot2c_f32_bf16_dpp v48, v43, v241 row_newbcast:14 row_mask:0xf bank_mask:0xf
  v_dot2c_f32_bf16_dpp v49, v43, v246 row_newbcast:14 row_mask:0xf bank_mask:0xf
  v_dot2c_f32_bf16_dpp v50, v43, v242 row_newbcast:14 row_mask:0xf bank_mask:0xf
  v_dot2c_f32_bf16_dpp v51, v43, v247 row_newbcast:14 row_mask:0xf bank_mask:0xf
  s_nop 0
  s_waitcnt vmcnt(2)
  v_perm_b32 v243, v252, v248, s82
  v_perm_b32 v252, v252, v248, s83
  v_perm_b32 v248, v253, v249, s82
  v_perm_b32 v253, v253, v249, s83
  v_perm_b32 v249, v254, v250, s82
  v_perm_b32 v254, v254, v250, s83
  v_perm_b32 v250, v255, v251, s82
  v_perm_b32 v255, v255, v251, s83
  v_dot2c_f32_bf16_dpp v44, v43, v243 row_newbcast:15 row_mask:0xf bank_mask:0xf
  v_dot2c_f32_bf16_dpp v45, v43, v252 row_newbcast:15 row_mask:0xf bank_mask:0xf
  v_dot2c_f32_bf16_dpp v46, v43, v248 row_newbcast:15 row_mask:0xf bank_mask:0xf
  v_dot2c_f32_bf16_dpp v47, v43, v253 row_newbcast:15 row_mask:0xf bank_mask:0xf
  v_dot2c_f32_bf16_dpp v48, v43, v249 row_newbcast:15 row_mask:0xf bank_mask:0xf
  v_dot2c_f32_bf16_dpp v49, v43, v254 row_newbcast:15 row_mask:0xf bank_mask:0xf
  v_dot2c_f32_bf16_dpp v50, v43, v250 row_newbcast:15 row_mask:0xf bank_mask:0xf
  v_dot2c_f32_bf16_dpp v51, v43, v255 row_newbcast:15 row_mask:0xf bank_mask:0xf
  v_permlane32_swap_b32 v44, v48
  v_permlane32_swap_b32 v45, v49
  v_permlane32_swap_b32 v46, v50
  v_permlane32_swap_b32 v47, v51
  v_add_f32 v44, v44, v48
  v_add_f32 v45, v45, v49
  v_add_f32 v46, v46, v50
  v_add_f32 v47, v47, v51
  s_nop 0
  v_permlane16_swap_b32 v44, v46
  v_permlane16_swap_b32 v45, v47
  v_add_f32 v44, v44, v46
  v_add_f32 v45, v45, v47
  v_lshlrev_b32 v4, 5, v2
  v_lshl_add_u32 v4, v3, 3, v4
  s_lshl_b32 s77, s72, 9
  v_add_u32 v5, s77, v4
  ds_write_b64 v5, v[44:45] offset:256
  s_waitcnt lgkmcnt(0)
  s_barrier
  s_mov_b32 s48, s24
  s_mov_b32 s49, s25
  s_mov_b32 s50, 4194304
  s_mov_b32 s51, 0x00020000
  v_lshlrev_b32 v4, 4, v2
  v_lshl_add_u32 v4, v3, 11, v4
  s_lshl_b32 s77, s79, 17
  s_lshl_b32 s78, s72, 8
  s_add_u32 s77, s77, s78
  buffer_load_dwordx4 v[128:131], v4, s[48:51], s77 offen offset:0
  buffer_load_dwordx4 v[132:135], v4, s[48:51], s77 offen offset:1024
  s_add_u32 s77, s77, 8192
  s_waitcnt vmcnt(1)
  buffer_load_dwordx4 v[136:139], v4, s[48:51], s77 offen offset:0
  s_waitcnt vmcnt(1)
  buffer_load_dwordx4 v[140:143], v4, s[48:51], s77 offen offset:1024
  s_add_u32 s77, s77, 8192
  s_waitcnt vmcnt(1)
  buffer_load_dwordx4 v[144:147], v4, s[48:51], s77 offen offset:0
  s_waitcnt vmcnt(1)
  buffer_load_dwordx4 v[148:151], v4, s[48:51], s77 offen offset:1024
  s_add_u32 s77, s77, 8192
  s_waitcnt vmcnt(1)
  buffer_load_dwordx4 v[152:155], v4, s[48:51], s77 offen offset:0
  s_waitcnt vmcnt(1)
  buffer_load_dwordx4 v[156:159], v4, s[48:51], s77 offen offset:1024
  s_add_u32 s77, s77, 8192
  s_waitcnt vmcnt(1)
  buffer_load_dwordx4 v[160:163], v4, s[48:51], s77 offen offset:0
  s_waitcnt vmcnt(1)
  buffer_load_dwordx4 v[164:167], v4, s[48:51], s77 offen offset:1024
  s_add_u32 s77, s77, 8192
  s_waitcnt vmcnt(1)
  buffer_load_dwordx4 v[168:171], v4, s[48:51], s77 offen offset:0
  s_waitcnt vmcnt(1)
  buffer_load_dwordx4 v[172:175], v4, s[48:51], s77 offen offset:1024
  s_add_u32 s77, s77, 8192
  s_waitcnt vmcnt(1)
  buffer_load_dwordx4 v[176:179], v4, s[48:51], s77 offen offset:0
  s_waitcnt vmcnt(1)
  buffer_load_dwordx4 v[180:183], v4, s[48:51], s77 offen offset:1024
  s_add_u32 s77, s77, 8192
  s_waitcnt vmcnt(1)
  buffer_load_dwordx4 v[184:187], v4, s[48:51], s77 offen offset:0
  s_waitcnt vmcnt(1)
  buffer_load_dwordx4 v[188:191], v4, s[48:51], s77 offen offset:1024
  s_add_u32 s77, s77, 8192
  s_waitcnt vmcnt(1)
  buffer_load_dwordx4 v[192:195], v4, s[48:51], s77 offen offset:0
  s_waitcnt vmcnt(1)
  buffer_load_dwordx4 v[196:199], v4, s[48:51], s77 offen offset:1024
  s_add_u32 s77, s77, 8192
  s_waitcnt vmcnt(1)
  buffer_load_dwordx4 v[200:203], v4, s[48:51], s77 offen offset:0
  s_waitcnt vmcnt(1)
  buffer_load_dwordx4 v[204:207], v4, s[48:51], s77 offen offset:1024
  s_add_u32 s77, s77, 8192
  s_waitcnt vmcnt(1)
  buffer_load_dwordx4 v[208:211], v4, s[48:51], s77 offen offset:0
  s_waitcnt vmcnt(1)
  buffer_load_dwordx4 v[212:215], v4, s[48:51], s77 offen offset:1024
  s_add_u32 s77, s77, 8192
  s_waitcnt vmcnt(1)
  buffer_load_dwordx4 v[216:219], v4, s[48:51], s77 offen offset:0
  s_waitcnt vmcnt(1)
  buffer_load_dwordx4 v[220:223], v4, s[48:51], s77 offen offset:1024
  s_add_u32 s77, s77, 8192
  s_waitcnt vmcnt(1)
  buffer_load_dwordx4 v[224:227], v4, s[48:51], s77 offen offset:0
  s_waitcnt vmcnt(1)
  buffer_load_dwordx4 v[228:231], v4, s[48:51], s77 offen offset:1024
  s_add_u32 s77, s77, 8192
  s_waitcnt vmcnt(1)
  buffer_load_dwordx4 v[232:235], v4, s[48:51], s77 offen offset:0
  s_waitcnt vmcnt(1)
  buffer_load_dwordx4 v[236:239], v4, s[48:51], s77 offen offset:1024
  s_add_u32 s77, s77, 8192
  s_waitcnt vmcnt(1)
  buffer_load_dwordx4 v[240:243], v4, s[48:51], s77 offen offset:0
  s_waitcnt vmcnt(1)
  buffer_load_dwordx4 v[244:247], v4, s[48:51], s77 offen offset:1024
  s_add_u32 s77, s77, 8192
  s_waitcnt vmcnt(1)
  buffer_load_dwordx4 v[248:251], v4, s[48:51], s77 offen offset:0
  s_waitcnt vmcnt(1)
  buffer_load_dwordx4 v[252:255], v4, s[48:51], s77 offen offset:1024
  s_nop 0
  s_waitcnt vmcnt(30)
  v_perm_b32 v127, v132, v128, s82
  v_perm_b32 v132, v132, v128, s83
  v_perm_b32 v128, v133, v129, s82
  v_perm_b32 v133, v133, v129, s83
  v_perm_b32 v129, v134, v130, s82
  v_perm_b32 v134, v134, v130, s83
  v_perm_b32 v130, v135, v131, s82
  v_perm_b32 v135, v135, v131, s83
  s_nop 0
  s_waitcnt vmcnt(28)
  v_perm_b32 v131, v140, v136, s82
  v_perm_b32 v140, v140, v136, s83
  v_perm_b32 v136, v141, v137, s82
  v_perm_b32 v141, v141, v137, s83
  v_perm_b32 v137, v142, v138, s82
  v_perm_b32 v142, v142, v138, s83
  v_perm_b32 v138, v143, v139, s82
  v_perm_b32 v143, v143, v139, s83
  s_nop 0
  s_waitcnt vmcnt(26)
  v_perm_b32 v139, v148, v144, s82
  v_perm_b32 v148, v148, v144, s83
  v_perm_b32 v144, v149, v145, s82
  v_perm_b32 v149, v149, v145, s83
  v_perm_b32 v145, v150, v146, s82
  v_perm_b32 v150, v150, v146, s83
  v_perm_b32 v146, v151, v147, s82
  v_perm_b32 v151, v151, v147, s83
  s_nop 0
  s_waitcnt vmcnt(24)
  v_perm_b32 v147, v156, v152, s82
  v_perm_b32 v156, v156, v152, s83
  v_perm_b32 v152, v157, v153, s82
  v_perm_b32 v157, v157, v153, s83
  v_perm_b32 v153, v158, v154, s82
  v_perm_b32 v158, v158, v154, s83
  v_perm_b32 v154, v159, v155, s82
  v_perm_b32 v159, v159, v155, s83
  s_nop 0
  s_waitcnt vmcnt(22)
  v_perm_b32 v155, v164, v160, s82
  v_perm_b32 v164, v164, v160, s83
  v_perm_b32 v160, v165, v161, s82
  v_perm_b32 v165, v165, v161, s83
  v_perm_b32 v161, v166, v162, s82
  v_perm_b32 v166, v166, v162, s83
  v_perm_b32 v162, v167, v163, s82
  v_perm_b32 v167, v167, v163, s83
  s_nop 0
  s_waitcnt vmcnt(20)
  v_perm_b32 v163, v172, v168, s82
  v_perm_b32 v172, v172, v168, s83
  v_perm_b32 v168, v173, v169, s82
  v_perm_b32 v173, v173, v169, s83
  v_perm_b32 v169, v174, v170, s82
  v_perm_b32 v174, v174, v170, s83
  v_perm_b32 v170, v175, v171, s82
  v_perm_b32 v175, v175, v171, s83
  s_nop 0
  s_waitcnt vmcnt(18)
  v_perm_b32 v171, v180, v176, s82
  v_perm_b32 v180, v180, v176, s83
  v_perm_b32 v176, v181, v177, s82
  v_perm_b32 v181, v181, v177, s83
  v_perm_b32 v177, v182, v178, s82
  v_perm_b32 v182, v182, v178, s83
  v_perm_b32 v178, v183, v179, s82
  v_perm_b32 v183, v183, v179, s83
  s_nop 0
  s_waitcnt vmcnt(16)
  v_perm_b32 v179, v188, v184, s82
  v_perm_b32 v188, v188, v184, s83
  v_perm_b32 v184, v189, v185, s82
  v_perm_b32 v189, v189, v185, s83
  v_perm_b32 v185, v190, v186, s82
  v_perm_b32 v190, v190, v186, s83
  v_perm_b32 v186, v191, v187, s82
  v_perm_b32 v191, v191, v187, s83
  s_nop 0
  s_waitcnt vmcnt(14)
  v_perm_b32 v187, v196, v192, s82
  v_perm_b32 v196, v196, v192, s83
  v_perm_b32 v192, v197, v193, s82
  v_perm_b32 v197, v197, v193, s83
  v_perm_b32 v193, v198, v194, s82
  v_perm_b32 v198, v198, v194, s83
  v_perm_b32 v194, v199, v195, s82
  v_perm_b32 v199, v199, v195, s83
  s_nop 0
  s_waitcnt vmcnt(12)
  v_perm_b32 v195, v204, v200, s82
  v_perm_b32 v204, v204, v200, s83
  v_perm_b32 v200, v205, v201, s82
  v_perm_b32 v205, v205, v201, s83
  v_perm_b32 v201, v206, v202, s82
  v_perm_b32 v206, v206, v202, s83
  v_perm_b32 v202, v207, v203, s82
  v_perm_b32 v207, v207, v203, s83
  s_nop 0
  s_waitcnt vmcnt(10)
  v_perm_b32 v203, v212, v208, s82
  v_perm_b32 v212, v212, v208, s83
  v_perm_b32 v208, v213, v209, s82
  v_perm_b32 v213, v213, v209, s83
  v_perm_b32 v209, v214, v210, s82
  v_perm_b32 v214, v214, v210, s83
  v_perm_b32 v210, v215, v211, s82
  v_perm_b32 v215, v215, v211, s83
  s_nop 0
  s_waitcnt vmcnt(8)
  v_perm_b32 v211, v220, v216, s82
  v_perm_b32 v220, v220, v216, s83
  v_perm_b32 v216, v221, v217, s82
  v_perm_b32 v221, v221, v217, s83
  v_perm_b32 v217, v222, v218, s82
  v_perm_b32 v222, v222, v218, s83
  v_perm_b32 v218, v223, v219, s82
  v_perm_b32 v223, v223, v219, s83
  s_nop 0
  s_waitcnt vmcnt(6)
  v_perm_b32 v219, v228, v224, s82
  v_perm_b32 v228, v228, v224, s83
  v_perm_b32 v224, v229, v225, s82
  v_perm_b32 v229, v229, v225, s83
  v_perm_b32 v225, v230, v226, s82
  v_perm_b32 v230, v230, v226, s83
  v_perm_b32 v226, v231, v227, s82
  v_perm_b32 v231, v231, v227, s83
  s_nop 0
  s_waitcnt vmcnt(4)
  v_perm_b32 v227, v236, v232, s82
  v_perm_b32 v236, v236, v232, s83
  v_perm_b32 v232, v237, v233, s82
  v_perm_b32 v237, v237, v233, s83
  v_perm_b32 v233, v238, v234, s82
  v_perm_b32 v238, v238, v234, s83
  v_perm_b32 v234, v239, v235, s82
  v_perm_b32 v239, v239, v235, s83
  s_nop 0
  s_waitcnt vmcnt(2)
  v_perm_b32 v235, v244, v240, s82
  v_perm_b32 v244, v244, v240, s83
  v_perm_b32 v240, v245, v241, s82
  v_perm_b32 v245, v245, v241, s83
  v_perm_b32 v241, v246, v242, s82
  v_perm_b32 v246, v246, v242, s83
  v_perm_b32 v242, v247, v243, s82
  v_perm_b32 v247, v247, v243, s83
  s_nop 0
  s_waitcnt vmcnt(0)
  v_perm_b32 v243, v252, v248, s82
  v_perm_b32 v252, v252, v248, s83
  v_perm_b32 v248, v253, v249, s82
  v_perm_b32 v253, v253, v249, s83
  v_perm_b32 v249, v254, v250, s82
  v_perm_b32 v254, v254, v250, s83
  v_perm_b32 v250, v255, v251, s82
  v_perm_b32 v255, v255, v251, s83
  s_sub_u32 s87, s2, 64
  s_nop 0
  s_cmp_lt_u32 s2, 128
  s_cbranch_scc1 L_v_moddone
  s_and_b32 s75, s87, 7
  s_lshl_b32 s75, s75, 2
  s_lshr_b32 s76, s87, 3
  s_and_b32 s76, s76, 3
  s_add_u32 s75, s75, s76
  s_and_b32 s76, s87, 0xe0
  s_add_u32 s76, s76, s75
  s_lshl_b32 s76, s76, 5
  s_mul_i32 s77, s72, 786432
  s_add_u32 s76, s76, s77
  v_and_b32 v4, 7, v0
  v_lshlrev_b32_e64 v4, 10, v4
  v_bfe_u32 v5, v0, 3, 1
  v_lshl_add_u32 v4, v5, 7, v4
  v_lshl_add_u32 v4, v3, 4, v4
  s_lshl_b32 s77, s72, 8
  buffer_load_dwordx4 v[20:23], v4, s[56:59], s77 offen
  buffer_load_dwordx4 v[24:27], v4, s[56:59], s77 offen offset:64
  v_lshrrev_b32 v5, 1, v0
  v_mul_u32_u24 v5, 6144, v5
  v_and_b32_e64 v6, 1, v0
  v_lshl_add_u32 v5, v6, 4, v5
  s_add_u32 m0, s86, 0
  s_waitcnt vmcnt(0)
  buffer_load_dwordx4 v5, s[60:63], s76 offen  lds
  s_add_u32 s76, s76, 196608
  s_add_u32 m0, s86, 1024
  s_nop 0
  s_waitcnt vmcnt(0)
  buffer_load_dwordx4 v5, s[60:63], s76 offen  lds
  s_add_u32 s76, s76, 196608
  s_add_u32 m0, s86, 2048
  s_nop 0
  s_waitcnt vmcnt(0)
  buffer_load_dwordx4 v5, s[60:63], s76 offen  lds
  s_add_u32 s76, s76, 196608
  s_add_u32 m0, s86, 3072
  s_waitcnt vmcnt(0)
  buffer_load_dwordx4 v5, s[60:63], s76 offen  lds
  s_waitcnt vmcnt(4)
  v_lshlrev_b32_e64 v28, 16, v20
  v_and_b32 v29, 0xffff0000, v20
  v_mul_f32 v30, 0xbfb8aa3b, v28
  v_exp_f32 v30, v30
  s_nop 0
  v_add_f32_e64 v30, 1.0, v30
  v_min_f32 v30, 0x7f7fffff, v30
  v_rcp_f32 v32, v30
  s_nop 0
  v_mul_f32_e64 v34, v28, v32
  v_fma_f32 v28, -v34, v30, v28
  v_fma_f32 v28, v28, v32, v34
  v_mul_f32 v31, 0xbfb8aa3b, v29
  v_exp_f32 v31, v31
  s_nop 0
  v_add_f32_e64 v31, 1.0, v31
  v_min_f32 v31, 0x7f7fffff, v31
  v_rcp_f32 v33, v31
  s_nop 0
  v_mul_f32_e64 v35, v29, v33
  v_fma_f32 v29, -v35, v31, v29
  v_fma_f32 v29, v29, v33, v35
  v_cvt_pk_bf16_f32 v20, v28, v29
  v_lshlrev_b32_e64 v28, 16, v21
  v_and_b32 v29, 0xffff0000, v21
  v_mul_f32 v30, 0xbfb8aa3b, v28
  v_exp_f32 v30, v30
  s_nop 0
  v_add_f32_e64 v30, 1.0, v30
  v_min_f32 v30, 0x7f7fffff, v30
  v_rcp_f32 v32, v30
  s_nop 0
  v_mul_f32_e64 v34, v28, v32
  v_fma_f32 v28, -v34, v30, v28
  v_fma_f32 v28, v28, v32, v34
  v_mul_f32 v31, 0xbfb8aa3b, v29
  v_exp_f32 v31, v31
  s_nop 0
  v_add_f32_e64 v31, 1.0, v31
  v_min_f32 v31, 0x7f7fffff, v31
  v_rcp_f32 v33, v31
  s_nop 0
  v_mul_f32_e64 v35, v29, v33
  v_fma_f32 v29, -v35, v31, v29
  v_fma_f32 v29, v29, v33, v35
  v_cvt_pk_bf16_f32 v21, v28, v29
  v_lshlrev_b32_e64 v28, 16, v22
  v_and_b32 v29, 0xffff0000, v22
  v_mul_f32 v30, 0xbfb8aa3b, v28
  v_exp_f32 v30, v30
  s_nop 0
  v_add_f32_e64 v30, 1.0, v30
  v_min_f32 v30, 0x7f7fffff, v30
  v_rcp_f32 v32, v30
  s_nop 0
  v_mul_f32_e64 v34, v28, v32
  v_fma_f32 v28, -v34, v30, v28
  v_fma_f32 v28, v28, v32, v34
  v_mul_f32 v31, 0xbfb8aa3b, v29
  v_exp_f32 v31, v31
  s_nop 0
  v_add_f32_e64 v31, 1.0, v31
  v_min_f32 v31, 0x7f7fffff, v31
  v_rcp_f32 v33, v31
  s_nop 0
  v_mul_f32_e64 v35, v29, v33
  v_fma_f32 v29, -v35, v31, v29
  v_fma_f32 v29, v29, v33, v35
  v_cvt_pk_bf16_f32 v22, v28, v29
  v_lshlrev_b32_e64 v28, 16, v23
  v_and_b32 v29, 0xffff0000, v23
  v_mul_f32 v30, 0xbfb8aa3b, v28
  v_exp_f32 v30, v30
  s_nop 0
  v_add_f32_e64 v30, 1.0, v30
  v_min_f32 v30, 0x7f7fffff, v30
  v_rcp_f32 v32, v30
  s_nop 0
  v_mul_f32_e64 v34, v28, v32
  v_fma_f32 v28, -v34, v30, v28
  v_fma_f32 v28, v28, v32, v34
  v_mul_f32 v31, 0xbfb8aa3b, v29
  v_exp_f32 v31, v31
  s_nop 0
  v_add_f32_e64 v31, 1.0, v31
  v_min_f32 v31, 0x7f7fffff, v31
  v_rcp_f32 v33, v31
  s_nop 0
  v_mul_f32_e64 v35, v29, v33
  v_fma_f32 v29, -v35, v31, v29
  v_fma_f32 v29, v29, v33, v35
  v_cvt_pk_bf16_f32 v23, v28, v29
  v_lshlrev_b32_e64 v28, 16, v24
  v_and_b32 v29, 0xffff0000, v24
  v_mul_f32 v30, 0xbfb8aa3b, v28
  v_exp_f32 v30, v30
  s_nop 0
  v_add_f32_e64 v30, 1.0, v30
  v_min_f32 v30, 0x7f7fffff, v30
  v_rcp_f32 v32, v30
  s_nop 0
  v_mul_f32_e64 v34, v28, v32
  v_fma_f32 v28, -v34, v30, v28
  v_fma_f32 v28, v28, v32, v34
  v_mul_f32 v31, 0xbfb8aa3b, v29
  v_exp_f32 v31, v31
  s_nop 0
  v_add_f32_e64 v31, 1.0, v31
  v_min_f32 v31, 0x7f7fffff, v31
  v_rcp_f32 v33, v31
  s_nop 0
  v_mul_f32_e64 v35, v29, v33
  v_fma_f32 v29, -v35, v31, v29
  v_fma_f32 v29, v29, v33, v35
  v_cvt_pk_bf16_f32 v24, v28, v29
  v_lshlrev_b32_e64 v28, 16, v25
  v_and_b32 v29, 0xffff0000, v25
  v_mul_f32 v30, 0xbfb8aa3b, v28
  v_exp_f32 v30, v30
  s_nop 0
  v_add_f32_e64 v30, 1.0, v30
  v_min_f32 v30, 0x7f7fffff, v30
  v_rcp_f32 v32, v30
  s_nop 0
  v_mul_f32_e64 v34, v28, v32
  v_fma_f32 v28, -v34, v30, v28
  v_fma_f32 v28, v28, v32, v34
  v_mul_f32 v31, 0xbfb8aa3b, v29
  v_exp_f32 v31, v31
  s_nop 0
  v_add_f32_e64 v31, 1.0, v31
  v_min_f32 v31, 0x7f7fffff, v31
  v_rcp_f32 v33, v31
  s_nop 0
  v_mul_f32_e64 v35, v29, v33
  v_fma_f32 v29, -v35, v31, v29
  v_fma_f32 v29, v29, v33, v35
  v_cvt_pk_bf16_f32 v25, v28, v29
  v_lshlrev_b32_e64 v28, 16, v26
  v_and_b32 v29, 0xffff0000, v26
  v_mul_f32 v30, 0xbfb8aa3b, v28
  v_exp_f32 v30, v30
  s_nop 0
  v_add_f32_e64 v30, 1.0, v30
  v_min_f32 v30, 0x7f7fffff, v30
  v_rcp_f32 v32, v30
  s_nop 0
  v_mul_f32_e64 v34, v28, v32
  v_fma_f32 v28, -v34, v30, v28
  v_fma_f32 v28, v28, v32, v34
  v_mul_f32 v31, 0xbfb8aa3b, v29
  v_exp_f32 v31, v31
  s_nop 0
  v_add_f32_e64 v31, 1.0, v31
  v_min_f32 v31, 0x7f7fffff, v31
  v_rcp_f32 v33, v31
  s_nop 0
  v_mul_f32_e64 v35, v29, v33
  v_fma_f32 v29, -v35, v31, v29
  v_fma_f32 v29, v29, v33, v35
  v_cvt_pk_bf16_f32 v26, v28, v29
  v_lshlrev_b32_e64 v28, 16, v27
  v_and_b32 v29, 0xffff0000, v27
  v_mul_f32 v30, 0xbfb8aa3b, v28
  v_exp_f32 v30, v30
  s_nop 0
  v_add_f32_e64 v30, 1.0, v30
  v_min_f32 v30, 0x7f7fffff, v30
  v_rcp_f32 v32, v30
  s_nop 0
  v_mul_f32_e64 v34, v28, v32
  v_fma_f32 v28, -v34, v30, v28
  v_fma_f32 v28, v28, v32, v34
  v_mul_f32 v31, 0xbfb8aa3b, v29
  v_exp_f32 v31, v31
  s_nop 0
  v_add_f32_e64 v31, 1.0, v31
  v_min_f32 v31, 0x7f7fffff, v31
  v_rcp_f32 v33, v31
  s_nop 0
  v_mul_f32_e64 v35, v29, v33
  v_fma_f32 v29, -v35, v31, v29
  v_fma_f32 v29, v29, v33, v35
  v_cvt_pk_bf16_f32 v27, v28, v29
  v_lshrrev_b32 v4, 2, v2
  v_lshlrev_b32 v4, 5, v4
  v_lshl_add_u32 v4, v3, 8, v4
  v_and_b32_e64 v7, 3, v2
  v_lshl_add_u32 v4, v7, 3, v4
  v_add_u32 v4, s86, v4
  s_waitcnt vmcnt(0)
  ds_read_b64_tr_b16 v[76:77], v4 offset:0
  ds_read_b64_tr_b16 v[78:79], v4 offset:128
  ds_read_b64_tr_b16 v[80:81], v4 offset:1024
  ds_read_b64_tr_b16 v[82:83], v4 offset:1152
  ds_read_b64_tr_b16 v[84:85], v4 offset:2048
  ds_read_b64_tr_b16 v[86:87], v4 offset:2176
  ds_read_b64_tr_b16 v[88:89], v4 offset:3072
  ds_read_b64_tr_b16 v[90:91], v4 offset:3200
  s_nop 0
  s_waitcnt lgkmcnt(0)
  v_mfma_f32_16x16x32_bf16 v[52:55], v[20:23], v[76:79], 0
  v_mfma_f32_16x16x32_bf16 v[56:59], v[20:23], v[84:87], 0
  v_mfma_f32_16x16x32_bf16 v[52:55], v[24:27], v[80:83], v[52:55]
  v_mfma_f32_16x16x32_bf16 v[56:59], v[24:27], v[88:91], v[56:59]
  s_nop 0
  s_nop 6
  v_cndmask_b32 v68, v56, v52, s[84:85]
  v_cndmask_b32 v69, v57, v53, s[84:85]
  v_cndmask_b32 v70, v58, v54, s[84:85]
  v_cndmask_b32 v71, v59, v55, s[84:85]
  s_lshl_b32 s77, s72, 10
  v_add_u32 v5, s77, v1
  ds_write_b128 v5, v[68:71] offset:4352
  v_mov_b32_e64 v6, 0
  v_mov_b32 v5, 1
  s_mov_b64 exec, 1
  ds_add_rtn_u32 v5, v6, v5 offset:4
  s_mov_b64 exec, -1
  s_waitcnt lgkmcnt(0)
  v_readfirstlane_b32 s77, v5
  s_cmp_lg_u32 s77, 3
  s_cbranch_scc1 L_v_moddone
  v_and_b32 v4, 7, v0
  v_lshlrev_b32 v4, 5, v4
  v_lshrrev_b32 v7, 5, v0
  v_lshl_add_u32 v4, v7, 8, v4
  v_bfe_u32 v7, v0, 3, 2
  v_lshl_add_u32 v4, v7, 2, v4
  v_add_u32 v7, 4352, v4
  ds_read2_b32 v[76:77], v7 offset0:0 offset1:4
  ds_read2_b32 v[78:79], v7 offset0:128 offset1:132
  v_add_u32 v7, 1024, v7
  ds_read2_b32 v[80:81], v7 offset0:0 offset1:4
  ds_read2_b32 v[82:83], v7 offset0:128 offset1:132
  v_add_u32 v7, 1024, v7
  ds_read2_b32 v[84:85], v7 offset0:0 offset1:4
  ds_read2_b32 v[86:87], v7 offset0:128 offset1:132
  v_add_u32 v7, 1024, v7
  ds_read2_b32 v[88:89], v7 offset0:0 offset1:4
  ds_read2_b32 v[90:91], v7 offset0:128 offset1:132
  s_waitcnt lgkmcnt(0)
  v_add_f32 v76, v76, v84
  v_add_f32 v77, v77, v85
  v_add_f32 v78, v78, v86
  v_add_f32 v79, v79, v87
  v_add_f32 v80, v80, v88
  v_add_f32 v81, v81, v89
  v_add_f32 v82, v82, v90
  v_add_f32 v83, v83, v91
  v_add_f32 v76, v76, v80
  v_add_f32 v77, v77, v81
  v_add_f32 v78, v78, v82
  v_add_f32 v79, v79, v83
  v_add_f32 v39, v76, v78
  v_add_f32_e64 v40, v77, v79
  v_cvt_pk_bf16_f32 v68, v39, v40
  v_mov_b32_e64 v69, s80
  s_and_b32 s77, s87, 0xe0
  s_add_u32 s77, s77, s75
  s_lshl_b32 s77, s77, 9
  s_add_u32 s77, s77, 4096
  v_lshlrev_b32_e64 v4, 3, v0
  buffer_store_dwordx2 v[68:69], v4, s[52:55], s77 offen sc1
L_v_moddone:
  s_nop 7
  s_nop 3
  v_mov_b32 v24, 0
  v_mov_b32 v25, 0
  v_mov_b32 v26, 0
  v_mov_b32 v27, 0
  v_mov_b32 v28, 0
  v_mov_b32 v29, 0
  v_mov_b32 v60, 0
  v_mov_b32 v61, 0
  v_mov_b32 v62, 0
  v_mov_b32 v63, 0
  s_mov_b32 s90, 393216
  s_cmp_lt_u32 s88, 86
  s_cbranch_scc0 L_nof1w
  v_lshrrev_b32 v5, 1, v0
  v_mul_u32_u24 v5, 2752, v5
  v_and_b32_e64 v6, 1, v0
  v_lshl_add_u32 v5, v6, 4, v5
  s_mov_b32 s60, s28
  s_mov_b32 s61, s29
  s_mov_b32 s62, 1409024
  s_mov_b32 s63, 0x00020000
  s_mul_i32 s76, s72, 352256
  s_lshl_b32 s77, s88, 5
  s_add_u32 s76, s76, s77
  s_add_u32 m0, s86, 0
  s_waitcnt vmcnt(0)
  buffer_load_dwordx4 v5, s[60:63], s76 offen  lds
  s_add_u32 s76, s76, 88064
  s_add_u32 m0, s86, 1024
  s_nop 0
  s_waitcnt vmcnt(0)
  buffer_load_dwordx4 v5, s[60:63], s76 offen  lds
  s_add_u32 s76, s76, 88064
  s_add_u32 m0, s86, 2048
  s_nop 0
  s_waitcnt vmcnt(0)
  buffer_load_dwordx4 v5, s[60:63], s76 offen  lds
  s_add_u32 s76, s76, 88064
  s_add_u32 m0, s86, 3072
  s_nop 0
  s_waitcnt vmcnt(0)
  buffer_load_dwordx4 v5, s[60:63], s76 offen  lds
  s_mov_b32 s60, s30
  s_mov_b32 s61, s31
  s_mov_b32 s62, 1409024
  s_mov_b32 s63, 0x00020000
  s_mul_i32 s76, s72, 352256
  s_lshl_b32 s77, s88, 5
  s_add_u32 s76, s76, s77
  s_add_u32 m0, s86, 4096
  s_nop 0
  s_waitcnt vmcnt(0)
  buffer_load_dwordx4 v5, s[60:63], s76 offen  lds
  s_add_u32 s76, s76, 88064
  s_add_u32 m0, s86, 5120
  s_nop 0
  s_waitcnt vmcnt(0)
  buffer_load_dwordx4 v5, s[60:63], s76 offen  lds
  s_add_u32 s76, s76, 88064
  s_add_u32 m0, s86, 6144
  s_nop 0
  s_waitcnt vmcnt(0)
  buffer_load_dwordx4 v5, s[60:63], s76 offen  lds
  s_add_u32 s76, s76, 88064
  s_add_u32 m0, s86, 7168
  s_nop 0
  s_waitcnt vmcnt(0)
  buffer_load_dwordx4 v5, s[60:63], s76 offen  lds
  v_bfe_u32 v4, v2, 1, 1
  v_mul_u32_u24 v4, 24576, v4
  v_and_b32_e64 v7, 1, v2
  v_lshl_add_u32 v4, v7, 12, v4
  v_lshl_add_u32 v4, v3, 8, v4
  v_lshrrev_b32 v7, 2, v2
  v_lshl_add_u32 v4, v7, 5, v4
  s_lshl_b32 s77, s72, 3
  s_add_u32 s77, s77, 39424
  v_add_u32 v27, s77, v4
  v_mov_b32 v6, 0
  v_mov_b32_e64 v5, 1
  s_waitcnt vmcnt(0)
  s_mov_b64 exec, 1
  ds_add_u32 v6, v5 offset:20
  s_mov_b64 exec, -1
  s_mov_b32 s81, 0
L_w_stg:
  s_nop 7
  s_nop 3
  ds_read_b32 v7, v6 offset:20
  s_waitcnt lgkmcnt(0)
  v_readfirstlane_b32 s77, v7
  s_cmp_ge_u32 s77, 4
  s_cbranch_scc1 L_w_stg_ok
  s_add_u32 s81, s81, 1
  s_cmp_lt_u32 s81, 400000
  s_cbranch_scc0 L_w_stg_ok
  s_sleep 8
  s_branch L_w_stg
L_w_stg_ok:
  s_nop 7
  s_nop 3
  ds_read_b64_tr_b16 v[76:77], v27 offset:0
  ds_read_b64_tr_b16 v[78:79], v27 offset:128
  ds_read_b64_tr_b16 v[80:81], v27 offset:1024
  ds_read_b64_tr_b16 v[82:83], v27 offset:1152
  ds_read_b64_tr_b16 v[84:85], v27 offset:2048
  ds_read_b64_tr_b16 v[86:87], v27 offset:2176
  ds_read_b64_tr_b16 v[88:89], v27 offset:3072
  ds_read_b64_tr_b16 v[90:91], v27 offset:3200
  ds_read_b64_tr_b16 v[92:93], v27 offset:12288
  ds_read_b64_tr_b16 v[94:95], v27 offset:12416
  ds_read_b64_tr_b16 v[96:97], v27 offset:13312
  ds_read_b64_tr_b16 v[98:99], v27 offset:13440
  ds_read_b64_tr_b16 v[100:101], v27 offset:14336
  ds_read_b64_tr_b16 v[102:103], v27 offset:14464
  ds_read_b64_tr_b16 v[104:105], v27 offset:15360
  ds_read_b64_tr_b16 v[106:107], v27 offset:15488
  v_mov_b32 v6, 0
  s_mov_b32 s81, 0
L_wk1:
  s_nop 7
  s_nop 3
  ds_read_b32 v7, v6 offset:12
  s_waitcnt lgkmcnt(0)
  v_readfirstlane_b32 s77, v7
  s_cmp_ge_u32 s77, 1
  s_cbranch_scc1 L_wk1_ok
  s_add_u32 s81, s81, 1
  s_cmp_lt_u32 s81, 400000
  s_cbranch_scc0 L_wk1_ok
  s_sleep 16
  s_branch L_wk1
L_wk1_ok:
  s_nop 7
  s_nop 3
  v_lshrrev_b32 v4, 2, v0
  v_lshlrev_b32 v4, 9, v4
  v_and_b32 v5, 3, v0
  v_lshl_add_u32 v4, v5, 4, v4
  s_lshl_b32 s75, s72, 7
  s_add_u32 s75, s75, 53248
  s_add_u32 s76, s75, 8192
  s_add_u32 s78, s75, 16384
  s_add_u32 s91, s75, 24576
  s_mov_b32 s81, 0
L_poll_sb0:
  s_nop 7
  s_nop 0
  s_nop 2
  buffer_load_dwordx4 v[8:11], v4, s[52:55], s75 offen offset:0 sc1
  buffer_load_dwordx4 v[12:15], v4, s[52:55], s76 offen offset:0 sc1
  buffer_load_dwordx4 v[16:19], v4, s[52:55], s78 offen offset:0 sc1
  buffer_load_dwordx4 v[20:23], v4, s[52:55], s91 offen offset:0 sc1
  s_waitcnt vmcnt(0)
  v_xor_b32 v7, s80, v9
  v_bitop3_b32 v7, v11, s80, v7 bitop3:0xbe
  v_bitop3_b32 v7, v13, s80, v7 bitop3:0xbe
  v_bitop3_b32 v7, v15, s80, v7 bitop3:0xbe
  v_bitop3_b32 v7, v17, s80, v7 bitop3:0xbe
  v_bitop3_b32 v7, v19, s80, v7 bitop3:0xbe
  v_bitop3_b32 v7, v21, s80, v7 bitop3:0xbe
  v_bitop3_b32 v7, v23, s80, v7 bitop3:0xbe
  v_cmp_ne_u32_e64 vcc, 0, v7
  s_cbranch_vccz L_poll_sb0_ok
  s_add_u32 s81, s81, 1
  s_cmp_lt_u32 s81, 100000
  s_cbranch_scc0 L_poll_sb0_ok
  s_sleep 32
  s_branch L_poll_sb0
L_poll_sb0_ok:
  s_nop 7
  s_nop 3
  v_lshlrev_b32 v108, 16, v8
  v_and_b32 v109, 0xffff0000, v8
  v_lshlrev_b32_e64 v52, 16, v16
  v_and_b32 v53, 0xffff0000, v16
  v_add_f32 v52, 1.0, v52
  v_add_f32 v53, 1.0, v53
  v_cvt_pk_bf16_f32 v39, v52, v53
  v_lshlrev_b32_e64 v52, 16, v39
  v_and_b32 v53, 0xffff0000, v39
  v_lshlrev_b32_e64 v110, 16, v10
  v_and_b32 v111, 0xffff0000, v10
  v_lshlrev_b32_e64 v54, 16, v18
  v_and_b32 v55, 0xffff0000, v18
  v_add_f32 v54, 1.0, v54
  v_add_f32 v55, 1.0, v55
  v_cvt_pk_bf16_f32 v39, v54, v55
  v_lshlrev_b32_e64 v54, 16, v39
  v_and_b32 v55, 0xffff0000, v39
  v_lshlrev_b32_e64 v112, 16, v12
  v_and_b32 v113, 0xffff0000, v12
  v_lshlrev_b32_e64 v56, 16, v20
  v_and_b32 v57, 0xffff0000, v20
  v_add_f32 v56, 1.0, v56
  v_add_f32 v57, 1.0, v57
  v_cvt_pk_bf16_f32 v39, v56, v57
  v_lshlrev_b32_e64 v56, 16, v39
  v_and_b32 v57, 0xffff0000, v39
  v_lshlrev_b32_e64 v114, 16, v14
  v_and_b32 v115, 0xffff0000, v14
  v_lshlrev_b32_e64 v58, 16, v22
  v_and_b32 v59, 0xffff0000, v22
  v_add_f32 v58, 1.0, v58
  v_add_f32 v59, 1.0, v59
  v_cvt_pk_bf16_f32 v39, v58, v59
  v_lshlrev_b32_e64 v58, 16, v39
  v_and_b32 v59, 0xffff0000, v39
  s_mov_b32 s81, 0
L_poll_sb1:
  s_nop 7
  s_nop 0
  s_nop 2
  buffer_load_dwordx4 v[8:11], v4, s[52:55], s75 offen offset:64 sc1
  buffer_load_dwordx4 v[12:15], v4, s[52:55], s76 offen offset:64 sc1
  buffer_load_dwordx4 v[16:19], v4, s[52:55], s78 offen offset:64 sc1
  buffer_load_dwordx4 v[20:23], v4, s[52:55], s91 offen offset:64 sc1
  s_waitcnt vmcnt(0)
  v_xor_b32 v7, s80, v9
  v_bitop3_b32 v7, v11, s80, v7 bitop3:0xbe
  v_bitop3_b32 v7, v13, s80, v7 bitop3:0xbe
  v_bitop3_b32 v7, v15, s80, v7 bitop3:0xbe
  v_bitop3_b32 v7, v17, s80, v7 bitop3:0xbe
  v_bitop3_b32 v7, v19, s80, v7 bitop3:0xbe
  v_bitop3_b32 v7, v21, s80, v7 bitop3:0xbe
  v_bitop3_b32 v7, v23, s80, v7 bitop3:0xbe
  v_cmp_ne_u32_e64 vcc, 0, v7
  s_cbranch_vccz L_poll_sb1_ok
  s_add_u32 s81, s81, 1
  s_cmp_lt_u32 s81, 100000
  s_cbranch_scc0 L_poll_sb1_ok
  s_sleep 32
  s_branch L_poll_sb1
L_poll_sb1_ok:
  s_nop 7
  s_nop 3
  v_lshlrev_b32 v116, 16, v8
  v_and_b32 v117, 0xffff0000, v8
  v_lshlrev_b32_e64 v60, 16, v16
  v_and_b32 v61, 0xffff0000, v16
  v_add_f32 v60, 1.0, v60
  v_add_f32 v61, 1.0, v61
  v_cvt_pk_bf16_f32 v39, v60, v61
  v_lshlrev_b32_e64 v60, 16, v39
  v_and_b32 v61, 0xffff0000, v39
  v_lshlrev_b32_e64 v118, 16, v10
  v_and_b32 v119, 0xffff0000, v10
  v_lshlrev_b32_e64 v62, 16, v18
  v_and_b32 v63, 0xffff0000, v18
  v_add_f32 v62, 1.0, v62
  v_add_f32 v63, 1.0, v63
  v_cvt_pk_bf16_f32 v39, v62, v63
  v_lshlrev_b32_e64 v62, 16, v39
  v_and_b32 v63, 0xffff0000, v39
  v_lshlrev_b32_e64 v120, 16, v12
  v_and_b32 v121, 0xffff0000, v12
  v_lshlrev_b32_e64 v64, 16, v20
  v_and_b32 v65, 0xffff0000, v20
  v_add_f32 v64, 1.0, v64
  v_add_f32 v65, 1.0, v65
  v_cvt_pk_bf16_f32 v39, v64, v65
  v_lshlrev_b32_e64 v64, 16, v39
  v_and_b32 v65, 0xffff0000, v39
  v_lshlrev_b32_e64 v122, 16, v14
  v_and_b32 v123, 0xffff0000, v14
  v_lshlrev_b32_e64 v66, 16, v22
  v_and_b32 v67, 0xffff0000, v22
  v_add_f32 v66, 1.0, v66
  v_add_f32 v67, 1.0, v67
  v_cvt_pk_bf16_f32 v39, v66, v67
  v_lshlrev_b32_e64 v66, 16, v39
  v_and_b32 v67, 0xffff0000, v39
  s_mul_i32 s77, s72, 2080
  v_lshlrev_b32 v24, 3, v0
  v_add_u32 v24, s77, v24
  v_and_b32_e64 v25, 7, v0
  v_mul_u32_u24 v25, 1040, v25
  v_bfe_u32 v5, v0, 3, 1
  v_lshl_add_u32 v25, v5, 9, v25
  v_lshl_add_u32 v25, v3, 4, v25
  v_bfe_u32 v26, v0, 4, 1
  v_lshlrev_b32 v26, 6, v26
  v_lshrrev_b32 v5, 5, v0
  v_lshl_add_u32 v26, v5, 5, v26
  v_bfe_u32 v5, v0, 1, 1
  v_lshl_add_u32 v26, v5, 4, v26
  s_bfe_u32 s90, s88, 0x20002
  s_lshl_b32 s90, s90, 11
  s_lshr_b32 s77, s88, 4
  s_lshl_b32 s77, s77, 14
  s_add_u32 s90, s90, s77
  s_bfe_u32 s77, s88, 0x10001
  s_lshl_b32 s77, s77, 7
  s_add_u32 s90, s90, s77
  s_and_b32 s77, s88, 1
  s_lshl_b32 s77, s77, 9
  s_add_u32 s90, s90, s77
  s_and_b32 s77, s72, 1
  s_lshl_b32 s77, s77, 10
  s_add_u32 s90, s90, s77
  s_lshr_b32 s77, s72, 1
  s_lshl_b32 s77, s77, 8
  s_add_u32 s90, s90, s77
  s_add_u32 s90, s90, 393216
  v_lshrrev_b32 v28, 2, v0
  v_lshlrev_b32 v28, 7, v28
  v_and_b32 v5, 3, v0
  v_lshl_add_u32 v28, v5, 4, v28
  s_and_b32 s77, s2, 3
  s_lshl_b32 s77, s77, 15
  v_add_u32 v28, s77, v28
  s_waitcnt lgkmcnt(0)
  s_branch L_wdone
L_nof1w:
  s_nop 7
  s_nop 3
  s_mov_b32 s75, s89
  s_cmp_lt_u32 s75, 32
  s_cbranch_scc0 L_wdone
  v_lshrrev_b32 v38, 2, v2
  v_lshlrev_b32 v38, 5, v38
  v_lshl_add_u32 v38, v3, 8, v38
  v_and_b32_e64 v7, 3, v2
  v_lshl_add_u32 v38, v7, 3, v38
  v_add_u32_e64 v38, s86, v38
  s_mov_b32 s60, s32
  s_mov_b32 s61, s33
  s_mov_b32 s62, 1409024
  s_mov_b32 s63, 0x00020000
  v_lshrrev_b32 v5, 1, v0
  v_lshlrev_b32 v5, 10, v5
  v_and_b32_e64 v6, 1, v0
  v_lshl_add_u32 v5, v6, 4, v5
  s_mul_i32 s78, s72, 12
  s_lshl_b32 s77, s75, 5
  s_add_u32 s76, s78, 0
  s_min_u32 s76, s76, 42
  s_lshl_b32 s76, s76, 15
  s_add_u32 s76, s76, s77
  s_add_u32 m0, s86, 0
  s_waitcnt vmcnt(0)
  buffer_load_dwordx4 v5, s[60:63], s76 offen  lds
  s_add_u32 s76, s78, 1
  s_min_u32 s76, s76, 42
  s_lshl_b32 s76, s76, 15
  s_add_u32 s76, s76, s77
  s_add_u32 m0, s86, 1024
  s_waitcnt vmcnt(0)
  buffer_load_dwordx4 v5, s[60:63], s76 offen  lds
  s_add_u32 s76, s78, 2
  s_min_u32 s76, s76, 42
  s_lshl_b32 s76, s76, 15
  s_add_u32 s76, s76, s77
  s_add_u32 m0, s86, 2048
  s_waitcnt vmcnt(0)
  buffer_load_dwordx4 v5, s[60:63], s76 offen  lds
  s_add_u32 s76, s78, 3
  s_min_u32 s76, s76, 42
  s_lshl_b32 s76, s76, 15
  s_add_u32 s76, s76, s77
  s_add_u32 m0, s86, 3072
  s_waitcnt vmcnt(0)
  buffer_load_dwordx4 v5, s[60:63], s76 offen  lds
  s_add_u32 s76, s78, 4
  s_min_u32 s76, s76, 42
  s_lshl_b32 s76, s76, 15
  s_add_u32 s76, s76, s77
  s_add_u32 m0, s86, 4096
  s_waitcnt vmcnt(0)
  buffer_load_dwordx4 v5, s[60:63], s76 offen  lds
  s_add_u32 s76, s78, 5
  s_min_u32 s76, s76, 42
  s_lshl_b32 s76, s76, 15
  s_add_u32 s76, s76, s77
  s_add_u32 m0, s86, 5120
  s_waitcnt vmcnt(0)
  buffer_load_dwordx4 v5, s[60:63], s76 offen  lds
  s_add_u32 s76, s78, 6
  s_min_u32 s76, s76, 42
  s_lshl_b32 s76, s76, 15
  s_add_u32 s76, s76, s77
  s_add_u32 m0, s86, 6144
  s_waitcnt vmcnt(0)
  buffer_load_dwordx4 v5, s[60:63], s76 offen  lds
  s_add_u32 s76, s78, 7
  s_min_u32 s76, s76, 42
  s_lshl_b32 s76, s76, 15
  s_add_u32 s76, s76, s77
  s_add_u32 m0, s86, 7168
  s_waitcnt vmcnt(0)
  buffer_load_dwordx4 v5, s[60:63], s76 offen  lds
  s_add_u32 s76, s78, 8
  s_min_u32 s76, s76, 42
  s_lshl_b32 s76, s76, 15
  s_add_u32 s76, s76, s77
  s_add_u32 m0, s86, 8192
  s_waitcnt vmcnt(0)
  buffer_load_dwordx4 v5, s[60:63], s76 offen  lds
  s_add_u32 s76, s78, 9
  s_min_u32 s76, s76, 42
  s_lshl_b32 s76, s76, 15
  s_add_u32 s76, s76, s77
  s_add_u32 m0, s86, 9216
  s_waitcnt vmcnt(0)
  buffer_load_dwordx4 v5, s[60:63], s76 offen  lds
  s_add_u32 s76, s78, 10
  s_min_u32 s76, s76, 42
  s_lshl_b32 s76, s76, 15
  s_add_u32 s76, s76, s77
  s_add_u32 m0, s86, 10240
  s_waitcnt vmcnt(0)
  buffer_load_dwordx4 v5, s[60:63], s76 offen  lds
  s_add_u32 s76, s78, 11
  s_min_u32 s76, s76, 42
  s_lshl_b32 s76, s76, 15
  s_add_u32 s76, s76, s77
  s_add_u32 m0, s86, 11264
  s_waitcnt vmcnt(0)
  buffer_load_dwordx4 v5, s[60:63], s76 offen  lds
  s_waitcnt vmcnt(0)
  ds_read_b64_tr_b16 v[76:77], v38 offset:0
  ds_read_b64_tr_b16 v[78:79], v38 offset:128
  ds_read_b64_tr_b16 v[80:81], v38 offset:1024
  ds_read_b64_tr_b16 v[82:83], v38 offset:1152
  ds_read_b64_tr_b16 v[84:85], v38 offset:2048
  ds_read_b64_tr_b16 v[86:87], v38 offset:2176
  ds_read_b64_tr_b16 v[88:89], v38 offset:3072
  ds_read_b64_tr_b16 v[90:91], v38 offset:3200
  ds_read_b64_tr_b16 v[92:93], v38 offset:4096
  ds_read_b64_tr_b16 v[94:95], v38 offset:4224
  ds_read_b64_tr_b16 v[96:97], v38 offset:5120
  ds_read_b64_tr_b16 v[98:99], v38 offset:5248
  ds_read_b64_tr_b16 v[100:101], v38 offset:6144
  ds_read_b64_tr_b16 v[102:103], v38 offset:6272
  ds_read_b64_tr_b16 v[104:105], v38 offset:7168
  ds_read_b64_tr_b16 v[106:107], v38 offset:7296
  ds_read_b64_tr_b16 v[108:109], v38 offset:8192
  ds_read_b64_tr_b16 v[110:111], v38 offset:8320
  ds_read_b64_tr_b16 v[112:113], v38 offset:9216
  ds_read_b64_tr_b16 v[114:115], v38 offset:9344
  ds_read_b64_tr_b16 v[116:117], v38 offset:10240
  ds_read_b64_tr_b16 v[118:119], v38 offset:10368
  ds_read_b64_tr_b16 v[120:121], v38 offset:11264
  ds_read_b64_tr_b16 v[122:123], v38 offset:11392
  v_mov_b32 v6, 0
  s_mov_b32 s81, 0
L_wk2:
  s_nop 7
  s_nop 3
  ds_read_b32 v7, v6 offset:12
  s_waitcnt lgkmcnt(0)
  v_readfirstlane_b32 s77, v7
  s_cmp_ge_u32 s77, 1
  s_cbranch_scc1 L_wk2_ok
  s_add_u32 s81, s81, 1
  s_cmp_lt_u32 s81, 400000
  s_cbranch_scc0 L_wk2_ok
  s_sleep 16
  s_branch L_wk2
L_wk2_ok:
  s_nop 7
  s_nop 3
  v_lshlrev_b32 v4, 3, v0
  s_lshl_b32 s77, s75, 9
  s_add_u32 s77, s77, 86016
  s_mov_b32 s81, 0
L_poll_gb:
  s_nop 7
  s_nop 0
  s_nop 2
  buffer_load_dwordx2 v[8:9], v4, s[52:55], s77 offen sc1
  s_waitcnt vmcnt(0)
  v_xor_b32 v7, s80, v9
  v_cmp_ne_u32_e64 vcc, 0, v7
  s_cbranch_vccz L_poll_gb_ok
  s_add_u32 s81, s81, 1
  s_cmp_lt_u32 s81, 100000
  s_cbranch_scc0 L_poll_gb_ok
  s_sleep 32
  s_branch L_poll_gb
L_poll_gb_ok:
  s_nop 7
  s_nop 3
  v_mov_b32 v125, v8
  v_bfe_u32 v5, v0, 3, 1
  s_mul_i32 s78, s72, 12
  v_add_u32 v5, s78, v5
  v_and_b32 v4, 880, v1
  v_add_u32 v4, 83968, v4
  s_mul_i32 s78, s72, 12288
  s_mul_i32 s77, s72, 6
  s_add_u32 s77, s77, 0
  s_and_b32 s78, s77, 3
  s_lshl_b32 s78, s78, 11
  s_lshr_b32 s77, s77, 2
  s_lshl_b32 s77, s77, 14
  s_add_u32 s78, s78, s77
  v_add_u32 v6, 0, v5
  v_cmp_gt_u32 vcc, 43, v6
  s_nop 1
  v_cndmask_b32 v30, 0, -1, vcc
  v_add_u32 v6, s78, v1
  v_cndmask_b32 v24, v4, v6, vcc
  s_add_u32 s78, s78, 2048
  s_mul_i32 s77, s72, 6
  s_add_u32 s77, s77, 1
  s_and_b32 s78, s77, 3
  s_lshl_b32 s78, s78, 11
  s_lshr_b32 s77, s77, 2
  s_lshl_b32 s77, s77, 14
  s_add_u32 s78, s78, s77
  v_add_u32 v6, 2, v5
  v_cmp_gt_u32 vcc, 43, v6
  s_nop 1
  v_cndmask_b32 v31, 0, -1, vcc
  v_add_u32 v6, s78, v1
  v_cndmask_b32 v25, v4, v6, vcc
  s_add_u32 s78, s78, 2048
  s_mul_i32 s77, s72, 6
  s_add_u32 s77, s77, 2
  s_and_b32 s78, s77, 3
  s_lshl_b32 s78, s78, 11
  s_lshr_b32 s77, s77, 2
  s_lshl_b32 s77, s77, 14
  s_add_u32 s78, s78, s77
  v_add_u32 v6, 4, v5
  v_cmp_gt_u32 vcc, 43, v6
  s_nop 1
  v_cndmask_b32 v32, 0, -1, vcc
  v_add_u32 v6, s78, v1
  v_cndmask_b32 v26, v4, v6, vcc
  s_add_u32 s78, s78, 2048
  s_mul_i32 s77, s72, 6
  s_add_u32 s77, s77, 3
  s_and_b32 s78, s77, 3
  s_lshl_b32 s78, s78, 11
  s_lshr_b32 s77, s77, 2
  s_lshl_b32 s77, s77, 14
  s_add_u32 s78, s78, s77
  v_add_u32 v6, 6, v5
  v_cmp_gt_u32 vcc, 43, v6
  s_nop 1
  v_cndmask_b32 v33, 0, -1, vcc
  v_add_u32 v6, s78, v1
  v_cndmask_b32 v27, v4, v6, vcc
  s_add_u32 s78, s78, 2048
  s_mul_i32 s77, s72, 6
  s_add_u32 s77, s77, 4
  s_and_b32 s78, s77, 3
  s_lshl_b32 s78, s78, 11
  s_lshr_b32 s77, s77, 2
  s_lshl_b32 s77, s77, 14
  s_add_u32 s78, s78, s77
  v_add_u32 v6, 8, v5
  v_cmp_gt_u32 vcc, 43, v6
  s_nop 1
  v_cndmask_b32 v34, 0, -1, vcc
  v_add_u32 v6, s78, v1
  v_cndmask_b32 v28, v4, v6, vcc
  s_add_u32 s78, s78, 2048
  s_mul_i32 s77, s72, 6
  s_add_u32 s77, s77, 5
  s_and_b32 s78, s77, 3
  s_lshl_b32 s78, s78, 11
  s_lshr_b32 s77, s77, 2
  s_lshl_b32 s77, s77, 14
  s_add_u32 s78, s78, s77
  v_add_u32 v6, 10, v5
  v_cmp_gt_u32 vcc, 43, v6
  s_nop 1
  v_cndmask_b32 v35, 0, -1, vcc
  v_add_u32 v6, s78, v1
  v_cndmask_b32 v29, v4, v6, vcc
  v_lshrrev_b32 v60, 3, v0
  v_lshlrev_b32 v62, 10, v60
  v_and_b32 v60, 5, v60
  v_lshlrev_b32 v60, 12, v60
  v_bfe_u32 v5, v0, 4, 1
  v_lshl_add_u32 v60, v5, 17, v60
  v_and_b32_e64 v5, 7, v0
  v_lshl_add_u32 v60, v5, 3, v60
  s_and_b32 s77, s2, 3
  s_lshl_b32 s77, s77, 15
  v_add_u32_e64 v60, s77, v60
  v_lshl_add_u32 v62, v5, 2, v62
  v_and_b32 v61, 7, v0
  v_lshlrev_b32 v61, 5, v61
  v_lshrrev_b32_e64 v7, 5, v0
  v_lshl_add_u32 v61, v7, 8, v61
  v_bfe_u32 v7, v0, 3, 2
  v_lshl_add_u32 v61, v7, 2, v61
  s_lshl_b32 s77, s72, 10
  v_add_u32 v63, s77, v1
  s_waitcnt lgkmcnt(0)
L_wdone:
  s_nop 7
  s_nop 0
  s_nop 2
  s_cmp_lg_u32 s72, 1
  s_cbranch_scc1 L_nm_end
  s_sub_u32 s77, s2, 192
  s_cmp_ge_u32 s77, 16
  s_cbranch_scc1 L_nm_end
  s_mul_i32 s77, s77, 4
  s_mov_b32 s22, 0
  s_mov_b32 s81, 0
L_nm:
  s_nop 7
  s_nop 0
  s_nop 2
  s_and_b32 s78, s77, 63
  s_lshl_b32 s78, s78, 7
  s_lshr_b32 s76, s77, 6
  s_lshl_b32 s76, s76, 14
  s_add_u32 s78, s78, s76
  s_and_b32 s76, s77, 1
  s_lshl_b32 s76, s76, 13
  s_add_u32 s78, s78, s76
  s_add_u32 s78, s78, 786432
  s_xor_b32 s23, s78, 0x2000
  s_memtime s[92:93]
  s_waitcnt lgkmcnt(0)
  s_buffer_load_dword s76, s[52:55], s78
  s_waitcnt lgkmcnt(0)
  s_memtime s[94:95]
  s_waitcnt lgkmcnt(0)
  s_buffer_load_dword s76, s[52:55], s23
  s_waitcnt lgkmcnt(0)
  s_memtime s[24:25]
  s_waitcnt lgkmcnt(0)
  s_sub_u32 s75, s94, s92
  s_sub_u32 s76, s24, s94
  s_sub_u32 s75, s75, s76
  s_min_i32 s75, s75, 1024
  s_max_i32 s75, s75, -1024
  s_lshr_b32 s76, s2, 2
  s_xor_b32 s76, s76, s77
  s_sub_u32 s78, 0, s75
  s_bitcmp1_b32 s76, 0
  s_cselect_b32 s75, s78, s75
  s_add_u32 s22, s22, s75
  s_add_u32 s77, s77, 1
  s_add_u32 s81, s81, 1
  s_cmp_lt_u32 s81, 4
  s_cbranch_scc1 L_nm
  v_mov_b32 v6, 0
  v_mov_b32 v68, s22
  v_mov_b32 v69, s80
  s_lshl_b32 s77, s2, 3
  s_add_u32 s77, s77, 375296
  s_mov_b64 exec, 1
  buffer_store_dwordx2 v[68:69], v6, s[52:55], s77 offen sc1
  s_mov_b64 exec, -1
L_nm_end:
  s_nop 7
  s_nop 3
  v_mov_b32 v6, 0
  s_mov_b32 s81, 0
L_wk3:
  s_nop 7
  s_nop 3
  ds_read_b32 v7, v6 offset:12
  s_waitcnt lgkmcnt(0)
  v_readfirstlane_b32 s77, v7
  s_cmp_ge_u32 s77, 1
  s_cbranch_scc1 L_wk3_ok
  s_add_u32 s81, s81, 1
  s_cmp_lt_u32 s81, 400000
  s_cbranch_scc0 L_wk3_ok
  s_sleep 16
  s_branch L_wk3
L_wk3_ok:
  s_nop 7
  s_nop 3
  v_and_b32 v5, 3, v0
  v_lshrrev_b32 v6, 5, v0
  v_lshl_add_u32 v5, v5, 1, v6
  v_lshlrev_b32 v36, 3, v5
  s_lshl_b32 s77, s73, 6
  s_lshl_b32 s78, s74, 9
  s_add_u32 s77, s77, s78
  s_add_u32 s77, s77, 36864
  s_mov_b32 s81, 0
L_poll_ga:
  s_nop 7
  s_nop 0
  s_nop 2
  buffer_load_dwordx2 v[8:9], v36, s[52:55], s77 offen sc1
  s_waitcnt vmcnt(0)
  v_xor_b32 v7, s80, v9
  v_cmp_ne_u32_e64 vcc, 0, v7
  s_cbranch_vccz L_poll_ga_ok
  s_add_u32 s81, s81, 1
  s_cmp_lt_u32 s81, 100000
  s_cbranch_scc0 L_poll_ga_ok
  s_sleep 32
  s_branch L_poll_ga
L_poll_ga_ok:
  s_nop 7
  s_nop 3
  v_mov_b32 v124, v8
  v_bfe_u32 v4, v0, 2, 1
  v_lshl_add_u32 v36, v4, 6, v36
  v_bfe_u32 v4, v0, 3, 2
  v_lshl_add_u32 v36, v4, 15, v36
  v_lshlrev_b32 v4, 2, v5
  s_lshl_b32 s77, s73, 10
  s_lshl_b32 s78, s74, 5
  s_add_u32 s77, s77, s78
  buffer_load_dword v126, v4, s[44:47], s77 offen
  v_lshlrev_b32_e64 v4, 5, v2
  v_lshl_add_u32 v4, v3, 3, v4
  v_bfe_u32 v5, v2, 2, 1
  v_lshlrev_b32 v5, 12, v5
  v_lshrrev_b32 v6, 3, v2
  v_lshl_add_u32 v5, v6, 14, v5
  v_and_b32_e64 v6, 3, v2
  v_lshl_add_u32 v5, v6, 5, v5
  v_lshl_add_u32 v5, v3, 3, v5
  v_lshrrev_b32 v37, 2, v0
  v_lshlrev_b32 v37, 7, v37
  v_and_b32 v6, 3, v0
  v_lshl_add_u32 v37, v6, 4, v37
  s_lshl_b32 s87, s73, 17
  s_lshl_b32 s78, s72, 15
  s_add_u32 s87, s87, s78
  s_lshl_b32 s78, s79, 7
  s_add_u32 s87, s87, s78
  s_add_u32 s87, s87, 1048576
  v_lshrrev_b32 v6, 5, v0
  v_lshlrev_b32 v6, 4, v6
  v_lshrrev_b32 v8, v6, s80
  v_and_b32 v6, 1, v0
  v_lshlrev_b32 v6, 4, v6
  v_lshrrev_b32 v16, v6, s80
  v_lshrrev_b32 v9, 4, v8
  v_lshrrev_b32 v17, 4, v16
  v_lshrrev_b32 v10, 8, v8
  v_lshrrev_b32 v18, 8, v16
  v_lshrrev_b32 v11, 12, v8
  v_lshrrev_b32 v19, 12, v16
  v_and_b32 v16, 15, v16
  v_and_b32 v17, 15, v17
  v_and_b32 v18, 15, v18
  v_and_b32 v19, 15, v19
  s_waitcnt vmcnt(0)
  s_mov_b64 s[34:35], 0
  s_mov_b64 exec, 0
  s_nop 4
  s_branch L_vlast
L_real:
  s_nop 7
  s_nop 3
  s_mov_b64 s[34:35], -1
  s_mov_b64 exec, -1
  v_mov_b32 v6, 0
  s_cmp_lg_u32 s72, 0
  s_cbranch_scc1 L_nv_end
  s_mov_b32 s81, 0
L_nv:
  s_nop 7
  s_nop 0
  s_nop 2
  ds_read2_b32 v[68:69], v6 offset0:2 offset1:4
  s_memrealtime s[92:93]
  s_waitcnt lgkmcnt(0)
  v_readfirstlane_b32 s77, v68
  v_readfirstlane_b32 s78, v69
  s_cmp_lg_u32 s77, 0
  s_cbranch_scc1 L_nv_end
  s_sub_u32 s92, s92, s78
  s_cmp_ge_i32 s92, 5009
  s_cbranch_scc1 L_nv_go
  s_add_u32 s81, s81, 1
  s_cmp_lt_u32 s81, 100000
  s_cbranch_scc0 L_nv_end
  s_sleep 32
  s_branch L_nv
L_nv_go:
  s_nop 7
  s_nop 3
  v_lshlrev_b32 v68, 3, v0
  s_mov_b32 s77, 376832
  v_not_b32 v46, s80
  v_not_b32 v47, s80
  v_not_b32 v48, s80
  v_not_b32 v49, s80
  v_not_b32 v50, s80
  v_not_b32 v51, s80
  buffer_load_dwordx2 v[44:45], v68, s[52:55], s77 offen
  s_waitcnt vmcnt(0)
  v_cmp_eq_u32 vcc, s80, v45
  s_nop 1
  v_cndmask_b32 v44, 0, v44, vcc
  v_cmp_eq_u32 vcc, s80, v47
  s_nop 1
  v_cndmask_b32 v46, 0, v46, vcc
  v_cmp_eq_u32 vcc, s80, v49
  s_nop 1
  v_cndmask_b32 v48, 0, v48, vcc
  v_cmp_eq_u32 vcc, s80, v51
  s_nop 1
  v_cndmask_b32 v50, 0, v50, vcc
  v_add_u32 v44, v44, v46
  v_add3_u32 v44, v44, v48, v50
  s_nop 0
  s_nop 0
  v_add_u32_dpp v44, v44, v44 quad_perm:[1,0,3,2] row_mask:0xf bank_mask:0xf
  s_nop 0
  s_nop 0
  v_add_u32_dpp v44, v44, v44 quad_perm:[2,3,0,1] row_mask:0xf bank_mask:0xf
  s_nop 0
  s_nop 0
  v_add_u32_dpp v44, v44, v44 row_half_mirror row_mask:0xf bank_mask:0xf
  s_nop 0
  s_nop 0
  v_add_u32_dpp v44, v44, v44 row_mirror row_mask:0xf bank_mask:0xf
  v_mov_b32 v68, v44
  s_nop 1
  v_permlane16_swap_b32 v44, v68
  v_add_u32 v44, v44, v68
  v_mov_b32 v68, v44
  s_nop 1
  v_permlane32_swap_b32 v44, v68
  v_add_u32 v44, v44, v68
  s_nop 0
  v_readfirstlane_b32 s77, v44
  s_cmp_gt_i32 s77, 0
  s_cselect_b32 s77, 4, 0
  s_xor_b32 s77, s77, s2
  s_and_b32 s77, s77, 4
  s_lshl_b32 s77, s77, 11
  s_or_b32 s77, s77, 1
  v_mov_b32_e64 v68, s77
  ds_write_b32 v6, v68 offset:28
L_nv_end:
  s_nop 7
  s_nop 3
  s_mov_b32 s81, 0
L_nw:
  s_nop 7
  s_nop 3
  ds_read2_b32 v[68:69], v6 offset0:2 offset1:7
  s_waitcnt lgkmcnt(0)
  v_readfirstlane_b32 s77, v68
  v_readfirstlane_b32 s78, v69
  s_or_b32 s77, s77, s78
  s_cmp_lg_u32 s77, 0
  s_cbranch_scc1 L_nw_ok
  s_add_u32 s81, s81, 1
  s_cmp_lt_u32 s81, 400000
  s_cbranch_scc0 L_nw_ok
  s_sleep 4
  s_branch L_nw
L_nw_ok:
  s_nop 7
  s_nop 0
  s_nop 2
  s_and_b32 s78, s78, 0x2000
  v_add_u32_e64 v37, s78, v37
  s_cmp_lt_u32 s88, 86
  s_cselect_b32 s76, s78, 0
  v_add_u32 v28, s76, v28
  s_cmp_lt_u32 s89, 32
  s_cselect_b32 s76, s78, 0
  v_add_u32 v24, s76, v24
  v_add_u32 v25, s76, v25
  v_add_u32 v26, s76, v26
  v_add_u32 v27, s76, v27
  v_add_u32 v28, s76, v28
  v_add_u32 v29, s76, v29
  v_mov_b32 v44, 0
  v_mov_b32 v45, 0
  v_mov_b32 v46, 0
  v_mov_b32 v47, 0
  v_mov_b32 v48, 0
  v_mov_b32 v49, 0
  v_mov_b32_e64 v50, 0
  v_mov_b32 v51, 0
  s_barrier
L_t1:
  ds_read_b64 v[68:69], v4 offset:2304
  ds_read_b64 v[70:71], v4 offset:2816
  ds_read_b64 v[72:73], v4 offset:3328
  ds_read_b64 v[74:75], v4 offset:3840
  s_waitcnt lgkmcnt(0)
  v_add_f32 v68, v68, v72
  v_add_f32 v69, v69, v73
  v_add_f32 v70, v70, v74
  v_add_f32 v71, v71, v75
  v_add_f32 v68, v68, v70
  v_add_f32_e64 v69, v69, v71
  v_cvt_pk_bf16_f32 v43, v68, v69
  s_nop 0
  s_nop 0
  v_dot2c_f32_bf16_dpp v44, v43, v127 row_newbcast:0 row_mask:0xf bank_mask:0xf
  v_dot2c_f32_bf16_dpp v45, v43, v132 row_newbcast:0 row_mask:0xf bank_mask:0xf
  v_dot2c_f32_bf16_dpp v46, v43, v128 row_newbcast:0 row_mask:0xf bank_mask:0xf
  v_dot2c_f32_bf16_dpp v47, v43, v133 row_newbcast:0 row_mask:0xf bank_mask:0xf
  v_dot2c_f32_bf16_dpp v48, v43, v129 row_newbcast:0 row_mask:0xf bank_mask:0xf
  v_dot2c_f32_bf16_dpp v49, v43, v134 row_newbcast:0 row_mask:0xf bank_mask:0xf
  v_dot2c_f32_bf16_dpp v50, v43, v130 row_newbcast:0 row_mask:0xf bank_mask:0xf
  v_dot2c_f32_bf16_dpp v51, v43, v135 row_newbcast:0 row_mask:0xf bank_mask:0xf
  v_dot2c_f32_bf16_dpp v44, v43, v131 row_newbcast:1 row_mask:0xf bank_mask:0xf
  v_dot2c_f32_bf16_dpp v45, v43, v140 row_newbcast:1 row_mask:0xf bank_mask:0xf
  v_dot2c_f32_bf16_dpp v46, v43, v136 row_newbcast:1 row_mask:0xf bank_mask:0xf
  v_dot2c_f32_bf16_dpp v47, v43, v141 row_newbcast:1 row_mask:0xf bank_mask:0xf
  v_dot2c_f32_bf16_dpp v48, v43, v137 row_newbcast:1 row_mask:0xf bank_mask:0xf
  v_dot2c_f32_bf16_dpp v49, v43, v142 row_newbcast:1 row_mask:0xf bank_mask:0xf
  v_dot2c_f32_bf16_dpp v50, v43, v138 row_newbcast:1 row_mask:0xf bank_mask:0xf
  v_dot2c_f32_bf16_dpp v51, v43, v143 row_newbcast:1 row_mask:0xf bank_mask:0xf
  v_dot2c_f32_bf16_dpp v44, v43, v139 row_newbcast:2 row_mask:0xf bank_mask:0xf
  v_dot2c_f32_bf16_dpp v45, v43, v148 row_newbcast:2 row_mask:0xf bank_mask:0xf
  v_dot2c_f32_bf16_dpp v46, v43, v144 row_newbcast:2 row_mask:0xf bank_mask:0xf
  v_dot2c_f32_bf16_dpp v47, v43, v149 row_newbcast:2 row_mask:0xf bank_mask:0xf
  v_dot2c_f32_bf16_dpp v48, v43, v145 row_newbcast:2 row_mask:0xf bank_mask:0xf
  v_dot2c_f32_bf16_dpp v49, v43, v150 row_newbcast:2 row_mask:0xf bank_mask:0xf
  v_dot2c_f32_bf16_dpp v50, v43, v146 row_newbcast:2 row_mask:0xf bank_mask:0xf
  v_dot2c_f32_bf16_dpp v51, v43, v151 row_newbcast:2 row_mask:0xf bank_mask:0xf
  v_dot2c_f32_bf16_dpp v44, v43, v147 row_newbcast:3 row_mask:0xf bank_mask:0xf
  v_dot2c_f32_bf16_dpp v45, v43, v156 row_newbcast:3 row_mask:0xf bank_mask:0xf
  v_dot2c_f32_bf16_dpp v46, v43, v152 row_newbcast:3 row_mask:0xf bank_mask:0xf
  v_dot2c_f32_bf16_dpp v47, v43, v157 row_newbcast:3 row_mask:0xf bank_mask:0xf
  v_dot2c_f32_bf16_dpp v48, v43, v153 row_newbcast:3 row_mask:0xf bank_mask:0xf
  v_dot2c_f32_bf16_dpp v49, v43, v158 row_newbcast:3 row_mask:0xf bank_mask:0xf
  v_dot2c_f32_bf16_dpp v50, v43, v154 row_newbcast:3 row_mask:0xf bank_mask:0xf
  v_dot2c_f32_bf16_dpp v51, v43, v159 row_newbcast:3 row_mask:0xf bank_mask:0xf
  v_dot2c_f32_bf16_dpp v44, v43, v155 row_newbcast:4 row_mask:0xf bank_mask:0xf
  v_dot2c_f32_bf16_dpp v45, v43, v164 row_newbcast:4 row_mask:0xf bank_mask:0xf
  v_dot2c_f32_bf16_dpp v46, v43, v160 row_newbcast:4 row_mask:0xf bank_mask:0xf
  v_dot2c_f32_bf16_dpp v47, v43, v165 row_newbcast:4 row_mask:0xf bank_mask:0xf
  v_dot2c_f32_bf16_dpp v48, v43, v161 row_newbcast:4 row_mask:0xf bank_mask:0xf
  v_dot2c_f32_bf16_dpp v49, v43, v166 row_newbcast:4 row_mask:0xf bank_mask:0xf
  v_dot2c_f32_bf16_dpp v50, v43, v162 row_newbcast:4 row_mask:0xf bank_mask:0xf
  v_dot2c_f32_bf16_dpp v51, v43, v167 row_newbcast:4 row_mask:0xf bank_mask:0xf
  v_dot2c_f32_bf16_dpp v44, v43, v163 row_newbcast:5 row_mask:0xf bank_mask:0xf
  v_dot2c_f32_bf16_dpp v45, v43, v172 row_newbcast:5 row_mask:0xf bank_mask:0xf
  v_dot2c_f32_bf16_dpp v46, v43, v168 row_newbcast:5 row_mask:0xf bank_mask:0xf
  v_dot2c_f32_bf16_dpp v47, v43, v173 row_newbcast:5 row_mask:0xf bank_mask:0xf
  v_dot2c_f32_bf16_dpp v48, v43, v169 row_newbcast:5 row_mask:0xf bank_mask:0xf
  v_dot2c_f32_bf16_dpp v49, v43, v174 row_newbcast:5 row_mask:0xf bank_mask:0xf
  v_dot2c_f32_bf16_dpp v50, v43, v170 row_newbcast:5 row_mask:0xf bank_mask:0xf
  v_dot2c_f32_bf16_dpp v51, v43, v175 row_newbcast:5 row_mask:0xf bank_mask:0xf
  v_dot2c_f32_bf16_dpp v44, v43, v171 row_newbcast:6 row_mask:0xf bank_mask:0xf
  v_dot2c_f32_bf16_dpp v45, v43, v180 row_newbcast:6 row_mask:0xf bank_mask:0xf
  v_dot2c_f32_bf16_dpp v46, v43, v176 row_newbcast:6 row_mask:0xf bank_mask:0xf
  v_dot2c_f32_bf16_dpp v47, v43, v181 row_newbcast:6 row_mask:0xf bank_mask:0xf
  v_dot2c_f32_bf16_dpp v48, v43, v177 row_newbcast:6 row_mask:0xf bank_mask:0xf
  v_dot2c_f32_bf16_dpp v49, v43, v182 row_newbcast:6 row_mask:0xf bank_mask:0xf
  v_dot2c_f32_bf16_dpp v50, v43, v178 row_newbcast:6 row_mask:0xf bank_mask:0xf
  v_dot2c_f32_bf16_dpp v51, v43, v183 row_newbcast:6 row_mask:0xf bank_mask:0xf
  v_dot2c_f32_bf16_dpp v44, v43, v179 row_newbcast:7 row_mask:0xf bank_mask:0xf
  v_dot2c_f32_bf16_dpp v45, v43, v188 row_newbcast:7 row_mask:0xf bank_mask:0xf
  v_dot2c_f32_bf16_dpp v46, v43, v184 row_newbcast:7 row_mask:0xf bank_mask:0xf
  v_dot2c_f32_bf16_dpp v47, v43, v189 row_newbcast:7 row_mask:0xf bank_mask:0xf
  v_dot2c_f32_bf16_dpp v48, v43, v185 row_newbcast:7 row_mask:0xf bank_mask:0xf
  v_dot2c_f32_bf16_dpp v49, v43, v190 row_newbcast:7 row_mask:0xf bank_mask:0xf
  v_dot2c_f32_bf16_dpp v50, v43, v186 row_newbcast:7 row_mask:0xf bank_mask:0xf
  v_dot2c_f32_bf16_dpp v51, v43, v191 row_newbcast:7 row_mask:0xf bank_mask:0xf
  v_dot2c_f32_bf16_dpp v44, v43, v187 row_newbcast:8 row_mask:0xf bank_mask:0xf
  v_dot2c_f32_bf16_dpp v45, v43, v196 row_newbcast:8 row_mask:0xf bank_mask:0xf
  v_dot2c_f32_bf16_dpp v46, v43, v192 row_newbcast:8 row_mask:0xf bank_mask:0xf
  v_dot2c_f32_bf16_dpp v47, v43, v197 row_newbcast:8 row_mask:0xf bank_mask:0xf
  v_dot2c_f32_bf16_dpp v48, v43, v193 row_newbcast:8 row_mask:0xf bank_mask:0xf
  v_dot2c_f32_bf16_dpp v49, v43, v198 row_newbcast:8 row_mask:0xf bank_mask:0xf
  v_dot2c_f32_bf16_dpp v50, v43, v194 row_newbcast:8 row_mask:0xf bank_mask:0xf
  v_dot2c_f32_bf16_dpp v51, v43, v199 row_newbcast:8 row_mask:0xf bank_mask:0xf
  v_dot2c_f32_bf16_dpp v44, v43, v195 row_newbcast:9 row_mask:0xf bank_mask:0xf
  v_dot2c_f32_bf16_dpp v45, v43, v204 row_newbcast:9 row_mask:0xf bank_mask:0xf
  v_dot2c_f32_bf16_dpp v46, v43, v200 row_newbcast:9 row_mask:0xf bank_mask:0xf
  v_dot2c_f32_bf16_dpp v47, v43, v205 row_newbcast:9 row_mask:0xf bank_mask:0xf
  v_dot2c_f32_bf16_dpp v48, v43, v201 row_newbcast:9 row_mask:0xf bank_mask:0xf
  v_dot2c_f32_bf16_dpp v49, v43, v206 row_newbcast:9 row_mask:0xf bank_mask:0xf
  v_dot2c_f32_bf16_dpp v50, v43, v202 row_newbcast:9 row_mask:0xf bank_mask:0xf
  v_dot2c_f32_bf16_dpp v51, v43, v207 row_newbcast:9 row_mask:0xf bank_mask:0xf
  v_dot2c_f32_bf16_dpp v44, v43, v203 row_newbcast:10 row_mask:0xf bank_mask:0xf
  v_dot2c_f32_bf16_dpp v45, v43, v212 row_newbcast:10 row_mask:0xf bank_mask:0xf
  v_dot2c_f32_bf16_dpp v46, v43, v208 row_newbcast:10 row_mask:0xf bank_mask:0xf
  v_dot2c_f32_bf16_dpp v47, v43, v213 row_newbcast:10 row_mask:0xf bank_mask:0xf
  v_dot2c_f32_bf16_dpp v48, v43, v209 row_newbcast:10 row_mask:0xf bank_mask:0xf
  v_dot2c_f32_bf16_dpp v49, v43, v214 row_newbcast:10 row_mask:0xf bank_mask:0xf
  v_dot2c_f32_bf16_dpp v50, v43, v210 row_newbcast:10 row_mask:0xf bank_mask:0xf
  v_dot2c_f32_bf16_dpp v51, v43, v215 row_newbcast:10 row_mask:0xf bank_mask:0xf
  v_dot2c_f32_bf16_dpp v44, v43, v211 row_newbcast:11 row_mask:0xf bank_mask:0xf
  v_dot2c_f32_bf16_dpp v45, v43, v220 row_newbcast:11 row_mask:0xf bank_mask:0xf
  v_dot2c_f32_bf16_dpp v46, v43, v216 row_newbcast:11 row_mask:0xf bank_mask:0xf
  v_dot2c_f32_bf16_dpp v47, v43, v221 row_newbcast:11 row_mask:0xf bank_mask:0xf
  v_dot2c_f32_bf16_dpp v48, v43, v217 row_newbcast:11 row_mask:0xf bank_mask:0xf
  v_dot2c_f32_bf16_dpp v49, v43, v222 row_newbcast:11 row_mask:0xf bank_mask:0xf
  v_dot2c_f32_bf16_dpp v50, v43, v218 row_newbcast:11 row_mask:0xf bank_mask:0xf
  v_dot2c_f32_bf16_dpp v51, v43, v223 row_newbcast:11 row_mask:0xf bank_mask:0xf
  v_dot2c_f32_bf16_dpp v44, v43, v219 row_newbcast:12 row_mask:0xf bank_mask:0xf
  v_dot2c_f32_bf16_dpp v45, v43, v228 row_newbcast:12 row_mask:0xf bank_mask:0xf
  v_dot2c_f32_bf16_dpp v46, v43, v224 row_newbcast:12 row_mask:0xf bank_mask:0xf
  v_dot2c_f32_bf16_dpp v47, v43, v229 row_newbcast:12 row_mask:0xf bank_mask:0xf
  v_dot2c_f32_bf16_dpp v48, v43, v225 row_newbcast:12 row_mask:0xf bank_mask:0xf
  v_dot2c_f32_bf16_dpp v49, v43, v230 row_newbcast:12 row_mask:0xf bank_mask:0xf
  v_dot2c_f32_bf16_dpp v50, v43, v226 row_newbcast:12 row_mask:0xf bank_mask:0xf
  v_dot2c_f32_bf16_dpp v51, v43, v231 row_newbcast:12 row_mask:0xf bank_mask:0xf
  v_dot2c_f32_bf16_dpp v44, v43, v227 row_newbcast:13 row_mask:0xf bank_mask:0xf
  v_dot2c_f32_bf16_dpp v45, v43, v236 row_newbcast:13 row_mask:0xf bank_mask:0xf
  v_dot2c_f32_bf16_dpp v46, v43, v232 row_newbcast:13 row_mask:0xf bank_mask:0xf
  v_dot2c_f32_bf16_dpp v47, v43, v237 row_newbcast:13 row_mask:0xf bank_mask:0xf
  v_dot2c_f32_bf16_dpp v48, v43, v233 row_newbcast:13 row_mask:0xf bank_mask:0xf
  v_dot2c_f32_bf16_dpp v49, v43, v238 row_newbcast:13 row_mask:0xf bank_mask:0xf
  v_dot2c_f32_bf16_dpp v50, v43, v234 row_newbcast:13 row_mask:0xf bank_mask:0xf
  v_dot2c_f32_bf16_dpp v51, v43, v239 row_newbcast:13 row_mask:0xf bank_mask:0xf
  v_dot2c_f32_bf16_dpp v44, v43, v235 row_newbcast:14 row_mask:0xf bank_mask:0xf
  v_dot2c_f32_bf16_dpp v45, v43, v244 row_newbcast:14 row_mask:0xf bank_mask:0xf
  v_dot2c_f32_bf16_dpp v46, v43, v240 row_newbcast:14 row_mask:0xf bank_mask:0xf
  v_dot2c_f32_bf16_dpp v47, v43, v245 row_newbcast:14 row_mask:0xf bank_mask:0xf
  v_dot2c_f32_bf16_dpp v48, v43, v241 row_newbcast:14 row_mask:0xf bank_mask:0xf
  v_dot2c_f32_bf16_dpp v49, v43, v246 row_newbcast:14 row_mask:0xf bank_mask:0xf
  v_dot2c_f32_bf16_dpp v50, v43, v242 row_newbcast:14 row_mask:0xf bank_mask:0xf
  v_dot2c_f32_bf16_dpp v51, v43, v247 row_newbcast:14 row_mask:0xf bank_mask:0xf
  v_dot2c_f32_bf16_dpp v44, v43, v243 row_newbcast:15 row_mask:0xf bank_mask:0xf
  v_dot2c_f32_bf16_dpp v45, v43, v252 row_newbcast:15 row_mask:0xf bank_mask:0xf
  v_dot2c_f32_bf16_dpp v46, v43, v248 row_newbcast:15 row_mask:0xf bank_mask:0xf
  v_dot2c_f32_bf16_dpp v47, v43, v253 row_newbcast:15 row_mask:0xf bank_mask:0xf
  v_dot2c_f32_bf16_dpp v48, v43, v249 row_newbcast:15 row_mask:0xf bank_mask:0xf
  v_dot2c_f32_bf16_dpp v49, v43, v254 row_newbcast:15 row_mask:0xf bank_mask:0xf
  v_dot2c_f32_bf16_dpp v50, v43, v250 row_newbcast:15 row_mask:0xf bank_mask:0xf
  v_dot2c_f32_bf16_dpp v51, v43, v255 row_newbcast:15 row_mask:0xf bank_mask:0xf
  v_permlane32_swap_b32 v44, v48
  v_permlane32_swap_b32 v45, v49
  v_permlane32_swap_b32 v46, v50
  v_permlane32_swap_b32 v47, v51
  v_add_f32 v44, v44, v48
  v_add_f32 v45, v45, v49
  v_add_f32 v46, v46, v50
  v_add_f32 v47, v47, v51
  s_nop 0
  v_permlane16_swap_b32 v44, v46
  v_permlane16_swap_b32 v45, v47
  v_add_f32 v44, v44, v46
  v_add_f32 v45, v45, v47
  v_add_u32 v44, 8, v44
  v_add_u32 v45, 8, v45
  v_mov_b32 v46, v44
  v_mov_b32 v47, v45
  s_nop 0
  v_permlane16_swap_b32 v44, v46
  v_permlane16_swap_b32 v45, v47
  v_bfi_b32 v68, 15, v8, v44
  v_bfi_b32 v69, 15, v9, v45
  v_bfi_b32 v70, 15, v10, v46
  v_bfi_b32 v71, 15, v11, v47
  s_and_b32 exec_lo, 0xffff, s34
  s_and_b32 exec_hi, 0xffff, s34
  buffer_store_dwordx4 v[68:71], v5, s[52:55], s87 offen sc1
  s_add_u32 s30, s87, 0x2000
  buffer_store_dwordx4 v[68:71], v5, s[52:55], s30 offen sc1
  s_mov_b64 exec, s[34:35]
  s_cmp_lt_u32 s88, 86
  s_cbranch_scc1 L_gate
  s_mov_b32 s75, s89
  s_cmp_lt_u32 s75, 32
  s_cbranch_scc1 L_gate
  s_cmp_eq_u32 s72, 0
  s_cbranch_scc1 L_gate
  s_branch L_fin
L_gate:
  s_nop 7
  s_nop 3
  v_mov_b32_e64 v6, 0
  ds_read_b32 v7, v6 offset:16
  s_waitcnt lgkmcnt(0)
  v_readfirstlane_b32 s91, v7
  s_add_u32 s91, s91, 7647
  s_cmp_lg_u32 s72, 0
  s_cbranch_scc1 L_r1done
  v_lshlrev_b32_e64 v44, 16, v124
  v_and_b32 v45, 0xffff0000, v124
  v_lshlrev_b32_e64 v46, 16, v126
  v_and_b32 v47, 0xffff0000, v126
  v_mov_b32 v69, s80
  s_lshl_b32 s31, s73, 5
  s_or_b32 s31, s31, s74
  s_lshr_b32 s77, s31, 2
  s_lshl_b32 s77, s77, 14
  s_bfe_u32 s78, s31, 0x10001
  s_lshl_b32 s78, s78, 12
  s_add_u32 s77, s77, s78
  s_and_b32 s78, s31, 1
  s_lshl_b32 s78, s78, 6
  s_add_u32 s77, s77, s78
  s_add_u32 s77, s77, 1048576
  s_andn2_b32 s81, 128, s34
L_tw1:
  s_memrealtime s[92:93]
  s_nop 0
  s_waitcnt lgkmcnt(0)
  s_sub_u32 s92, s92, s91
  s_cmp_ge_i32 s92, 0
  s_cbranch_scc1 L_tw1_ok
  s_add_u32 s81, s81, 1
  s_cmp_lt_u32 s81, 128
  s_cbranch_scc1 L_tw1
L_tw1_ok:
  s_mov_b32 s81, 0
L_poll_wop:
  buffer_load_dwordx4 v[8:11], v37, s[52:55], s77 offen offset:0 sc1
  buffer_load_dwordx4 v[12:15], v37, s[52:55], s77 offen offset:2048 sc1
  s_and_b32 s76, s31, 0xbf
  s_lshl_b32 s76, s76, 7
  s_nop 0
  s_bfe_u32 s78, s31, 0x10006
  s_lshl_b32 s78, s78, 17
  s_add_u32 s76, s76, s78
  s_add_u32 s76, s76, 524288
  s_add_u32 s78, s76, 0x2000
  s_waitcnt vmcnt(1)
  v_xor_b32 v8, v16, v8
  v_xor_b32 v9, v17, v9
  v_xor_b32 v10, v18, v10
  v_xor_b32_e64 v11, v19, v11
  v_or3_b32 v7, v8, v9, v10
  s_waitcnt vmcnt(0)
  v_xor_b32 v12, v16, v12
  v_xor_b32 v13, v17, v13
  v_xor_b32 v14, v18, v14
  v_xor_b32_e64 v15, v19, v15
  v_pk_add_f32 v[128:129], v[8:9], v[12:13]
  v_pk_add_f32 v[130:131], v[10:11], v[14:15]
  v_or3_b32 v7, v7, v11, v12
  v_or3_b32 v7, v7, v13, v14
  v_permlane32_swap_b32 v128, v130
  v_permlane32_swap_b32 v129, v131
  v_pk_add_f32 v[128:129], v[128:129], v[130:131]
  v_mov_b32 v130, v128
  v_mov_b32 v131, v129
  v_bitop3_b32 v7, v7, v15, 15 bitop3:0xa8
  v_permlane16_swap_b32 v128, v130
  v_permlane16_swap_b32 v129, v131
  v_pk_add_f32 v[128:129], v[128:129], v[130:131]
  v_cmp_ne_u32_e64 vcc, 0, v7
  s_cbranch_vccnz L_wop_retry
L_poll_wop_ok:
  v_add_f32_dpp v128, v128, v128 row_ror:4 row_mask:0xf bank_mask:0xf
  v_add_f32_dpp v129, v129, v129 row_ror:4 row_mask:0xf bank_mask:0xf
  s_nop 0
  v_add_f32_dpp v128, v128, v128 row_ror:8 row_mask:0xf bank_mask:0xf
  v_add_f32_dpp v129, v129, v129 row_ror:8 row_mask:0xf bank_mask:0xf
  v_cvt_pk_bf16_f32 v128, 0, v128
  v_cvt_pk_bf16_f32 v129, 0, v129
  v_pk_mul_f32 v[128:129], v[128:129], v[44:45]
  v_cvt_pk_bf16_f32 v128, 0, v128
  v_cvt_pk_bf16_f32 v129, 0, v129
  v_pk_add_f32 v[128:129], v[128:129], v[46:47]
  v_cvt_pk_bf16_f32 v68, v128, v129
  buffer_store_dwordx2 v[68:69], v36, s[52:55], s76 offen sc1
  buffer_store_dwordx2 v[68:69], v36, s[52:55], s78 offen sc1
L_r1done:
  s_cmp_lt_u32 s88, 86
  s_cbranch_scc0 L_notf1
  s_and_b32 s77, s72, 1
  s_lshl_b32 s77, s77, 17
  s_lshr_b32 s78, s72, 1
  s_lshl_b32 s78, s78, 14
  s_add_u32 s77, s77, s78
  s_add_u32 s30, s90, 0x2000
  s_add_u32 s77, s77, 524288
  s_add_u32 s78, s77, 2048
  s_add_u32 s75, s77, 4096
  s_add_u32 s76, s77, 6144
  s_mov_b32 s32, 0x11111111
  s_mov_b32 s33, 0x11111111
  s_andn2_b32 s81, 128, s34
L_tw2:
  s_memrealtime s[92:93]
  s_nop 0
  s_waitcnt lgkmcnt(0)
  s_sub_u32 s92, s92, s91
  s_cmp_ge_i32 s92, 59
  s_cbranch_scc1 L_tw2_ok
  s_add_u32 s81, s81, 1
  s_cmp_lt_u32 s81, 128
  s_cbranch_scc1 L_tw2
L_tw2_ok:
  s_mov_b32 s81, 0
L_poll_x1:
  buffer_load_dwordx4 v[8:11], v28, s[52:55], s77 offen sc1
  buffer_load_dwordx4 v[12:15], v28, s[52:55], s78 offen sc1
  buffer_load_dwordx4 v[16:19], v28, s[52:55], s75 offen sc1
  buffer_load_dwordx4 v[20:23], v28, s[52:55], s76 offen sc1
  s_waitcnt vmcnt(3)
  v_lshlrev_b32 v128, 16, v8
  v_and_b32 v129, 0xffff0000, v8
  v_readfirstlane_b32 s22, v128
  v_lshlrev_b32 v130, 16, v10
  v_and_b32 v131, 0xffff0000, v10
  s_waitcnt vmcnt(2)
  v_lshlrev_b32 v132, 16, v12
  v_and_b32 v133, 0xffff0000, v12
  v_lshlrev_b32_e64 v134, 16, v14
  v_and_b32 v135, 0xffff0000, v14
  s_waitcnt vmcnt(1)
  v_lshlrev_b32 v136, 16, v16
  v_and_b32 v137, 0xffff0000, v16
  v_readfirstlane_b32 s24, v136
  v_lshlrev_b32 v138, 16, v18
  v_and_b32 v139, 0xffff0000, v18
  s_waitcnt vmcnt(0)
  v_lshlrev_b32 v140, 16, v20
  v_and_b32 v141, 0xffff0000, v20
  v_lshlrev_b32_e64 v142, 16, v22
  v_and_b32 v143, 0xffff0000, v22
  v_pk_add_f32 v[144:145], v[128:129], s[22:23] op_sel_hi:[1,0] neg_lo:[0,1] neg_hi:[0,1]
  v_pk_add_f32 v[146:147], v[130:131], s[22:23] op_sel_hi:[1,0] neg_lo:[0,1] neg_hi:[0,1]
  v_pk_add_f32 v[148:149], v[132:133], s[22:23] op_sel_hi:[1,0] neg_lo:[0,1] neg_hi:[0,1]
  v_pk_add_f32 v[150:151], v[134:135], s[22:23] op_sel_hi:[1,0] neg_lo:[0,1] neg_hi:[0,1]
  v_pk_add_f32 v[152:153], v[136:137], s[24:25] op_sel_hi:[1,0] neg_lo:[0,1] neg_hi:[0,1]
  v_pk_add_f32 v[154:155], v[138:139], s[24:25] op_sel_hi:[1,0] neg_lo:[0,1] neg_hi:[0,1]
  v_pk_add_f32 v[156:157], v[140:141], s[24:25] op_sel_hi:[1,0] neg_lo:[0,1] neg_hi:[0,1]
  v_pk_add_f32 v[158:159], v[142:143], s[24:25] op_sel_hi:[1,0] neg_lo:[0,1] neg_hi:[0,1]
  v_mov_b32 v172, s24
  v_mov_b32 v173, s22
  v_cndmask_b32 v172, v172, v173, s[84:85]
  v_pk_add_f32 v[160:161], v[144:145], v[146:147]
  v_pk_add_f32 v[162:163], v[152:153], v[154:155]
  v_pk_add_f32 v[168:169], v[148:149], v[150:151]
  v_pk_add_f32 v[170:171], v[156:157], v[158:159]
  v_pk_mul_f32 v[164:165], v[144:145], v[144:145]
  v_pk_mul_f32 v[166:167], v[152:153], v[152:153]
  v_pk_add_f32 v[160:161], v[160:161], v[168:169]
  v_pk_add_f32 v[162:163], v[162:163], v[170:171]
  v_pk_fma_f32 v[164:165], v[146:147], v[146:147], v[164:165]
  v_pk_fma_f32 v[166:167], v[154:155], v[154:155], v[166:167]
  v_pk_fma_f32 v[164:165], v[148:149], v[148:149], v[164:165]
  v_pk_fma_f32 v[166:167], v[156:157], v[156:157], v[166:167]
  v_pk_fma_f32 v[164:165], v[150:151], v[150:151], v[164:165]
  v_pk_fma_f32 v[166:167], v[158:159], v[158:159], v[166:167]
  v_add_f32 v160, v160, v161
  v_add_f32 v162, v162, v163
  v_add_f32 v164, v164, v165
  v_add_f32 v166, v166, v167
  v_permlane32_swap_b32 v160, v162
  v_xor_b32 v7, s80, v9
  v_permlane32_swap_b32 v164, v166
  v_add_f32 v160, v160, v162
  v_add_f32_e64 v164, v164, v166
  v_bitop3_b32 v7, v11, s80, v7 bitop3:0xbe
  v_bitop3_b32 v7, v13, s80, v7 bitop3:0xbe
  v_permlane16_swap_b32 v160, v164
  v_add_f32 v160, v160, v164
  v_bitop3_b32 v7, v15, s80, v7 bitop3:0xbe
  v_bitop3_b32 v7, v17, s80, v7 bitop3:0xbe
  v_add_f32_dpp v160, v160, v160 quad_perm:[1,0,3,2] row_mask:0xf bank_mask:0xf
  v_bitop3_b32 v7, v19, s80, v7 bitop3:0xbe
  v_bitop3_b32 v7, v21, s80, v7 bitop3:0xbe
  v_add_f32_dpp v160, v160, v160 quad_perm:[2,3,0,1] row_mask:0xf bank_mask:0xf
  v_bitop3_b32 v7, v23, s80, v7 bitop3:0xbe
  s_nop 0
  v_add_f32_dpp v160, v160, v160 row_half_mirror row_mask:0xf bank_mask:0xf
  v_cmp_ne_u32_e64 vcc, 0, v7
  s_cbranch_vccnz L_x1_retry
L_poll_x1_ok:
  v_add_f32_dpp v160, v160, v160 row_mirror row_mask:0xf bank_mask:0xf
  v_mul_f32 v164, 0x3b000000, v160
  v_mul_f32 v160, 0x3b000000, v160
  s_nop 1
  v_permlane16_swap_b32 v160, v164
  v_add_f32_e64 v172, v172, v160
  v_fma_f32 v164, -v160, v160, v164
  v_cvt_pk_bf16_f32 v172, 0, v172
  v_max_f32_e64 v164, 0, v164
  v_cvt_pk_bf16_f32 v164, 0, v164
  v_add_f32 v164, 0x3727c5ac, v164
  v_readlane_b32 s22, v172, 0
  v_readlane_b32 s24, v172, 32
  v_cvt_pk_bf16_f32 v164, 0, v164
  v_sqrt_f32_e64 v164, v164
  v_pk_add_f32 v[128:129], v[128:129], s[22:23] op_sel_hi:[1,0] neg_lo:[0,1] neg_hi:[0,1]
  v_pk_add_f32 v[130:131], v[130:131], s[22:23] op_sel_hi:[1,0] neg_lo:[0,1] neg_hi:[0,1]
  v_cvt_pk_bf16_f32 v164, 0, v164
  v_rcp_f32_e64 v164, v164
  v_pk_add_f32 v[132:133], v[132:133], s[22:23] op_sel_hi:[1,0] neg_lo:[0,1] neg_hi:[0,1]
  v_pk_add_f32 v[134:135], v[134:135], s[22:23] op_sel_hi:[1,0] neg_lo:[0,1] neg_hi:[0,1]
  v_pk_add_f32 v[136:137], v[136:137], s[24:25] op_sel_hi:[1,0] neg_lo:[0,1] neg_hi:[0,1]
  v_pk_add_f32 v[138:139], v[138:139], s[24:25] op_sel_hi:[1,0] neg_lo:[0,1] neg_hi:[0,1]
  v_pk_add_f32 v[140:141], v[140:141], s[24:25] op_sel_hi:[1,0] neg_lo:[0,1] neg_hi:[0,1]
  v_pk_add_f32 v[142:143], v[142:143], s[24:25] op_sel_hi:[1,0] neg_lo:[0,1] neg_hi:[0,1]
  v_readlane_b32 s26, v164, 0
  v_readlane_b32 s28, v164, 32
  v_cvt_pk_bf16_f32 v128, 0, v128
  v_cvt_pk_bf16_f32 v129, 0, v129
  v_cvt_pk_bf16_f32 v130, 0, v130
  v_cvt_pk_bf16_f32 v131, 0, v131
  v_cvt_pk_bf16_f32 v132, 0, v132
  v_cvt_pk_bf16_f32 v133, 0, v133
  v_cvt_pk_bf16_f32 v134, 0, v134
  v_cvt_pk_bf16_f32 v135, 0, v135
  v_cvt_pk_bf16_f32 v136, 0, v136
  v_cvt_pk_bf16_f32 v137, 0, v137
  v_cvt_pk_bf16_f32 v138, 0, v138
  v_cvt_pk_bf16_f32 v139, 0, v139
  v_cvt_pk_bf16_f32 v140, 0, v140
  v_cvt_pk_bf16_f32 v141, 0, v141
  v_cvt_pk_bf16_f32 v142, 0, v142
  v_cvt_pk_bf16_f32 v143, 0, v143
  v_pk_mul_f32 v[128:129], v[128:129], s[26:27] op_sel_hi:[1,0]
  v_pk_mul_f32 v[130:131], v[130:131], s[26:27] op_sel_hi:[1,0]
  v_pk_mul_f32 v[132:133], v[132:133], s[26:27] op_sel_hi:[1,0]
  v_pk_mul_f32 v[134:135], v[134:135], s[26:27] op_sel_hi:[1,0]
  v_pk_mul_f32 v[136:137], v[136:137], s[28:29] op_sel_hi:[1,0]
  v_pk_mul_f32 v[138:139], v[138:139], s[28:29] op_sel_hi:[1,0]
  v_pk_mul_f32 v[140:141], v[140:141], s[28:29] op_sel_hi:[1,0]
  v_pk_mul_f32 v[142:143], v[142:143], s[28:29] op_sel_hi:[1,0]
  v_cvt_pk_bf16_f32 v128, 0, v128
  v_cvt_pk_bf16_f32 v129, 0, v129
  v_cvt_pk_bf16_f32 v130, 0, v130
  v_cvt_pk_bf16_f32 v131, 0, v131
  v_cvt_pk_bf16_f32 v132, 0, v132
  v_cvt_pk_bf16_f32 v133, 0, v133
  v_cvt_pk_bf16_f32 v134, 0, v134
  v_cvt_pk_bf16_f32 v135, 0, v135
  v_cvt_pk_bf16_f32 v136, 0, v136
  v_cvt_pk_bf16_f32 v137, 0, v137
  v_cvt_pk_bf16_f32 v138, 0, v138
  v_cvt_pk_bf16_f32 v139, 0, v139
  v_cvt_pk_bf16_f32 v140, 0, v140
  v_cvt_pk_bf16_f32 v141, 0, v141
  v_cvt_pk_bf16_f32 v142, 0, v142
  v_cvt_pk_bf16_f32 v143, 0, v143
  v_pk_mul_f32 v[128:129], v[128:129], v[52:53]
  v_pk_mul_f32 v[130:131], v[130:131], v[54:55]
  v_pk_mul_f32 v[132:133], v[132:133], v[56:57]
  v_pk_mul_f32 v[134:135], v[134:135], v[58:59]
  v_pk_mul_f32 v[136:137], v[136:137], v[60:61]
  v_pk_mul_f32 v[138:139], v[138:139], v[62:63]
  v_pk_mul_f32 v[140:141], v[140:141], v[64:65]
  v_pk_mul_f32 v[142:143], v[142:143], v[66:67]
  v_cvt_pk_bf16_f32 v128, 0, v128
  v_cvt_pk_bf16_f32 v129, 0, v129
  v_cvt_pk_bf16_f32 v130, 0, v130
  v_cvt_pk_bf16_f32 v131, 0, v131
  v_cvt_pk_bf16_f32 v132, 0, v132
  v_cvt_pk_bf16_f32 v133, 0, v133
  v_cvt_pk_bf16_f32 v134, 0, v134
  v_cvt_pk_bf16_f32 v135, 0, v135
  v_cvt_pk_bf16_f32 v136, 0, v136
  v_cvt_pk_bf16_f32 v137, 0, v137
  v_cvt_pk_bf16_f32 v138, 0, v138
  v_cvt_pk_bf16_f32 v139, 0, v139
  v_cvt_pk_bf16_f32 v140, 0, v140
  v_cvt_pk_bf16_f32 v141, 0, v141
  v_cvt_pk_bf16_f32 v142, 0, v142
  v_cvt_pk_bf16_f32 v143, 0, v143
  v_pk_add_f32 v[128:129], v[128:129], v[108:109]
  v_pk_add_f32 v[130:131], v[130:131], v[110:111]
  v_pk_add_f32 v[132:133], v[132:133], v[112:113]
  v_pk_add_f32 v[134:135], v[134:135], v[114:115]
  v_pk_add_f32 v[136:137], v[136:137], v[116:117]
  v_pk_add_f32 v[138:139], v[138:139], v[118:119]
  v_pk_add_f32 v[140:141], v[140:141], v[120:121]
  v_pk_add_f32 v[142:143], v[142:143], v[122:123]
  v_cvt_pk_bf16_f32 v176, v128, v129
  v_cvt_pk_bf16_f32 v177, v130, v131
  ds_write_b64 v24, v[176:177] offset:12544
  v_cvt_pk_bf16_f32 v178, v132, v133
  v_cvt_pk_bf16_f32 v179, v134, v135
  ds_write_b64 v24, v[178:179] offset:13056
  v_cvt_pk_bf16_f32 v180, v136, v137
  v_cvt_pk_bf16_f32 v181, v138, v139
  ds_write_b64 v24, v[180:181] offset:13584
  v_cvt_pk_bf16_f32 v182, v140, v141
  v_cvt_pk_bf16_f32 v183, v142, v143
  ds_write_b64 v24, v[182:183] offset:14096
  s_nop 0
  s_waitcnt lgkmcnt(0)
  s_cbranch_execz L_tb_144
  s_barrier
L_tb_144:
  ds_read_b128 v[192:195], v25 offset:12544
  ds_read_b128 v[196:199], v25 offset:12608
  ds_read_b128 v[200:203], v25 offset:12672
  ds_read_b128 v[204:207], v25 offset:12736
  ds_read_b128 v[208:211], v25 offset:12800
  ds_read_b128 v[212:215], v25 offset:12864
  ds_read_b128 v[216:219], v25 offset:12928
  ds_read_b128 v[220:223], v25 offset:12992
  v_mov_b32_e64 v73, s80
  v_mov_b32 v75, s80
  s_mov_b64 vcc, s[32:33]
  s_waitcnt lgkmcnt(7)
  v_mfma_f32_16x16x32_bf16 v[68:71], v[192:195], v[76:79], 0
  s_waitcnt lgkmcnt(6)
  v_mfma_f32_16x16x32_bf16 v[68:71], v[196:199], v[80:83], v[68:71]
  s_waitcnt lgkmcnt(5)
  v_mfma_f32_16x16x32_bf16 v[68:71], v[200:203], v[84:87], v[68:71]
  s_waitcnt lgkmcnt(4)
  v_mfma_f32_16x16x32_bf16 v[68:71], v[204:207], v[88:91], v[68:71]
  s_waitcnt lgkmcnt(3)
  v_mfma_f32_16x16x32_bf16 v[68:71], v[208:211], v[92:95], v[68:71]
  s_waitcnt lgkmcnt(2)
  v_mfma_f32_16x16x32_bf16 v[68:71], v[212:215], v[96:99], v[68:71]
  s_waitcnt lgkmcnt(1)
  v_mfma_f32_16x16x32_bf16 v[68:71], v[216:219], v[100:103], v[68:71]
  s_waitcnt lgkmcnt(0)
  v_mfma_f32_16x16x32_bf16 v[68:71], v[220:223], v[104:107], v[68:71]
  s_nop 7
  v_permlane32_swap_b32 v68, v70
  v_permlane32_swap_b32 v69, v71
  s_nop 0
  v_add_f32_dpp v68, v70, v68 row_ror:8 row_mask:0xf bank_mask:0xf
  v_add_f32_dpp v69, v71, v69 row_ror:8 row_mask:0xf bank_mask:0xf
  v_cvt_pk_bf16_f32 v68, 0, v68
  v_cvt_pk_bf16_f32 v69, 0, v69
  v_mul_f32 v5, 0xbfb8aa3b, v68
  v_mul_f32 v6, 0xbfb8aa3b, v69
  v_exp_f32 v5, v5
  v_exp_f32 v6, v6
  v_mov_b32_dpp v39, v68 row_shl:4 row_mask:0xf bank_mask:0xf
  v_mov_b32_dpp v40, v69 row_shl:4 row_mask:0xf bank_mask:0xf
  v_add_f32 v5, 1.0, v5
  v_add_f32 v6, 1.0, v6
  v_min_f32 v5, 0x7f7fffff, v5
  v_min_f32 v6, 0x7f7fffff, v6
  v_rcp_f32 v128, v5
  v_rcp_f32 v130, v6
  v_mul_f32 v129, v68, v128
  v_mul_f32 v131, v69, v130
  v_fma_f32 v68, -v129, v5, v68
  v_fma_f32 v69, -v131, v6, v69
  v_fma_f32 v68, v68, v128, v129
  v_fma_f32 v69, v69, v130, v131
  v_cvt_pk_bf16_f32 v68, 0, v68
  v_cvt_pk_bf16_f32 v69, 0, v69
  v_mul_f32_e64 v68, v68, v39
  v_mul_f32 v69, v69, v40
  s_nop 0
  v_mov_b32_dpp v39, v68 quad_perm:[1,0,3,2] row_mask:0xf bank_mask:0xf
  v_mov_b32_dpp v40, v69 quad_perm:[1,0,3,2] row_mask:0xf bank_mask:0xf
  v_cvt_pk_bf16_f32 v68, v68, v39
  v_cvt_pk_bf16_f32 v69, v69, v40
  s_nop 1
  v_cndmask_b32_dpp v72, v69, v68, vcc quad_perm:[0,0,0,0] row_mask:0xf bank_mask:0xf
  s_not_b64 vcc, vcc
  v_cndmask_b32_dpp v74, v68, v69, vcc quad_perm:[2,2,2,2] row_mask:0xf bank_mask:0xf
  s_and_b32 exec_lo, 0x00050005, s34
  s_and_b32 exec_hi, 0x00050005, s34
  buffer_store_dwordx4 v[72:75], v26, s[52:55], s90 offen sc1
  buffer_store_dwordx4 v[72:75], v26, s[52:55], s30 offen sc1
  s_branch L_fin
L_wop_retry:
  s_add_u32 s81, s81, 1
  s_cmp_lt_u32 s81, 100000
  s_cbranch_scc0 L_poll_wop_ok
  s_sleep 1
  s_branch L_poll_wop
L_x1_retry:
  s_add_u32 s81, s81, 1
  s_cmp_lt_u32 s81, 100000
  s_cbranch_scc0 L_poll_x1_ok
  s_sleep 1
  s_branch L_poll_x1
L_notf1:
  s_nop 7
  s_nop 0
  s_nop 2
  s_mov_b32 s75, s89
  s_cmp_lt_u32 s75, 32
  s_cbranch_scc0 L_fin
  s_mov_b32 s77, 393216
  s_mov_b32 s30, 394240
  s_lshl_b32 s76, s75, 7
  s_add_u32 s76, s76, 524288
  s_andn2_b32 s81, 128, s34
L_tw2b:
  s_memrealtime s[92:93]
  s_waitcnt lgkmcnt(0)
  s_sub_u32 s92, s92, s91
  s_cmp_ge_i32 s92, 79
  s_cbranch_scc1 L_tw2b_ok
  s_add_u32 s81, s81, 1
  s_cmp_lt_u32 s81, 128
  s_cbranch_scc1 L_tw2b
L_tw2b_ok:
  s_mov_b32 s81, 0
L_poll_x1b:
  s_nop 7
  s_nop 3
  buffer_load_dwordx2 v[176:177], v60, s[52:55], s76 offen sc1
  s_waitcnt vmcnt(0)
  v_xor_b32 v7, s80, v177
  v_cmp_ne_u32_e64 vcc, 0, v7
  s_cbranch_vccz L_poll_x1b_ok
  s_add_u32 s81, s81, 1
  s_cmp_lt_u32 s81, 100000
  s_cbranch_scc0 L_poll_x1b_ok
  s_sleep 1
  s_branch L_poll_x1b
L_poll_x1b_ok:
  s_nop 7
  s_nop 3
  v_lshlrev_b32 v44, 16, v125
  v_and_b32 v45, 0xffff0000, v125
  v_lshlrev_b32_e64 v46, 16, v176
  v_and_b32 v47, 0xffff0000, v176
  v_add_u32 v48, 4352, v61
  v_add_u32 v49, 5376, v61
  v_add_u32 v50, 6400, v61
  v_add_u32 v51, 7424, v61
  s_or_b32 s78, s75, s72
  s_cmp_lg_u32 s78, 0
  s_cbranch_scc1 L_gen_done
  s_sub_u32 s78, s80, 1254152324
  v_mov_b32 v5, s78
  v_mov_b32_e64 v4, 0
  s_and_b32 exec_lo, 1, s34
  s_and_b32 exec_hi, 0, s34
  buffer_store_dword v5, v4, s[52:55], 0 offen offset:0 sc1
  s_mov_b64 exec, s[34:35]
L_gen_done:
  s_nop 7
  s_nop 0
  s_nop 2
  s_andn2_b32 s81, 128, s34
L_tw3:
  s_memrealtime s[92:93]
  s_waitcnt lgkmcnt(0)
  s_sub_u32 s92, s92, s91
  s_cmp_ge_i32 s92, 169
  s_cbranch_scc1 L_tw3_ok
  s_add_u32 s81, s81, 1
  s_cmp_lt_u32 s81, 128
  s_cbranch_scc1 L_tw3
L_tw3_ok:
  s_mov_b32 s81, 0
L_poll_act:
  buffer_load_dwordx4 v[128:131], v24, s[52:55], s77 offen sc1
  buffer_load_dwordx4 v[132:135], v24, s[52:55], s30 offen sc1
  buffer_load_dwordx4 v[136:139], v25, s[52:55], s77 offen sc1
  buffer_load_dwordx4 v[140:143], v25, s[52:55], s30 offen sc1
  buffer_load_dwordx4 v[144:147], v26, s[52:55], s77 offen sc1
  buffer_load_dwordx4 v[148:151], v26, s[52:55], s30 offen sc1
  buffer_load_dwordx4 v[152:155], v27, s[52:55], s77 offen sc1
  buffer_load_dwordx4 v[156:159], v27, s[52:55], s30 offen sc1
  buffer_load_dwordx4 v[160:163], v28, s[52:55], s77 offen sc1
  buffer_load_dwordx4 v[164:167], v28, s[52:55], s30 offen sc1
  buffer_load_dwordx4 v[168:171], v29, s[52:55], s77 offen sc1
  buffer_load_dwordx4 v[172:175], v29, s[52:55], s30 offen sc1
  s_waitcnt vmcnt(10)
  v_and_b32 v192, v30, v128
  v_and_b32 v193, v30, v130
  v_and_b32 v194, v30, v132
  v_and_b32 v195, v30, v134
  v_xor_b32 v7, s80, v129
  v_bitop3_b32 v7, v131, s80, v7 bitop3:0xbe
  v_mfma_f32_16x16x32_bf16 v[52:55], v[192:195], v[76:79], 0
  v_bitop3_b32 v7, v133, s80, v7 bitop3:0xbe
  v_bitop3_b32 v7, v135, s80, v7 bitop3:0xbe
  v_mfma_f32_16x16x32_bf16 v[56:59], v[192:195], v[80:83], 0
  s_waitcnt vmcnt(8)
  v_and_b32 v196, v31, v136
  v_and_b32 v197, v31, v138
  v_and_b32 v198, v31, v140
  v_and_b32_e64 v199, v31, v142
  v_bitop3_b32 v7, v137, s80, v7 bitop3:0xbe
  v_bitop3_b32 v7, v139, s80, v7 bitop3:0xbe
  v_mfma_f32_16x16x32_bf16 v[52:55], v[196:199], v[84:87], v[52:55]
  v_bitop3_b32 v7, v141, s80, v7 bitop3:0xbe
  v_bitop3_b32 v7, v143, s80, v7 bitop3:0xbe
  v_mfma_f32_16x16x32_bf16 v[56:59], v[196:199], v[88:91], v[56:59]
  s_waitcnt vmcnt(6)
  v_and_b32 v200, v32, v144
  v_and_b32 v201, v32, v146
  v_and_b32 v202, v32, v148
  v_and_b32_e64 v203, v32, v150
  v_bitop3_b32 v7, v145, s80, v7 bitop3:0xbe
  v_bitop3_b32 v7, v147, s80, v7 bitop3:0xbe
  v_mfma_f32_16x16x32_bf16 v[52:55], v[200:203], v[92:95], v[52:55]
  v_bitop3_b32 v7, v149, s80, v7 bitop3:0xbe
  v_bitop3_b32 v7, v151, s80, v7 bitop3:0xbe
  v_mfma_f32_16x16x32_bf16 v[56:59], v[200:203], v[96:99], v[56:59]
  s_waitcnt vmcnt(4)
  v_and_b32 v204, v33, v152
  v_and_b32 v205, v33, v154
  v_and_b32 v206, v33, v156
  v_and_b32_e64 v207, v33, v158
  v_bitop3_b32 v7, v153, s80, v7 bitop3:0xbe
  v_bitop3_b32 v7, v155, s80, v7 bitop3:0xbe
  v_mfma_f32_16x16x32_bf16 v[52:55], v[204:207], v[100:103], v[52:55]
  v_bitop3_b32 v7, v157, s80, v7 bitop3:0xbe
  v_bitop3_b32 v7, v159, s80, v7 bitop3:0xbe
  v_mfma_f32_16x16x32_bf16 v[56:59], v[204:207], v[104:107], v[56:59]
  s_waitcnt vmcnt(2)
  v_and_b32 v208, v34, v160
  v_and_b32 v209, v34, v162
  v_and_b32 v210, v34, v164
  v_and_b32_e64 v211, v34, v166
  v_bitop3_b32 v7, v161, s80, v7 bitop3:0xbe
  v_bitop3_b32 v7, v163, s80, v7 bitop3:0xbe
  v_mfma_f32_16x16x32_bf16 v[52:55], v[208:211], v[108:111], v[52:55]
  v_bitop3_b32 v7, v165, s80, v7 bitop3:0xbe
  v_bitop3_b32 v7, v167, s80, v7 bitop3:0xbe
  v_mfma_f32_16x16x32_bf16 v[56:59], v[208:211], v[112:115], v[56:59]
  s_waitcnt vmcnt(0)
  v_and_b32 v212, v35, v168
  v_and_b32 v213, v35, v170
  v_and_b32 v214, v35, v172
  v_and_b32_e64 v215, v35, v174
  v_bitop3_b32 v7, v169, s80, v7 bitop3:0xbe
  v_bitop3_b32 v7, v171, s80, v7 bitop3:0xbe
  v_mfma_f32_16x16x32_bf16 v[52:55], v[212:215], v[116:119], v[52:55]
  v_bitop3_b32 v7, v173, s80, v7 bitop3:0xbe
  v_bitop3_b32 v7, v175, s80, v7 bitop3:0xbe
  v_mfma_f32_16x16x32_bf16 v[56:59], v[212:215], v[120:123], v[56:59]
  v_cmp_ne_u32_e64 vcc, 0, v7
  s_cbranch_vccz L_poll_act_ok
  s_add_u32 s81, s81, 1
  s_cmp_lt_u32 s81, 100000
  s_cbranch_scc0 L_poll_act_ok
  s_sleep 1
  s_branch L_poll_act
L_poll_act_ok:
  s_nop 5
  v_cndmask_b32 v68, v56, v52, s[84:85]
  v_cndmask_b32 v69, v57, v53, s[84:85]
  v_cndmask_b32 v70, v58, v54, s[84:85]
  v_cndmask_b32 v71, v59, v55, s[84:85]
  ds_write_b128 v63, v[68:71] offset:4352
  s_nop 0
  s_waitcnt lgkmcnt(0)
  s_cbranch_execz L_tb_145
  s_barrier
L_tb_145:
  s_cmp_lg_u32 s72, 0
  s_cbranch_scc1 L_fin
  ds_read2_b32 v[128:129], v48 offset0:0 offset1:4
  ds_read2_b32 v[130:131], v48 offset0:128 offset1:132
  ds_read2_b32 v[132:133], v49 offset0:0 offset1:4
  ds_read2_b32 v[134:135], v49 offset0:128 offset1:132
  ds_read2_b32 v[136:137], v50 offset0:0 offset1:4
  ds_read2_b32 v[138:139], v50 offset0:128 offset1:132
  ds_read2_b32 v[140:141], v51 offset0:0 offset1:4
  ds_read2_b32 v[142:143], v51 offset0:128 offset1:132
  s_lshl_b32 s77, s75, 5
  s_waitcnt lgkmcnt(6)
  v_pk_add_f32 v[128:129], v[128:129], v[130:131]
  s_nop 0
  s_waitcnt lgkmcnt(4)
  v_pk_add_f32 v[132:133], v[132:133], v[134:135]
  v_pk_add_f32 v[132:133], v[132:133], v[128:129]
  s_waitcnt lgkmcnt(2)
  v_pk_add_f32 v[136:137], v[136:137], v[138:139]
  s_waitcnt lgkmcnt(0)
  v_pk_add_f32 v[140:141], v[140:141], v[142:143]
  v_pk_add_f32 v[140:141], v[140:141], v[136:137]
  v_pk_add_f32 v[128:129], v[132:133], v[140:141]
  v_cvt_pk_bf16_f32 v128, 0, v128
  v_cvt_pk_bf16_f32 v129, 0, v129
  v_pk_mul_f32 v[128:129], v[128:129], v[44:45]
  v_cvt_pk_bf16_f32 v128, 0, v128
  v_cvt_pk_bf16_f32 v129, 0, v129
  v_pk_add_f32 v[128:129], v[128:129], v[46:47]
  v_cvt_pk_bf16_f32 v68, v128, v129
  buffer_store_dword v68, v62, s[64:67], s77 offen
L_fin:
  s_cbranch_execz L_real
L_end:
  s_endpgm
.section .rodata,"a"
.p2align 6
.amdhsa_kernel adaLN_cond__mha_block_cached__swiglu_ffn__decode_kernel
  .amdhsa_next_free_vgpr 256
  .amdhsa_next_free_sgpr 96
  .amdhsa_accum_offset 256
  .amdhsa_group_segment_fixed_size 0
  .amdhsa_kernarg_size 112
  .amdhsa_user_sgpr_count 2
  .amdhsa_user_sgpr_kernarg_segment_ptr 1
  .amdhsa_system_sgpr_workgroup_id_x 1
  .amdhsa_float_denorm_mode_32 3
.end_amdhsa_kernel
```
